```python
import torch

def _softmax(x, axis=-1):
    return torch.softmax(x, dim=axis)

def _gelu(x):
    return torch.nn.functional.gelu(x, approximate='tanh')

def _silu(x):
    return torch.nn.functional.silu(x)

def _sigmoid(x):
    return torch.sigmoid(x)

def _layernorm(x, axis=-1, eps=1e-05):
    m = x.mean(dim=axis, keepdim=True)
    v = x.var(dim=axis, keepdim=True, unbiased=False)
    return (x - m) / torch.sqrt(v + eps)

def _scatter_add(tgt, idx, src, axis=0):
    return tgt.clone().index_add_(axis, idx, src)

def _segment_sum(src, seg, n):
    out = torch.zeros((n,) + src.shape[1:], dtype=src.dtype)
    return out.index_add_(0, seg, src)

def _pad(x, pw):
    flat = tuple((v for pair in reversed(pw) for v in pair))
    return torch.nn.functional.pad(x, flat)
kernel_name = 'adaLN_cond__grouped_kv_mqa__geglu_ffn__prompt'

def setup_inputs():

    _w = lambda a: (lambda t: t.to(torch.bfloat16) if t.is_floating_point() else t)(torch.as_tensor(a))

    def _A_setup():
        B, S, D, H = (1, 2048, 512, 32)
        Dh = D // H
        return {'x': _w((lambda *s: torch.randn(*s, dtype=torch.bfloat16) * 0.05)(B, S, D)), 'wq': _w((lambda *s: torch.randn(*s, dtype=torch.bfloat16) * 0.1)(D, H * Dh)), 'wk': _w((lambda *s: torch.randn(*s, dtype=torch.bfloat16) * 0.1)(D, Dh)), 'wv': _w((lambda *s: torch.randn(*s, dtype=torch.bfloat16) * 0.05)(D, Dh)), 'wo': _w((lambda *s: torch.randn(*s, dtype=torch.bfloat16) * 0.05)(H * Dh, D))}
    _A_in = _A_setup()

    def _B_setup():
        B, S, D, F = (1, 2048, 512, 1792)
        return {'x': _w((lambda *s: torch.randn(*s, dtype=torch.bfloat16) * 0.05)(B, S, D)), 'w_gate': _w((lambda *s: torch.randn(*s, dtype=torch.bfloat16) * 0.05)(D, F)), 'w_up': _w((lambda *s: torch.randn(*s, dtype=torch.bfloat16) * 0.05)(D, F)), 'w_down': _w((lambda *s: torch.randn(*s, dtype=torch.bfloat16) * 0.05)(F, D))}
    _B_in = _B_setup()
    return {'A_x': _A_in['x'], 'A_wq': _A_in['wq'], 'A_wk': _A_in['wk'], 'A_wv': _A_in['wv'], 'A_wo': _A_in['wo'], 'B_x': _B_in['x'], 'B_w_gate': _B_in['w_gate'], 'B_w_up': _B_in['w_up'], 'B_w_down': _B_in['w_down'], 'c': _w((lambda *s: torch.randn(*s, dtype=torch.bfloat16) * 0.1)(1, 512) * 8.0), 'w_mod': _w((lambda *s: torch.randn(*s, dtype=torch.bfloat16) * 0.1)(512, 6 * 512) * 512 ** (-0.5) * 8.0)}

def reference(A_x, A_wq, A_wk, A_wv, A_wo, B_x, B_w_gate, B_w_up, B_w_down, c, w_mod):

    def _A_ref(x, wq, wk, wv, wo):
        B, S, D = x.shape
        H = 32
        Dh = D // H
        q = (lambda x, *d: x.permute(*d))((x @ wq).reshape(B, S, H, Dh), 0, 2, 1, 3)
        k = x @ wk
        v = x @ wv
        scores = torch.einsum('bhqd,bkd->bhqk', q, k) * Dh ** (-0.5)
        p = _softmax(scores, axis=-1)
        o = torch.einsum('bhqk,bkd->bhqd', p, v)
        return (lambda x, *d: x.permute(*d))(o, 0, 2, 1, 3).reshape(B, S, H * Dh) @ wo

    def _B_ref(x, w_gate, w_up, w_down):
        return _gelu(x @ w_gate) * (x @ w_up) @ w_down
    x = A_x
    mod = (_silu(c) @ w_mod).reshape(c.shape[0], 6, 1, -1)
    sa, ca, ga, sb, cb, gb = (mod[:, 0].clone(), mod[:, 1].clone(), mod[:, 2].clone(), mod[:, 3].clone(), mod[:, 4].clone(), mod[:, 5].clone())
    h = _layernorm(x, axis=-1) * (1 + ca) + sa
    x = x + ga * _A_ref(h, A_wq, A_wk, A_wv, A_wo)
    h = _layernorm(x, axis=-1) * (1 + cb) + sb
    x = x + gb * _B_ref(h, B_w_gate, B_w_up, B_w_down)
    return x
```

```asm
; @launch kernel=k1_prep_kernel grid=(256,1,1) block=(256,1,1) lds=2048
; @launch kernel=kf_main_kernel grid=(256,1,1) block=(512,1,1) lds=163840
.amdgcn_target "amdgcn-amd-amdhsa--gfx950"
.text
.globl k1_prep_kernel
.p2align 8
.type k1_prep_kernel,@function
k1_prep_kernel:
    s_cmp_ge_u32 s2, 256
    s_cbranch_scc1 K1_END
    s_load_dwordx16 s[16:31], s[0:1], 0
    s_load_dwordx8 s[32:39], s[0:1], 64
    s_load_dwordx2 s[40:41], s[0:1], 104
    v_lshrrev_b32 v1, 6, v0
    v_and_b32 v2, 63, v0
    v_readfirstlane_b32 s3, v1
    s_getpc_b64 s[50:51]
K1_PC0:
    s_lshr_b32 s43, s2, 3
    s_and_b32 s43, s43, 7
    s_min_u32 s43, s43, ((K1_END-K1_PC0)>>10)
    s_lshl_b32 s43, s43, 10
    s_and_b32 s50, s50, 0xffffffc0
    v_lshl_add_u32 v116, v2, 4, s43
    s_cmp_lg_u32 s3, 3
    s_cbranch_scc1 K1_NOPF
    global_load_dwordx4 v[112:115], v116, s[50:51]
K1_NOPF:
    s_waitcnt lgkmcnt(0)
    s_mov_b32 s4, s40
    s_mov_b32 s5, s41
    s_mov_b32 s6, 0x10000000
    s_mov_b32 s7, 0x00020000
    s_cmp_ge_u32 s2, 96
    s_cbranch_scc1 K1_REST
K1_MOD:
    s_mov_b32 s8, s36
    s_mov_b32 s9, s37
    s_mov_b32 s10, 3145728
    s_mov_b32 s11, 0x00020000
    s_mov_b32 s12, s34
    s_mov_b32 s13, s35
    s_mov_b32 s14, 1024
    s_mov_b32 s15, 0x00020000
    v_and_b32 v3, 3, v0
    v_lshrrev_b32 v4, 2, v0
    v_lshlrev_b32 v6, 1, v4
    s_mov_b32 s42, 6144
    v_mul_lo_u32 v5, v4, s42
    v_lshl_add_u32 v5, v3, 4, v5
    s_and_b32 s52, s2, 7
    s_mul_i32 s52, s52, 12
    s_lshr_b32 s43, s2, 3
    s_add_u32 s52, s52, s43
    s_lshl_b32 s43, s52, 6
    buffer_load_ushort v44, v6, s[12:15], 0 offen offset:0
    buffer_load_ushort v45, v6, s[12:15], 0 offen offset:128
    buffer_load_ushort v46, v6, s[12:15], 0 offen offset:256
    buffer_load_ushort v47, v6, s[12:15], 0 offen offset:384
    buffer_load_ushort v48, v6, s[12:15], 0 offen offset:512
    buffer_load_ushort v49, v6, s[12:15], 0 offen offset:640
    buffer_load_ushort v50, v6, s[12:15], 0 offen offset:768
    buffer_load_ushort v51, v6, s[12:15], 0 offen offset:896
    buffer_load_dwordx4 v[12:15], v5, s[8:11], s43 offen nt
    s_add_u32 s43, s43, 393216
    buffer_load_dwordx4 v[16:19], v5, s[8:11], s43 offen nt
    s_add_u32 s43, s43, 393216
    buffer_load_dwordx4 v[20:23], v5, s[8:11], s43 offen nt
    s_add_u32 s43, s43, 393216
    buffer_load_dwordx4 v[24:27], v5, s[8:11], s43 offen nt
    s_add_u32 s43, s43, 393216
    buffer_load_dwordx4 v[28:31], v5, s[8:11], s43 offen nt
    s_add_u32 s43, s43, 393216
    buffer_load_dwordx4 v[32:35], v5, s[8:11], s43 offen nt
    s_add_u32 s43, s43, 393216
    buffer_load_dwordx4 v[36:39], v5, s[8:11], s43 offen nt
    s_add_u32 s43, s43, 393216
    buffer_load_dwordx4 v[40:43], v5, s[8:11], s43 offen nt
    v_mov_b32 v60, 0
    v_mov_b32 v61, 0
    v_mov_b32 v62, 0
    v_mov_b32 v63, 0
    v_mov_b32 v64, 0
    v_mov_b32 v65, 0
    v_mov_b32 v66, 0
    v_mov_b32 v67, 0
    s_waitcnt vmcnt(8)
    v_lshlrev_b32 v44, 16, v44
    v_lshlrev_b32 v45, 16, v45
    v_lshlrev_b32 v46, 16, v46
    v_lshlrev_b32 v47, 16, v47
    v_lshlrev_b32 v48, 16, v48
    v_lshlrev_b32 v49, 16, v49
    v_lshlrev_b32 v50, 16, v50
    v_lshlrev_b32 v51, 16, v51
    v_mul_f32 v52, 0xbfb8aa3b, v44
    v_mul_f32 v53, 0xbfb8aa3b, v45
    v_mul_f32 v54, 0xbfb8aa3b, v46
    v_mul_f32 v55, 0xbfb8aa3b, v47
    v_mul_f32 v56, 0xbfb8aa3b, v48
    v_mul_f32 v57, 0xbfb8aa3b, v49
    v_mul_f32 v58, 0xbfb8aa3b, v50
    v_mul_f32 v59, 0xbfb8aa3b, v51
    v_exp_f32 v52, v52
    v_exp_f32 v53, v53
    v_exp_f32 v54, v54
    v_exp_f32 v55, v55
    v_exp_f32 v56, v56
    v_exp_f32 v57, v57
    v_exp_f32 v58, v58
    v_exp_f32 v59, v59
    v_add_f32 v52, 1.0, v52
    v_add_f32 v53, 1.0, v53
    v_add_f32 v54, 1.0, v54
    v_add_f32 v55, 1.0, v55
    v_add_f32 v56, 1.0, v56
    v_add_f32 v57, 1.0, v57
    v_add_f32 v58, 1.0, v58
    v_add_f32 v59, 1.0, v59
    v_rcp_f32 v52, v52
    v_rcp_f32 v53, v53
    v_rcp_f32 v54, v54
    v_rcp_f32 v55, v55
    v_rcp_f32 v56, v56
    v_rcp_f32 v57, v57
    v_rcp_f32 v58, v58
    v_rcp_f32 v59, v59
    v_mul_f32 v44, v44, v52
    v_mul_f32 v45, v45, v53
    v_mul_f32 v46, v46, v54
    v_mul_f32 v47, v47, v55
    v_mul_f32 v48, v48, v56
    v_mul_f32 v49, v49, v57
    v_mul_f32 v50, v50, v58
    v_mul_f32 v51, v51, v59
    v_cvt_pk_bf16_f32 v44, v44, v44
    v_lshlrev_b32 v44, 16, v44
    v_cvt_pk_bf16_f32 v45, v45, v45
    v_lshlrev_b32 v45, 16, v45
    v_cvt_pk_bf16_f32 v46, v46, v46
    v_lshlrev_b32 v46, 16, v46
    v_cvt_pk_bf16_f32 v47, v47, v47
    v_lshlrev_b32 v47, 16, v47
    v_cvt_pk_bf16_f32 v48, v48, v48
    v_lshlrev_b32 v48, 16, v48
    v_cvt_pk_bf16_f32 v49, v49, v49
    v_lshlrev_b32 v49, 16, v49
    v_cvt_pk_bf16_f32 v50, v50, v50
    v_lshlrev_b32 v50, 16, v50
    v_cvt_pk_bf16_f32 v51, v51, v51
    v_lshlrev_b32 v51, 16, v51
    s_waitcnt vmcnt(7)
    v_lshlrev_b32 v7, 16, v12
    v_and_b32 v8, 0xffff0000, v12
    v_fmac_f32 v60, v7, v44
    v_fmac_f32 v61, v8, v44
    v_lshlrev_b32 v7, 16, v13
    v_and_b32 v8, 0xffff0000, v13
    v_fmac_f32 v62, v7, v44
    v_fmac_f32 v63, v8, v44
    v_lshlrev_b32 v7, 16, v14
    v_and_b32 v8, 0xffff0000, v14
    v_fmac_f32 v64, v7, v44
    v_fmac_f32 v65, v8, v44
    v_lshlrev_b32 v7, 16, v15
    v_and_b32 v8, 0xffff0000, v15
    v_fmac_f32 v66, v7, v44
    v_fmac_f32 v67, v8, v44
    s_waitcnt vmcnt(6)
    v_lshlrev_b32 v7, 16, v16
    v_and_b32 v8, 0xffff0000, v16
    v_fmac_f32 v60, v7, v45
    v_fmac_f32 v61, v8, v45
    v_lshlrev_b32 v7, 16, v17
    v_and_b32 v8, 0xffff0000, v17
    v_fmac_f32 v62, v7, v45
    v_fmac_f32 v63, v8, v45
    v_lshlrev_b32 v7, 16, v18
    v_and_b32 v8, 0xffff0000, v18
    v_fmac_f32 v64, v7, v45
    v_fmac_f32 v65, v8, v45
    v_lshlrev_b32 v7, 16, v19
    v_and_b32 v8, 0xffff0000, v19
    v_fmac_f32 v66, v7, v45
    v_fmac_f32 v67, v8, v45
    s_waitcnt vmcnt(5)
    v_lshlrev_b32 v7, 16, v20
    v_and_b32 v8, 0xffff0000, v20
    v_fmac_f32 v60, v7, v46
    v_fmac_f32 v61, v8, v46
    v_lshlrev_b32 v7, 16, v21
    v_and_b32 v8, 0xffff0000, v21
    v_fmac_f32 v62, v7, v46
    v_fmac_f32 v63, v8, v46
    v_lshlrev_b32 v7, 16, v22
    v_and_b32 v8, 0xffff0000, v22
    v_fmac_f32 v64, v7, v46
    v_fmac_f32 v65, v8, v46
    v_lshlrev_b32 v7, 16, v23
    v_and_b32 v8, 0xffff0000, v23
    v_fmac_f32 v66, v7, v46
    v_fmac_f32 v67, v8, v46
    s_waitcnt vmcnt(4)
    v_lshlrev_b32 v7, 16, v24
    v_and_b32 v8, 0xffff0000, v24
    v_fmac_f32 v60, v7, v47
    v_fmac_f32 v61, v8, v47
    v_lshlrev_b32 v7, 16, v25
    v_and_b32 v8, 0xffff0000, v25
    v_fmac_f32 v62, v7, v47
    v_fmac_f32 v63, v8, v47
    v_lshlrev_b32 v7, 16, v26
    v_and_b32 v8, 0xffff0000, v26
    v_fmac_f32 v64, v7, v47
    v_fmac_f32 v65, v8, v47
    v_lshlrev_b32 v7, 16, v27
    v_and_b32 v8, 0xffff0000, v27
    v_fmac_f32 v66, v7, v47
    v_fmac_f32 v67, v8, v47
    s_waitcnt vmcnt(3)
    v_lshlrev_b32 v7, 16, v28
    v_and_b32 v8, 0xffff0000, v28
    v_fmac_f32 v60, v7, v48
    v_fmac_f32 v61, v8, v48
    v_lshlrev_b32 v7, 16, v29
    v_and_b32 v8, 0xffff0000, v29
    v_fmac_f32 v62, v7, v48
    v_fmac_f32 v63, v8, v48
    v_lshlrev_b32 v7, 16, v30
    v_and_b32 v8, 0xffff0000, v30
    v_fmac_f32 v64, v7, v48
    v_fmac_f32 v65, v8, v48
    v_lshlrev_b32 v7, 16, v31
    v_and_b32 v8, 0xffff0000, v31
    v_fmac_f32 v66, v7, v48
    v_fmac_f32 v67, v8, v48
    s_waitcnt vmcnt(2)
    v_lshlrev_b32 v7, 16, v32
    v_and_b32 v8, 0xffff0000, v32
    v_fmac_f32 v60, v7, v49
    v_fmac_f32 v61, v8, v49
    v_lshlrev_b32 v7, 16, v33
    v_and_b32 v8, 0xffff0000, v33
    v_fmac_f32 v62, v7, v49
    v_fmac_f32 v63, v8, v49
    v_lshlrev_b32 v7, 16, v34
    v_and_b32 v8, 0xffff0000, v34
    v_fmac_f32 v64, v7, v49
    v_fmac_f32 v65, v8, v49
    v_lshlrev_b32 v7, 16, v35
    v_and_b32 v8, 0xffff0000, v35
    v_fmac_f32 v66, v7, v49
    v_fmac_f32 v67, v8, v49
    s_waitcnt vmcnt(1)
    v_lshlrev_b32 v7, 16, v36
    v_and_b32 v8, 0xffff0000, v36
    v_fmac_f32 v60, v7, v50
    v_fmac_f32 v61, v8, v50
    v_lshlrev_b32 v7, 16, v37
    v_and_b32 v8, 0xffff0000, v37
    v_fmac_f32 v62, v7, v50
    v_fmac_f32 v63, v8, v50
    v_lshlrev_b32 v7, 16, v38
    v_and_b32 v8, 0xffff0000, v38
    v_fmac_f32 v64, v7, v50
    v_fmac_f32 v65, v8, v50
    v_lshlrev_b32 v7, 16, v39
    v_and_b32 v8, 0xffff0000, v39
    v_fmac_f32 v66, v7, v50
    v_fmac_f32 v67, v8, v50
    s_waitcnt vmcnt(0)
    v_lshlrev_b32 v7, 16, v40
    v_and_b32 v8, 0xffff0000, v40
    v_fmac_f32 v60, v7, v51
    v_fmac_f32 v61, v8, v51
    v_lshlrev_b32 v7, 16, v41
    v_and_b32 v8, 0xffff0000, v41
    v_fmac_f32 v62, v7, v51
    v_fmac_f32 v63, v8, v51
    v_lshlrev_b32 v7, 16, v42
    v_and_b32 v8, 0xffff0000, v42
    v_fmac_f32 v64, v7, v51
    v_fmac_f32 v65, v8, v51
    v_lshlrev_b32 v7, 16, v43
    v_and_b32 v8, 0xffff0000, v43
    v_fmac_f32 v66, v7, v51
    v_fmac_f32 v67, v8, v51
    v_add_f32_dpp v60, v60, v60 row_ror:4 row_mask:0xf bank_mask:0xf
    v_add_f32_dpp v61, v61, v61 row_ror:4 row_mask:0xf bank_mask:0xf
    v_add_f32_dpp v62, v62, v62 row_ror:4 row_mask:0xf bank_mask:0xf
    v_add_f32_dpp v63, v63, v63 row_ror:4 row_mask:0xf bank_mask:0xf
    v_add_f32_dpp v64, v64, v64 row_ror:4 row_mask:0xf bank_mask:0xf
    v_add_f32_dpp v65, v65, v65 row_ror:4 row_mask:0xf bank_mask:0xf
    v_add_f32_dpp v66, v66, v66 row_ror:4 row_mask:0xf bank_mask:0xf
    v_add_f32_dpp v67, v67, v67 row_ror:4 row_mask:0xf bank_mask:0xf
    v_add_f32_dpp v60, v60, v60 row_ror:8 row_mask:0xf bank_mask:0xf
    v_add_f32_dpp v61, v61, v61 row_ror:8 row_mask:0xf bank_mask:0xf
    v_add_f32_dpp v62, v62, v62 row_ror:8 row_mask:0xf bank_mask:0xf
    v_add_f32_dpp v63, v63, v63 row_ror:8 row_mask:0xf bank_mask:0xf
    v_add_f32_dpp v64, v64, v64 row_ror:8 row_mask:0xf bank_mask:0xf
    v_add_f32_dpp v65, v65, v65 row_ror:8 row_mask:0xf bank_mask:0xf
    v_add_f32_dpp v66, v66, v66 row_ror:8 row_mask:0xf bank_mask:0xf
    v_add_f32_dpp v67, v67, v67 row_ror:8 row_mask:0xf bank_mask:0xf
    v_lshrrev_b32 v7, 4, v0
    v_lshlrev_b32 v7, 7, v7
    v_lshl_add_u32 v7, v3, 5, v7
    ds_write_b128 v7, v[60:63]
    ds_write_b128 v7, v[64:67] offset:16
    s_waitcnt lgkmcnt(0)
    s_barrier
    s_cmp_lg_u32 s3, 0
    s_cbranch_scc1 K1_END
    v_and_b32 v7, 31, v0
    v_lshlrev_b32 v7, 2, v7
    ds_read_b32 v12, v7 offset:0
    ds_read_b32 v13, v7 offset:128
    ds_read_b32 v14, v7 offset:256
    ds_read_b32 v15, v7 offset:384
    ds_read_b32 v16, v7 offset:512
    ds_read_b32 v17, v7 offset:640
    ds_read_b32 v18, v7 offset:768
    ds_read_b32 v19, v7 offset:896
    ds_read_b32 v20, v7 offset:1024
    ds_read_b32 v21, v7 offset:1152
    ds_read_b32 v22, v7 offset:1280
    ds_read_b32 v23, v7 offset:1408
    ds_read_b32 v24, v7 offset:1536
    ds_read_b32 v25, v7 offset:1664
    ds_read_b32 v26, v7 offset:1792
    ds_read_b32 v27, v7 offset:1920
    s_waitcnt lgkmcnt(0)
    v_add_f32 v12, v12, v13
    v_add_f32 v14, v14, v15
    v_add_f32 v16, v16, v17
    v_add_f32 v18, v18, v19
    v_add_f32 v20, v20, v21
    v_add_f32 v22, v22, v23
    v_add_f32 v24, v24, v25
    v_add_f32 v26, v26, v27
    v_add_f32 v12, v12, v14
    v_add_f32 v16, v16, v18
    v_add_f32 v20, v20, v22
    v_add_f32 v24, v24, v26
    v_add_f32 v12, v12, v16
    v_add_f32 v20, v20, v24
    v_add_f32 v12, v12, v20
    v_cvt_pk_bf16_f32 v12, v12, v12
    v_lshlrev_b32 v12, 16, v12
    s_lshr_b32 s42, s52, 4
    s_cmp_eq_u32 s42, 1
    s_cbranch_scc1 K1_MOD_P1
    s_cmp_eq_u32 s42, 4
    s_cbranch_scc0 K1_MOD_ST
K1_MOD_P1:
    v_add_f32 v12, 1.0, v12
    v_cvt_pk_bf16_f32 v12, v12, v12
    v_lshlrev_b32 v12, 16, v12
K1_MOD_ST:
    s_lshl_b32 s43, s52, 7
    s_add_u32 s43, s43, 0x0
    buffer_store_dword v12, v7, s[4:7], s43 offen
    s_endpgm
K1_REST:
    v_mov_b32 v120, -1
    v_mov_b32 v121, -1
    v_mov_b32 v122, -1
    v_mov_b32 v123, -1
    v_lshlrev_b32 v124, 4, v0
    s_sub_u32 s49, s2, 96
    s_lshl_b32 s49, s49, 12
    s_add_u32 s49, s49, 0xe80000
    s_cmp_ge_u32 s2, 128
    s_cbranch_scc1 K1_NOPOIS
    buffer_store_dwordx4 v[120:123], v124, s[4:7], s49 offen
K1_NOPOIS:
    s_cmp_lt_u32 s2, 160
    s_cbranch_scc1 K1_STAT
    s_cmp_lt_u32 s2, 248
    s_cbranch_scc1 K1_TR
    s_sub_u32 s42, s2, 248
    s_getpc_b64 s[50:51]
K1_PC:
    s_lshl_b32 s43, s42, 2
    s_add_u32 s43, s43, s3
    s_min_u32 s43, s43, ((KF_HOT_END-kf_main_kernel)>>10)
    s_lshl_b32 s43, s43, 10
    s_add_u32 s43, s43, kf_main_kernel-K1_PC
    v_lshl_add_u32 v30, v2, 4, s43
    global_load_dwordx4 v[32:35], v30, s[50:51]
    s_and_b32 s43, s42, 1
    s_cmp_eq_u32 s43, 0
    s_cselect_b32 s8, s20, s22
    s_cselect_b32 s9, s21, s23
    s_mov_b32 s10, 16384
    s_mov_b32 s11, 0x00020000
    s_lshr_b32 s44, s42, 1
    s_lshl_b32 s44, s44, 2
    s_add_u32 s44, s44, s3
    s_lshl_b32 s44, s44, 2
    v_lshrrev_b32 v3, 4, v2
    v_add_u32 v3, s44, v3
    v_and_b32 v4, 15, v2
    v_lshlrev_b32 v5, 8, v3
    v_lshl_add_u32 v5, v4, 1, v5
    buffer_load_ushort v10, v5, s[8:11], 0 offen offset:0 nt
    buffer_load_ushort v11, v5, s[8:11], 0 offen offset:32 nt
    buffer_load_ushort v12, v5, s[8:11], 0 offen offset:64 nt
    buffer_load_ushort v13, v5, s[8:11], 0 offen offset:96 nt
    buffer_load_ushort v14, v5, s[8:11], 0 offen offset:128 nt
    buffer_load_ushort v15, v5, s[8:11], 0 offen offset:160 nt
    buffer_load_ushort v16, v5, s[8:11], 0 offen offset:192 nt
    buffer_load_ushort v17, v5, s[8:11], 0 offen offset:224 nt
    v_and_b32 v6, 3, v4
    v_and_b32 v7, 4, v4
    v_lshl_or_b32 v6, v7, 1, v6
    v_and_b32 v7, 8, v4
    v_lshrrev_b32 v7, 1, v7
    v_or_b32 v6, v6, v7
    s_lshl_b32 s43, s43, 4
    v_add_u32 v6, s43, v6
    v_lshlrev_b32 v6, 4, v6
    v_lshl_add_u32 v6, v3, 9, v6
    s_mov_b32 s45, 0x8000
    v_mov_b32 v24, 0
    v_mov_b32 v25, 0
    v_mov_b32 v26, 0
    v_mov_b32 v27, 0
    v_lshrrev_b32 v28, 2, v0
    v_lshlrev_b32 v28, 7, v28
    v_and_b32 v29, 3, v0
    v_lshl_add_u32 v28, v29, 4, v28
    s_lshl_b32 s46, s42, 14
    s_add_u32 s46, s46, 0x40000
    s_add_u32 s47, s46, 8192
    buffer_store_dwordx4 v[24:27], v28, s[4:7], s46 offen
    buffer_store_dwordx4 v[24:27], v28, s[4:7], s47 offen
    s_waitcnt vmcnt(0)
    v_lshl_or_b32 v20, v11, 16, v10
    v_lshl_or_b32 v21, v13, 16, v12
    v_lshl_or_b32 v22, v15, 16, v14
    v_lshl_or_b32 v23, v17, 16, v16
    buffer_store_dwordx4 v[20:23], v6, s[4:7], s45 offen
    s_endpgm
K1_TR:
    s_sub_u32 s42, s2, 160
    s_cmp_lt_u32 s42, 16
    s_cbranch_scc1 K1_TR_Q
    s_cmp_lt_u32 s42, 32
    s_cbranch_scc1 K1_TR_O
    s_sub_u32 s42, s42, 32
    s_mov_b32 s8, s32
    s_mov_b32 s9, s33
    s_mov_b32 s10, 1835008
    s_mov_b32 s45, 0x200000
    s_mov_b32 s46, 114688
    s_branch K1_TR_GO
K1_TR_Q:
    s_mov_b32 s8, s18
    s_mov_b32 s9, s19
    s_mov_b32 s10, 524288
    s_mov_b32 s45, 0x80000
    s_mov_b32 s46, 32768
    s_branch K1_TR_GO
K1_TR_O:
    s_sub_u32 s42, s42, 16
    s_mov_b32 s8, s24
    s_mov_b32 s9, s25
    s_mov_b32 s10, 524288
    s_mov_b32 s45, 0x100000
    s_mov_b32 s46, 32768
K1_TR_GO:
    s_mov_b32 s11, 0x00020000
    s_and_b32 s43, s42, 7
    s_lshr_b32 s44, s42, 3
    s_lshl_b32 s44, s44, 2
    s_add_u32 s44, s44, s3
    s_lshl_b32 s47, s44, 16
    s_lshl_b32 s48, s43, 7
    s_add_u32 s47, s47, s48
    v_lshlrev_b32 v5, 1, v2
    buffer_load_ushort v10, v5, s[8:11], s47 offen offset:0 nt
    buffer_load_ushort v11, v5, s[8:11], s47 offen offset:1024 nt
    buffer_load_ushort v12, v5, s[8:11], s47 offen offset:2048 nt
    buffer_load_ushort v13, v5, s[8:11], s47 offen offset:3072 nt
    s_add_u32 s47, s47, 4096
    buffer_load_ushort v14, v5, s[8:11], s47 offen offset:0 nt
    buffer_load_ushort v15, v5, s[8:11], s47 offen offset:1024 nt
    buffer_load_ushort v16, v5, s[8:11], s47 offen offset:2048 nt
    buffer_load_ushort v17, v5, s[8:11], s47 offen offset:3072 nt
    s_add_u32 s47, s47, 4096
    buffer_load_ushort v18, v5, s[8:11], s47 offen offset:0 nt
    buffer_load_ushort v19, v5, s[8:11], s47 offen offset:1024 nt
    buffer_load_ushort v20, v5, s[8:11], s47 offen offset:2048 nt
    buffer_load_ushort v21, v5, s[8:11], s47 offen offset:3072 nt
    s_add_u32 s47, s47, 4096
    buffer_load_ushort v22, v5, s[8:11], s47 offen offset:0 nt
    buffer_load_ushort v23, v5, s[8:11], s47 offen offset:1024 nt
    buffer_load_ushort v24, v5, s[8:11], s47 offen offset:2048 nt
    buffer_load_ushort v25, v5, s[8:11], s47 offen offset:3072 nt
    s_add_u32 s47, s47, 4096
    buffer_load_ushort v26, v5, s[8:11], s47 offen offset:0 nt
    buffer_load_ushort v27, v5, s[8:11], s47 offen offset:1024 nt
    buffer_load_ushort v28, v5, s[8:11], s47 offen offset:2048 nt
    buffer_load_ushort v29, v5, s[8:11], s47 offen offset:3072 nt
    s_add_u32 s47, s47, 4096
    buffer_load_ushort v30, v5, s[8:11], s47 offen offset:0 nt
    buffer_load_ushort v31, v5, s[8:11], s47 offen offset:1024 nt
    buffer_load_ushort v32, v5, s[8:11], s47 offen offset:2048 nt
    buffer_load_ushort v33, v5, s[8:11], s47 offen offset:3072 nt
    s_add_u32 s47, s47, 4096
    buffer_load_ushort v34, v5, s[8:11], s47 offen offset:0 nt
    buffer_load_ushort v35, v5, s[8:11], s47 offen offset:1024 nt
    buffer_load_ushort v36, v5, s[8:11], s47 offen offset:2048 nt
    buffer_load_ushort v37, v5, s[8:11], s47 offen offset:3072 nt
    s_add_u32 s47, s47, 4096
    buffer_load_ushort v38, v5, s[8:11], s47 offen offset:0 nt
    buffer_load_ushort v39, v5, s[8:11], s47 offen offset:1024 nt
    buffer_load_ushort v40, v5, s[8:11], s47 offen offset:2048 nt
    buffer_load_ushort v41, v5, s[8:11], s47 offen offset:3072 nt
    s_add_u32 s47, s47, 4096
    buffer_load_ushort v42, v5, s[8:11], s47 offen offset:0 nt
    buffer_load_ushort v43, v5, s[8:11], s47 offen offset:1024 nt
    buffer_load_ushort v44, v5, s[8:11], s47 offen offset:2048 nt
    buffer_load_ushort v45, v5, s[8:11], s47 offen offset:3072 nt
    s_add_u32 s47, s47, 4096
    buffer_load_ushort v46, v5, s[8:11], s47 offen offset:0 nt
    buffer_load_ushort v47, v5, s[8:11], s47 offen offset:1024 nt
    buffer_load_ushort v48, v5, s[8:11], s47 offen offset:2048 nt
    buffer_load_ushort v49, v5, s[8:11], s47 offen offset:3072 nt
    s_add_u32 s47, s47, 4096
    buffer_load_ushort v50, v5, s[8:11], s47 offen offset:0 nt
    buffer_load_ushort v51, v5, s[8:11], s47 offen offset:1024 nt
    buffer_load_ushort v52, v5, s[8:11], s47 offen offset:2048 nt
    buffer_load_ushort v53, v5, s[8:11], s47 offen offset:3072 nt
    s_add_u32 s47, s47, 4096
    buffer_load_ushort v54, v5, s[8:11], s47 offen offset:0 nt
    buffer_load_ushort v55, v5, s[8:11], s47 offen offset:1024 nt
    buffer_load_ushort v56, v5, s[8:11], s47 offen offset:2048 nt
    buffer_load_ushort v57, v5, s[8:11], s47 offen offset:3072 nt
    s_add_u32 s47, s47, 4096
    buffer_load_ushort v58, v5, s[8:11], s47 offen offset:0 nt
    buffer_load_ushort v59, v5, s[8:11], s47 offen offset:1024 nt
    buffer_load_ushort v60, v5, s[8:11], s47 offen offset:2048 nt
    buffer_load_ushort v61, v5, s[8:11], s47 offen offset:3072 nt
    s_add_u32 s47, s47, 4096
    buffer_load_ushort v62, v5, s[8:11], s47 offen offset:0 nt
    buffer_load_ushort v63, v5, s[8:11], s47 offen offset:1024 nt
    buffer_load_ushort v64, v5, s[8:11], s47 offen offset:2048 nt
    buffer_load_ushort v65, v5, s[8:11], s47 offen offset:3072 nt
    s_add_u32 s47, s47, 4096
    buffer_load_ushort v66, v5, s[8:11], s47 offen offset:0 nt
    buffer_load_ushort v67, v5, s[8:11], s47 offen offset:1024 nt
    buffer_load_ushort v68, v5, s[8:11], s47 offen offset:2048 nt
    buffer_load_ushort v69, v5, s[8:11], s47 offen offset:3072 nt
    s_add_u32 s47, s47, 4096
    buffer_load_ushort v70, v5, s[8:11], s47 offen offset:0 nt
    buffer_load_ushort v71, v5, s[8:11], s47 offen offset:1024 nt
    buffer_load_ushort v72, v5, s[8:11], s47 offen offset:2048 nt
    buffer_load_ushort v73, v5, s[8:11], s47 offen offset:3072 nt
    v_and_b32 v6, 19, v2
    v_and_b32 v7, 4, v2
    v_lshl_or_b32 v6, v7, 1, v6
    v_and_b32 v7, 8, v2
    v_lshrrev_b32 v7, 1, v7
    v_or_b32 v6, v6, v7
    v_lshlrev_b32 v6, 4, v6
    v_lshrrev_b32 v7, 5, v2
    v_mul_lo_u32 v7, v7, s46
    v_add_u32 v6, v6, v7
    s_lshl_b32 s48, s43, 1
    s_mul_i32 s48, s48, s46
    s_add_u32 s45, s45, s48
    s_lshl_b32 s48, s44, 12
    s_add_u32 s45, s45, s48
    s_waitcnt vmcnt(56)
    v_lshl_or_b32 v80, v11, 16, v10
    v_lshl_or_b32 v81, v13, 16, v12
    v_lshl_or_b32 v82, v15, 16, v14
    v_lshl_or_b32 v83, v17, 16, v16
    buffer_store_dwordx4 v[80:83], v6, s[4:7], s45 offen offset:0
    s_waitcnt vmcnt(49)
    v_lshl_or_b32 v84, v19, 16, v18
    v_lshl_or_b32 v85, v21, 16, v20
    v_lshl_or_b32 v86, v23, 16, v22
    v_lshl_or_b32 v87, v25, 16, v24
    buffer_store_dwordx4 v[84:87], v6, s[4:7], s45 offen offset:512
    s_waitcnt vmcnt(42)
    v_lshl_or_b32 v88, v27, 16, v26
    v_lshl_or_b32 v89, v29, 16, v28
    v_lshl_or_b32 v90, v31, 16, v30
    v_lshl_or_b32 v91, v33, 16, v32
    buffer_store_dwordx4 v[88:91], v6, s[4:7], s45 offen offset:1024
    s_waitcnt vmcnt(35)
    v_lshl_or_b32 v92, v35, 16, v34
    v_lshl_or_b32 v93, v37, 16, v36
    v_lshl_or_b32 v94, v39, 16, v38
    v_lshl_or_b32 v95, v41, 16, v40
    buffer_store_dwordx4 v[92:95], v6, s[4:7], s45 offen offset:1536
    s_waitcnt vmcnt(28)
    v_lshl_or_b32 v96, v43, 16, v42
    v_lshl_or_b32 v97, v45, 16, v44
    v_lshl_or_b32 v98, v47, 16, v46
    v_lshl_or_b32 v99, v49, 16, v48
    buffer_store_dwordx4 v[96:99], v6, s[4:7], s45 offen offset:2048
    s_waitcnt vmcnt(21)
    v_lshl_or_b32 v100, v51, 16, v50
    v_lshl_or_b32 v101, v53, 16, v52
    v_lshl_or_b32 v102, v55, 16, v54
    v_lshl_or_b32 v103, v57, 16, v56
    buffer_store_dwordx4 v[100:103], v6, s[4:7], s45 offen offset:2560
    s_waitcnt vmcnt(14)
    v_lshl_or_b32 v104, v59, 16, v58
    v_lshl_or_b32 v105, v61, 16, v60
    v_lshl_or_b32 v106, v63, 16, v62
    v_lshl_or_b32 v107, v65, 16, v64
    buffer_store_dwordx4 v[104:107], v6, s[4:7], s45 offen offset:3072
    s_waitcnt vmcnt(7)
    v_lshl_or_b32 v108, v67, 16, v66
    v_lshl_or_b32 v109, v69, 16, v68
    v_lshl_or_b32 v110, v71, 16, v70
    v_lshl_or_b32 v111, v73, 16, v72
    buffer_store_dwordx4 v[108:111], v6, s[4:7], s45 offen offset:3584
    s_endpgm
K1_STAT:
    s_mov_b32 s8, s16
    s_mov_b32 s9, s17
    s_mov_b32 s10, 2097152
    s_mov_b32 s11, 0x00020000
    s_sub_u32 s42, s2, 96
    s_lshl_b32 s42, s42, 2
    s_add_u32 s42, s42, s3
    s_lshl_b32 s43, s42, 13
    s_add_u32 s44, s43, 4096
    v_lshlrev_b32 v5, 4, v2
    buffer_load_dwordx4 v[12:15], v5, s[8:11], s43 offen offset:0
    buffer_load_dwordx4 v[16:19], v5, s[8:11], s43 offen offset:1024
    buffer_load_dwordx4 v[20:23], v5, s[8:11], s43 offen offset:2048
    buffer_load_dwordx4 v[24:27], v5, s[8:11], s43 offen offset:3072
    buffer_load_dwordx4 v[28:31], v5, s[8:11], s44 offen offset:0
    buffer_load_dwordx4 v[32:35], v5, s[8:11], s44 offen offset:1024
    buffer_load_dwordx4 v[36:39], v5, s[8:11], s44 offen offset:2048
    buffer_load_dwordx4 v[40:43], v5, s[8:11], s44 offen offset:3072
    v_mov_b32 v6, 0x3f803f80
    v_mov_b32 v48, 0
    v_mov_b32 v49, 0
    v_mov_b32 v50, 0
    v_mov_b32 v51, 0
    v_mov_b32 v52, 0
    v_mov_b32 v53, 0
    v_mov_b32 v54, 0
    v_mov_b32 v55, 0
    v_mov_b32 v56, 0
    v_mov_b32 v57, 0
    v_mov_b32 v58, 0
    v_mov_b32 v59, 0
    v_mov_b32 v60, 0
    v_mov_b32 v61, 0
    v_mov_b32 v62, 0
    v_mov_b32 v63, 0
    s_waitcnt vmcnt(7)
    v_dot2_f32_bf16 v48, v12, v6, v48
    v_dot2_f32_bf16 v49, v12, v12, v49
    v_dot2_f32_bf16 v48, v13, v6, v48
    v_dot2_f32_bf16 v49, v13, v13, v49
    v_dot2_f32_bf16 v48, v14, v6, v48
    v_dot2_f32_bf16 v49, v14, v14, v49
    v_dot2_f32_bf16 v48, v15, v6, v48
    v_dot2_f32_bf16 v49, v15, v15, v49
    s_waitcnt vmcnt(6)
    v_dot2_f32_bf16 v50, v16, v6, v50
    v_dot2_f32_bf16 v51, v16, v16, v51
    v_dot2_f32_bf16 v50, v17, v6, v50
    v_dot2_f32_bf16 v51, v17, v17, v51
    v_dot2_f32_bf16 v50, v18, v6, v50
    v_dot2_f32_bf16 v51, v18, v18, v51
    v_dot2_f32_bf16 v50, v19, v6, v50
    v_dot2_f32_bf16 v51, v19, v19, v51
    s_waitcnt vmcnt(5)
    v_dot2_f32_bf16 v52, v20, v6, v52
    v_dot2_f32_bf16 v53, v20, v20, v53
    v_dot2_f32_bf16 v52, v21, v6, v52
    v_dot2_f32_bf16 v53, v21, v21, v53
    v_dot2_f32_bf16 v52, v22, v6, v52
    v_dot2_f32_bf16 v53, v22, v22, v53
    v_dot2_f32_bf16 v52, v23, v6, v52
    v_dot2_f32_bf16 v53, v23, v23, v53
    s_waitcnt vmcnt(4)
    v_dot2_f32_bf16 v54, v24, v6, v54
    v_dot2_f32_bf16 v55, v24, v24, v55
    v_dot2_f32_bf16 v54, v25, v6, v54
    v_dot2_f32_bf16 v55, v25, v25, v55
    v_dot2_f32_bf16 v54, v26, v6, v54
    v_dot2_f32_bf16 v55, v26, v26, v55
    v_dot2_f32_bf16 v54, v27, v6, v54
    v_dot2_f32_bf16 v55, v27, v27, v55
    s_waitcnt vmcnt(3)
    v_dot2_f32_bf16 v56, v28, v6, v56
    v_dot2_f32_bf16 v57, v28, v28, v57
    v_dot2_f32_bf16 v56, v29, v6, v56
    v_dot2_f32_bf16 v57, v29, v29, v57
    v_dot2_f32_bf16 v56, v30, v6, v56
    v_dot2_f32_bf16 v57, v30, v30, v57
    v_dot2_f32_bf16 v56, v31, v6, v56
    v_dot2_f32_bf16 v57, v31, v31, v57
    s_waitcnt vmcnt(2)
    v_dot2_f32_bf16 v58, v32, v6, v58
    v_dot2_f32_bf16 v59, v32, v32, v59
    v_dot2_f32_bf16 v58, v33, v6, v58
    v_dot2_f32_bf16 v59, v33, v33, v59
    v_dot2_f32_bf16 v58, v34, v6, v58
    v_dot2_f32_bf16 v59, v34, v34, v59
    v_dot2_f32_bf16 v58, v35, v6, v58
    v_dot2_f32_bf16 v59, v35, v35, v59
    s_waitcnt vmcnt(1)
    v_dot2_f32_bf16 v60, v36, v6, v60
    v_dot2_f32_bf16 v61, v36, v36, v61
    v_dot2_f32_bf16 v60, v37, v6, v60
    v_dot2_f32_bf16 v61, v37, v37, v61
    v_dot2_f32_bf16 v60, v38, v6, v60
    v_dot2_f32_bf16 v61, v38, v38, v61
    v_dot2_f32_bf16 v60, v39, v6, v60
    v_dot2_f32_bf16 v61, v39, v39, v61
    s_waitcnt vmcnt(0)
    v_dot2_f32_bf16 v62, v40, v6, v62
    v_dot2_f32_bf16 v63, v40, v40, v63
    v_dot2_f32_bf16 v62, v41, v6, v62
    v_dot2_f32_bf16 v63, v41, v41, v63
    v_dot2_f32_bf16 v62, v42, v6, v62
    v_dot2_f32_bf16 v63, v42, v42, v63
    v_dot2_f32_bf16 v62, v43, v6, v62
    v_dot2_f32_bf16 v63, v43, v43, v63
    v_add_f32_dpp v48, v48, v48 quad_perm:[1,0,3,2] row_mask:0xf bank_mask:0xf
    v_add_f32_dpp v49, v49, v49 quad_perm:[1,0,3,2] row_mask:0xf bank_mask:0xf
    v_add_f32_dpp v50, v50, v50 quad_perm:[1,0,3,2] row_mask:0xf bank_mask:0xf
    v_add_f32_dpp v51, v51, v51 quad_perm:[1,0,3,2] row_mask:0xf bank_mask:0xf
    v_add_f32_dpp v52, v52, v52 quad_perm:[1,0,3,2] row_mask:0xf bank_mask:0xf
    v_add_f32_dpp v53, v53, v53 quad_perm:[1,0,3,2] row_mask:0xf bank_mask:0xf
    v_add_f32_dpp v54, v54, v54 quad_perm:[1,0,3,2] row_mask:0xf bank_mask:0xf
    v_add_f32_dpp v55, v55, v55 quad_perm:[1,0,3,2] row_mask:0xf bank_mask:0xf
    v_add_f32_dpp v56, v56, v56 quad_perm:[1,0,3,2] row_mask:0xf bank_mask:0xf
    v_add_f32_dpp v57, v57, v57 quad_perm:[1,0,3,2] row_mask:0xf bank_mask:0xf
    v_add_f32_dpp v58, v58, v58 quad_perm:[1,0,3,2] row_mask:0xf bank_mask:0xf
    v_add_f32_dpp v59, v59, v59 quad_perm:[1,0,3,2] row_mask:0xf bank_mask:0xf
    v_add_f32_dpp v60, v60, v60 quad_perm:[1,0,3,2] row_mask:0xf bank_mask:0xf
    v_add_f32_dpp v61, v61, v61 quad_perm:[1,0,3,2] row_mask:0xf bank_mask:0xf
    v_add_f32_dpp v62, v62, v62 quad_perm:[1,0,3,2] row_mask:0xf bank_mask:0xf
    v_add_f32_dpp v63, v63, v63 quad_perm:[1,0,3,2] row_mask:0xf bank_mask:0xf
    v_add_f32_dpp v48, v48, v48 quad_perm:[2,3,0,1] row_mask:0xf bank_mask:0xf
    v_add_f32_dpp v49, v49, v49 quad_perm:[2,3,0,1] row_mask:0xf bank_mask:0xf
    v_add_f32_dpp v50, v50, v50 quad_perm:[2,3,0,1] row_mask:0xf bank_mask:0xf
    v_add_f32_dpp v51, v51, v51 quad_perm:[2,3,0,1] row_mask:0xf bank_mask:0xf
    v_add_f32_dpp v52, v52, v52 quad_perm:[2,3,0,1] row_mask:0xf bank_mask:0xf
    v_add_f32_dpp v53, v53, v53 quad_perm:[2,3,0,1] row_mask:0xf bank_mask:0xf
    v_add_f32_dpp v54, v54, v54 quad_perm:[2,3,0,1] row_mask:0xf bank_mask:0xf
    v_add_f32_dpp v55, v55, v55 quad_perm:[2,3,0,1] row_mask:0xf bank_mask:0xf
    v_add_f32_dpp v56, v56, v56 quad_perm:[2,3,0,1] row_mask:0xf bank_mask:0xf
    v_add_f32_dpp v57, v57, v57 quad_perm:[2,3,0,1] row_mask:0xf bank_mask:0xf
    v_add_f32_dpp v58, v58, v58 quad_perm:[2,3,0,1] row_mask:0xf bank_mask:0xf
    v_add_f32_dpp v59, v59, v59 quad_perm:[2,3,0,1] row_mask:0xf bank_mask:0xf
    v_add_f32_dpp v60, v60, v60 quad_perm:[2,3,0,1] row_mask:0xf bank_mask:0xf
    v_add_f32_dpp v61, v61, v61 quad_perm:[2,3,0,1] row_mask:0xf bank_mask:0xf
    v_add_f32_dpp v62, v62, v62 quad_perm:[2,3,0,1] row_mask:0xf bank_mask:0xf
    v_add_f32_dpp v63, v63, v63 quad_perm:[2,3,0,1] row_mask:0xf bank_mask:0xf
    v_add_f32_dpp v48, v48, v48 row_half_mirror row_mask:0xf bank_mask:0xf
    v_add_f32_dpp v49, v49, v49 row_half_mirror row_mask:0xf bank_mask:0xf
    v_add_f32_dpp v50, v50, v50 row_half_mirror row_mask:0xf bank_mask:0xf
    v_add_f32_dpp v51, v51, v51 row_half_mirror row_mask:0xf bank_mask:0xf
    v_add_f32_dpp v52, v52, v52 row_half_mirror row_mask:0xf bank_mask:0xf
    v_add_f32_dpp v53, v53, v53 row_half_mirror row_mask:0xf bank_mask:0xf
    v_add_f32_dpp v54, v54, v54 row_half_mirror row_mask:0xf bank_mask:0xf
    v_add_f32_dpp v55, v55, v55 row_half_mirror row_mask:0xf bank_mask:0xf
    v_add_f32_dpp v56, v56, v56 row_half_mirror row_mask:0xf bank_mask:0xf
    v_add_f32_dpp v57, v57, v57 row_half_mirror row_mask:0xf bank_mask:0xf
    v_add_f32_dpp v58, v58, v58 row_half_mirror row_mask:0xf bank_mask:0xf
    v_add_f32_dpp v59, v59, v59 row_half_mirror row_mask:0xf bank_mask:0xf
    v_add_f32_dpp v60, v60, v60 row_half_mirror row_mask:0xf bank_mask:0xf
    v_add_f32_dpp v61, v61, v61 row_half_mirror row_mask:0xf bank_mask:0xf
    v_add_f32_dpp v62, v62, v62 row_half_mirror row_mask:0xf bank_mask:0xf
    v_add_f32_dpp v63, v63, v63 row_half_mirror row_mask:0xf bank_mask:0xf
    v_add_f32_dpp v48, v48, v48 row_mirror row_mask:0xf bank_mask:0xf
    v_add_f32_dpp v49, v49, v49 row_mirror row_mask:0xf bank_mask:0xf
    v_add_f32_dpp v50, v50, v50 row_mirror row_mask:0xf bank_mask:0xf
    v_add_f32_dpp v51, v51, v51 row_mirror row_mask:0xf bank_mask:0xf
    v_add_f32_dpp v52, v52, v52 row_mirror row_mask:0xf bank_mask:0xf
    v_add_f32_dpp v53, v53, v53 row_mirror row_mask:0xf bank_mask:0xf
    v_add_f32_dpp v54, v54, v54 row_mirror row_mask:0xf bank_mask:0xf
    v_add_f32_dpp v55, v55, v55 row_mirror row_mask:0xf bank_mask:0xf
    v_add_f32_dpp v56, v56, v56 row_mirror row_mask:0xf bank_mask:0xf
    v_add_f32_dpp v57, v57, v57 row_mirror row_mask:0xf bank_mask:0xf
    v_add_f32_dpp v58, v58, v58 row_mirror row_mask:0xf bank_mask:0xf
    v_add_f32_dpp v59, v59, v59 row_mirror row_mask:0xf bank_mask:0xf
    v_add_f32_dpp v60, v60, v60 row_mirror row_mask:0xf bank_mask:0xf
    v_add_f32_dpp v61, v61, v61 row_mirror row_mask:0xf bank_mask:0xf
    v_add_f32_dpp v62, v62, v62 row_mirror row_mask:0xf bank_mask:0xf
    v_add_f32_dpp v63, v63, v63 row_mirror row_mask:0xf bank_mask:0xf
    v_add_f32_dpp v48, v48, v48 row_bcast:15 row_mask:0xa bank_mask:0xf
    v_add_f32_dpp v49, v49, v49 row_bcast:15 row_mask:0xa bank_mask:0xf
    v_add_f32_dpp v50, v50, v50 row_bcast:15 row_mask:0xa bank_mask:0xf
    v_add_f32_dpp v51, v51, v51 row_bcast:15 row_mask:0xa bank_mask:0xf
    v_add_f32_dpp v52, v52, v52 row_bcast:15 row_mask:0xa bank_mask:0xf
    v_add_f32_dpp v53, v53, v53 row_bcast:15 row_mask:0xa bank_mask:0xf
    v_add_f32_dpp v54, v54, v54 row_bcast:15 row_mask:0xa bank_mask:0xf
    v_add_f32_dpp v55, v55, v55 row_bcast:15 row_mask:0xa bank_mask:0xf
    v_add_f32_dpp v56, v56, v56 row_bcast:15 row_mask:0xa bank_mask:0xf
    v_add_f32_dpp v57, v57, v57 row_bcast:15 row_mask:0xa bank_mask:0xf
    v_add_f32_dpp v58, v58, v58 row_bcast:15 row_mask:0xa bank_mask:0xf
    v_add_f32_dpp v59, v59, v59 row_bcast:15 row_mask:0xa bank_mask:0xf
    v_add_f32_dpp v60, v60, v60 row_bcast:15 row_mask:0xa bank_mask:0xf
    v_add_f32_dpp v61, v61, v61 row_bcast:15 row_mask:0xa bank_mask:0xf
    v_add_f32_dpp v62, v62, v62 row_bcast:15 row_mask:0xa bank_mask:0xf
    v_add_f32_dpp v63, v63, v63 row_bcast:15 row_mask:0xa bank_mask:0xf
    v_add_f32_dpp v48, v48, v48 row_bcast:31 row_mask:0xc bank_mask:0xf
    v_add_f32_dpp v49, v49, v49 row_bcast:31 row_mask:0xc bank_mask:0xf
    v_add_f32_dpp v50, v50, v50 row_bcast:31 row_mask:0xc bank_mask:0xf
    v_add_f32_dpp v51, v51, v51 row_bcast:31 row_mask:0xc bank_mask:0xf
    v_add_f32_dpp v52, v52, v52 row_bcast:31 row_mask:0xc bank_mask:0xf
    v_add_f32_dpp v53, v53, v53 row_bcast:31 row_mask:0xc bank_mask:0xf
    v_add_f32_dpp v54, v54, v54 row_bcast:31 row_mask:0xc bank_mask:0xf
    v_add_f32_dpp v55, v55, v55 row_bcast:31 row_mask:0xc bank_mask:0xf
    v_add_f32_dpp v56, v56, v56 row_bcast:31 row_mask:0xc bank_mask:0xf
    v_add_f32_dpp v57, v57, v57 row_bcast:31 row_mask:0xc bank_mask:0xf
    v_add_f32_dpp v58, v58, v58 row_bcast:31 row_mask:0xc bank_mask:0xf
    v_add_f32_dpp v59, v59, v59 row_bcast:31 row_mask:0xc bank_mask:0xf
    v_add_f32_dpp v60, v60, v60 row_bcast:31 row_mask:0xc bank_mask:0xf
    v_add_f32_dpp v61, v61, v61 row_bcast:31 row_mask:0xc bank_mask:0xf
    v_add_f32_dpp v62, v62, v62 row_bcast:31 row_mask:0xc bank_mask:0xf
    v_add_f32_dpp v63, v63, v63 row_bcast:31 row_mask:0xc bank_mask:0xf
    v_readlane_b32 s48, v48, 63
    v_readlane_b32 s49, v49, 63
    v_readlane_b32 s50, v50, 63
    v_readlane_b32 s51, v51, 63
    v_readlane_b32 s52, v52, 63
    v_readlane_b32 s53, v53, 63
    v_readlane_b32 s54, v54, 63
    v_readlane_b32 s55, v55, 63
    v_readlane_b32 s56, v56, 63
    v_readlane_b32 s57, v57, 63
    v_readlane_b32 s58, v58, 63
    v_readlane_b32 s59, v59, 63
    v_readlane_b32 s60, v60, 63
    v_readlane_b32 s61, v61, 63
    v_readlane_b32 s62, v62, 63
    v_readlane_b32 s63, v63, 63
    v_mov_b32 v8, 0
    v_mov_b32 v9, 0
    v_writelane_b32 v8, s48, 0
    v_writelane_b32 v9, s49, 0
    v_writelane_b32 v8, s50, 1
    v_writelane_b32 v9, s51, 1
    v_writelane_b32 v8, s52, 2
    v_writelane_b32 v9, s53, 2
    v_writelane_b32 v8, s54, 3
    v_writelane_b32 v9, s55, 3
    v_writelane_b32 v8, s56, 4
    v_writelane_b32 v9, s57, 4
    v_writelane_b32 v8, s58, 5
    v_writelane_b32 v9, s59, 5
    v_writelane_b32 v8, s60, 6
    v_writelane_b32 v9, s61, 6
    v_writelane_b32 v8, s62, 7
    v_writelane_b32 v9, s63, 7
    v_mul_f32 v8, 0x3b000000, v8
    v_mul_f32 v9, 0x3b000000, v9
    v_fma_f32 v9, -v8, v8, v9
    v_max_f32 v9, 0, v9
    v_cvt_pk_bf16_f32 v8, v8, v8
    v_lshlrev_b32 v8, 16, v8
    v_cvt_pk_bf16_f32 v9, v9, v9
    v_lshlrev_b32 v9, 16, v9
    v_add_f32 v9, 0x3727c5ac, v9
    v_cvt_pk_bf16_f32 v9, v9, v9
    v_lshlrev_b32 v9, 16, v9
    v_sqrt_f32 v9, v9
    s_nop 0
    v_cvt_pk_bf16_f32 v9, v9, v9
    v_lshlrev_b32 v9, 16, v9
    v_rcp_f32 v10, v9
    s_nop 0
    v_mul_f32 v11, v8, v10
    v_sub_f32 v11, 0, v11
    v_lshlrev_b32 v5, 3, v2
    s_lshl_b32 s43, s42, 6
    s_add_u32 s43, s43, 0x10000
    s_mov_b64 exec, 0xff
    buffer_store_dwordx2 v[10:11], v5, s[4:7], s43 offen
    s_endpgm
K1_END:
    s_endpgm

.section .rodata,"a"
.p2align 6
.amdhsa_kernel k1_prep_kernel
  .amdhsa_next_free_vgpr 125
  .amdhsa_next_free_sgpr 64
  .amdhsa_accum_offset 128
  .amdhsa_group_segment_fixed_size 0
  .amdhsa_kernarg_size 112
  .amdhsa_user_sgpr_count 2
  .amdhsa_user_sgpr_kernarg_segment_ptr 1
  .amdhsa_system_sgpr_workgroup_id_x 1
.end_amdhsa_kernel
.text
.globl kf_main_kernel
.p2align 8
.type kf_main_kernel,@function
kf_main_kernel:
    s_cmp_ge_u32 s2, 256
    s_cbranch_scc1 KF_END
    s_load_dwordx2 s[40:41], s[0:1], 104
    s_load_dwordx2 s[16:17], s[0:1], 0
    s_load_dwordx2 s[18:19], s[0:1], 88
    s_load_dwordx4 s[44:47], s[0:1], 48
    v_lshrrev_b32 v1, 6, v0
    v_and_b32 v2, 63, v0
    v_readfirstlane_b32 s3, v1
    v_lshlrev_b32 v3, 4, v2
    s_cmp_lg_u32 s3, 7
    s_cbranch_scc1 KF_NOPF
    s_getpc_b64 s[34:35]
KF_PC:
    s_lshr_b32 s25, s2, 3
    s_min_u32 s25, s25, ((KF_HOT_END-KF_PC)>>10)
    s_lshl_b32 s25, s25, 10
    s_and_b32 s34, s34, 0xffffffc0
    v_add_u32 v1, s25, v3
    global_load_dwordx4 v[252:255], v1, s[34:35]
KF_NOPF:
    s_and_b32 s57, s2, 7
    s_lshl_b32 s57, s57, 5
    s_lshr_b32 s25, s2, 3
    s_add_u32 s57, s57, s25
    s_and_b32 s20, s57, 7
    s_lshr_b32 s21, s57, 3
    s_and_b32 s22, s57, 15
    s_lshr_b32 s23, s57, 4
    s_lshl_b32 s24, s23, 2
    s_and_b32 s25, s21, 1
    s_add_u32 s24, s24, s25
    s_lshr_b32 s29, s57, 2
    s_and_b32 s30, s57, 3
    s_lshl_b32 s28, s57, 3
    s_add_u32 s28, s28, s3
    s_lshl_b32 s28, s28, 10
    s_add_u32 s28, s28, 0xa00000
    s_lshl_b32 s32, s29, 3
    s_add_u32 s32, s32, s3
    s_lshl_b32 s33, s32, 5
    s_lshl_b32 s32, s32, 12
    s_lshl_b32 s37, s30, 3
    s_add_u32 s37, s37, s3
    s_lshl_b32 s37, s37, 14
    s_add_u32 s37, s37, 0x80000
    s_lshl_b32 s38, s3, 12
    s_lshr_b32 s25, s30, 1
    s_lshl_b32 s25, s25, 8
    s_add_u32 s38, s38, s25
    s_add_u32 s38, s38, 0x8000
    v_lshrrev_b32 v10, 4, v2
    v_and_b32 v11, 15, v2
    v_lshlrev_b32 v1, 4, v11
    v_lshl_add_u32 v1, v10, 9, v1
    s_bfe_u32 s39, s57, 0x20001
    s_lshl_b32 s39, s39, 3
    s_add_u32 s39, s39, s3
    s_lshl_b32 s48, s39, 6
    v_lshlrev_b32 v4, 5, v2
    s_waitcnt lgkmcnt(0)
    s_mov_b32 s4, s40
    s_mov_b32 s5, s41
    s_mov_b32 s6, 0x10000000
    s_mov_b32 s7, 0x00020000
    s_mov_b32 s8, s16
    s_mov_b32 s9, s17
    s_mov_b32 s10, 2097152
    s_mov_b32 s11, 0x00020000
    s_bitcmp0_b32 s57, 0
    s_cselect_b32 s12, s44, s46
    s_cselect_b32 s13, s45, s47
    buffer_load_dwordx4 v[12:15], v3, s[8:11], s32 offen offset:0
    buffer_load_dwordx4 v[16:19], v3, s[8:11], s32 offen offset:1024
    buffer_load_dwordx4 v[20:23], v3, s[8:11], s32 offen offset:2048
    buffer_load_dwordx4 v[24:27], v3, s[8:11], s32 offen offset:3072
    s_add_u32 s34, s40, s33
    s_addc_u32 s35, s41, 0
    s_load_dwordx8 s[92:99], s[34:35], 65536
    buffer_load_dwordx4 v[28:31], v4, s[4:7], 0 offen offset:0
    buffer_load_dwordx4 v[32:35], v4, s[4:7], 0 offen offset:16
    buffer_load_dwordx4 v[36:39], v4, s[4:7], 0 offen offset:2048
    buffer_load_dwordx4 v[40:43], v4, s[4:7], 0 offen offset:2064
    buffer_load_dwordx4 v[164:167], v1, s[4:7], s38 offen
    buffer_load_dwordx4 v[168:171], v1, s[4:7], s38 offen offset:2048
    s_barrier
    buffer_load_dwordx4 v[100:103], v3, s[4:7], s37 offen offset:0
    buffer_load_dwordx4 v[104:107], v3, s[4:7], s37 offen offset:1024
    buffer_load_dwordx4 v[108:111], v3, s[4:7], s37 offen offset:2048
    buffer_load_dwordx4 v[112:115], v3, s[4:7], s37 offen offset:3072
    s_add_u32 s34, s40, s48
    s_addc_u32 s35, s41, 0
    s_load_dwordx16 s[60:75], s[34:35], 8192
    s_load_dwordx16 s[76:91], s[34:35], 6144
    s_cmp_lt_u32 s57, 224
    s_cselect_b32 s14, 1835008, 0
    s_mov_b32 s15, 0x00020000
    s_mul_i32 s48, s39, 57344
    s_lshl_b32 s25, s21, 7
    s_add_u32 s48, s48, s25
    v_lshrrev_b32 v6, 1, v2
    v_mul_u32_u24 v6, 1056, v6
    v_and_b32 v7, 1, v2
    v_mul_u32_u24 v7, 528, v7
    s_lshl_b32 s25, s3, 6
    v_add3_u32 v6, v6, v7, s25
    v_lshrrev_b32 v7, 5, v2
    v_mul_u32_u24 v7, 528, v7
    v_and_b32 v8, 31, v2
    v_lshl_add_u32 v7, v8, 4, v7
    v_mov_b32 v0, 141312
    v_mov_b32 v8, 0
    v_mov_b32 v9, 0
    ds_write_b64 v0, v[8:9]
    ds_write_b64 v0, v[8:9] offset:8
    ds_write_b64 v0, v[8:9] offset:16
    ds_write_b64 v0, v[8:9] offset:24
    ds_write_b64 v0, v[8:9] offset:32
    ds_write_b64 v0, v[8:9] offset:40
    ds_write_b64 v0, v[8:9] offset:48
    ds_write_b64 v0, v[8:9] offset:56
    s_lshl_b32 s55, s23, 9
    s_add_u32 s55, s55, 0x48000
    s_lshl_b32 s26, s20, 16
    s_lshr_b32 s25, s3, 1
    s_lshl_b32 s25, s25, 13
    s_add_u32 s26, s26, s25
    s_add_u32 s26, s26, 0x100000
    s_mul_i32 s27, s22, 7
    s_min_u32 s25, s3, 6
    s_add_u32 s27, s27, s25
    s_lshl_b32 s31, s27, 10
    s_mul_i32 s27, s27, 33792
    s_add_u32 s27, s27, 0x400000
    s_mul_i32 s25, s23, 458752
    s_add_u32 s31, s31, s25
    s_add_u32 s31, s31, 0x1000000
    s_waitcnt lgkmcnt(0)
    s_waitcnt vmcnt(6)
    v_lshlrev_b32 v44, 16, v12
    v_and_b32 v45, 0xffff0000, v12
    v_lshlrev_b32 v46, 16, v13
    v_and_b32 v47, 0xffff0000, v13
    v_lshlrev_b32 v48, 16, v14
    v_and_b32 v49, 0xffff0000, v14
    v_lshlrev_b32 v50, 16, v15
    v_and_b32 v51, 0xffff0000, v15
    v_pk_fma_f32 v[44:45], v[44:45], s[92:93], s[92:93] op_sel:[0,0,1] op_sel_hi:[1,0,1]
    v_pk_fma_f32 v[46:47], v[46:47], s[92:93], s[92:93] op_sel:[0,0,1] op_sel_hi:[1,0,1]
    v_pk_fma_f32 v[48:49], v[48:49], s[92:93], s[92:93] op_sel:[0,0,1] op_sel_hi:[1,0,1]
    v_pk_fma_f32 v[50:51], v[50:51], s[92:93], s[92:93] op_sel:[0,0,1] op_sel_hi:[1,0,1]
    v_pk_fma_f32 v[44:45], v[44:45], v[36:37], v[28:29]
    v_pk_fma_f32 v[46:47], v[46:47], v[38:39], v[30:31]
    v_pk_fma_f32 v[48:49], v[48:49], v[40:41], v[32:33]
    v_pk_fma_f32 v[50:51], v[50:51], v[42:43], v[34:35]
    v_cvt_pk_bf16_f32 v12, v44, v45
    v_cvt_pk_bf16_f32 v13, v46, v47
    v_cvt_pk_bf16_f32 v14, v48, v49
    v_cvt_pk_bf16_f32 v15, v50, v51
    ds_write_b128 v6, v[12:15] offset:0
    v_lshlrev_b32 v44, 16, v16
    v_and_b32 v45, 0xffff0000, v16
    v_lshlrev_b32 v46, 16, v17
    v_and_b32 v47, 0xffff0000, v17
    v_lshlrev_b32 v48, 16, v18
    v_and_b32 v49, 0xffff0000, v18
    v_lshlrev_b32 v50, 16, v19
    v_and_b32 v51, 0xffff0000, v19
    v_pk_fma_f32 v[44:45], v[44:45], s[94:95], s[94:95] op_sel:[0,0,1] op_sel_hi:[1,0,1]
    v_pk_fma_f32 v[46:47], v[46:47], s[94:95], s[94:95] op_sel:[0,0,1] op_sel_hi:[1,0,1]
    v_pk_fma_f32 v[48:49], v[48:49], s[94:95], s[94:95] op_sel:[0,0,1] op_sel_hi:[1,0,1]
    v_pk_fma_f32 v[50:51], v[50:51], s[94:95], s[94:95] op_sel:[0,0,1] op_sel_hi:[1,0,1]
    v_pk_fma_f32 v[44:45], v[44:45], v[36:37], v[28:29]
    v_pk_fma_f32 v[46:47], v[46:47], v[38:39], v[30:31]
    v_pk_fma_f32 v[48:49], v[48:49], v[40:41], v[32:33]
    v_pk_fma_f32 v[50:51], v[50:51], v[42:43], v[34:35]
    v_cvt_pk_bf16_f32 v16, v44, v45
    v_cvt_pk_bf16_f32 v17, v46, v47
    v_cvt_pk_bf16_f32 v18, v48, v49
    v_cvt_pk_bf16_f32 v19, v50, v51
    ds_write_b128 v6, v[16:19] offset:16
    v_lshlrev_b32 v44, 16, v20
    v_and_b32 v45, 0xffff0000, v20
    v_lshlrev_b32 v46, 16, v21
    v_and_b32 v47, 0xffff0000, v21
    v_lshlrev_b32 v48, 16, v22
    v_and_b32 v49, 0xffff0000, v22
    v_lshlrev_b32 v50, 16, v23
    v_and_b32 v51, 0xffff0000, v23
    v_pk_fma_f32 v[44:45], v[44:45], s[96:97], s[96:97] op_sel:[0,0,1] op_sel_hi:[1,0,1]
    v_pk_fma_f32 v[46:47], v[46:47], s[96:97], s[96:97] op_sel:[0,0,1] op_sel_hi:[1,0,1]
    v_pk_fma_f32 v[48:49], v[48:49], s[96:97], s[96:97] op_sel:[0,0,1] op_sel_hi:[1,0,1]
    v_pk_fma_f32 v[50:51], v[50:51], s[96:97], s[96:97] op_sel:[0,0,1] op_sel_hi:[1,0,1]
    v_pk_fma_f32 v[44:45], v[44:45], v[36:37], v[28:29]
    v_pk_fma_f32 v[46:47], v[46:47], v[38:39], v[30:31]
    v_pk_fma_f32 v[48:49], v[48:49], v[40:41], v[32:33]
    v_pk_fma_f32 v[50:51], v[50:51], v[42:43], v[34:35]
    v_cvt_pk_bf16_f32 v20, v44, v45
    v_cvt_pk_bf16_f32 v21, v46, v47
    v_cvt_pk_bf16_f32 v22, v48, v49
    v_cvt_pk_bf16_f32 v23, v50, v51
    ds_write_b128 v6, v[20:23] offset:32
    v_lshlrev_b32 v44, 16, v24
    v_and_b32 v45, 0xffff0000, v24
    v_lshlrev_b32 v46, 16, v25
    v_and_b32 v47, 0xffff0000, v25
    v_lshlrev_b32 v48, 16, v26
    v_and_b32 v49, 0xffff0000, v26
    v_lshlrev_b32 v50, 16, v27
    v_and_b32 v51, 0xffff0000, v27
    v_pk_fma_f32 v[44:45], v[44:45], s[98:99], s[98:99] op_sel:[0,0,1] op_sel_hi:[1,0,1]
    v_pk_fma_f32 v[46:47], v[46:47], s[98:99], s[98:99] op_sel:[0,0,1] op_sel_hi:[1,0,1]
    v_pk_fma_f32 v[48:49], v[48:49], s[98:99], s[98:99] op_sel:[0,0,1] op_sel_hi:[1,0,1]
    v_pk_fma_f32 v[50:51], v[50:51], s[98:99], s[98:99] op_sel:[0,0,1] op_sel_hi:[1,0,1]
    v_pk_fma_f32 v[44:45], v[44:45], v[36:37], v[28:29]
    v_pk_fma_f32 v[46:47], v[46:47], v[38:39], v[30:31]
    v_pk_fma_f32 v[48:49], v[48:49], v[40:41], v[32:33]
    v_pk_fma_f32 v[50:51], v[50:51], v[42:43], v[34:35]
    v_cvt_pk_bf16_f32 v24, v44, v45
    v_cvt_pk_bf16_f32 v25, v46, v47
    v_cvt_pk_bf16_f32 v26, v48, v49
    v_cvt_pk_bf16_f32 v27, v50, v51
    ds_write_b128 v6, v[24:27] offset:48
    v_lshrrev_b32 v8, 1, v10
    v_mul_u32_u24 v8, 1056, v8
    v_and_b32 v9, 1, v10
    v_mul_u32_u24 v9, 528, v9
    v_lshl_add_u32 v9, v11, 4, v9
    s_mul_i32 s25, s3, 4224
    s_and_b32 s32, s30, 1
    s_lshl_b32 s33, s32, 8
    s_add_u32 s25, s25, s33
    v_add3_u32 v8, v8, v9, s25
    s_and_b32 s25, s3, 1
    s_mul_i32 s25, s25, 16896
    v_add_u32 v9, s25, v7
    s_add_u32 s37, s37, 4096
    buffer_load_dwordx4 v[116:119], v3, s[4:7], s37 offen offset:0
    buffer_load_dwordx4 v[120:123], v3, s[4:7], s37 offen offset:1024
    buffer_load_dwordx4 v[124:127], v3, s[4:7], s37 offen offset:2048
    buffer_load_dwordx4 v[128:131], v3, s[4:7], s37 offen offset:3072
    s_add_u32 s47, s37, 4096
    buffer_load_dwordx4 v[132:135], v3, s[4:7], s47 offen offset:0
    buffer_load_dwordx4 v[136:139], v3, s[4:7], s47 offen offset:1024
    s_lshl_b32 s25, s3, 10
    s_add_u32 s25, s25, 36864
    v_add_u32 v6, s25, v3
    s_waitcnt lgkmcnt(0)
    s_barrier
    ds_read_b128 v[52:55], v8
    ds_read_b128 v[56:59], v8 offset:2112
    s_waitcnt vmcnt(10)
    s_cmp_ge_u32 s30, 2
    s_cbranch_scc1 KF_VCH
    s_waitcnt lgkmcnt(1)
    v_mfma_f32_16x16x32_bf16 v[196:199], v[164:167], v[52:55], 0
    s_waitcnt lgkmcnt(0)
    v_mfma_f32_16x16x32_bf16 v[196:199], v[168:171], v[56:59], v[196:199]
    s_branch KF_KVW
KF_VCH:
    s_waitcnt lgkmcnt(1)
    v_mfma_f32_16x16x32_bf16 v[196:199], v[52:55], v[164:167], 0
    s_waitcnt lgkmcnt(0)
    v_mfma_f32_16x16x32_bf16 v[196:199], v[56:59], v[168:171], v[196:199]
    s_nop 0
KF_KVW:
    s_nop 7
    ds_write_b128 v6, v[196:199]
    s_add_u32 s37, s37, 6144
    s_waitcnt lgkmcnt(0)
    s_barrier
    s_cmp_lg_u32 s3, 0
    s_cbranch_scc1 KF_NOKV
    ds_read_b128 v[56:59], v6 offset:1024
    ds_read_b128 v[60:63], v6 offset:2048
    ds_read_b128 v[64:67], v6 offset:3072
    ds_read_b128 v[68:71], v6 offset:4096
    ds_read_b128 v[72:75], v6 offset:5120
    ds_read_b128 v[76:79], v6 offset:6144
    ds_read_b128 v[80:83], v6 offset:7168
    v_and_b32 v44, 3, v2
    v_and_b32 v45, 4, v2
    v_lshl_or_b32 v44, v45, 1, v44
    v_and_b32 v45, 8, v2
    v_lshrrev_b32 v45, 1, v45
    v_or_b32 v44, v44, v45
    v_and_b32 v45, 1, v10
    v_lshrrev_b32 v46, 1, v10
    v_lshlrev_b32 v46, 3, v46
    v_lshl_add_u32 v44, v44, 4, v46
    v_lshl_add_u32 v44, v45, 9, v44
    v_lshl_add_u32 v46, v11, 4, v46
    v_lshl_add_u32 v46, v45, 8, v46
    s_lshl_b32 s25, s29, 10
    s_add_u32 s25, s25, 0xe80000
    s_lshl_b32 s32, s32, 9
    s_add_u32 s32, s32, 0x10000
    s_cmp_ge_u32 s30, 2
    s_cselect_b32 s33, s32, s33
    s_cselect_b64 vcc, -1, 0
    s_add_u32 s25, s25, s33
    v_cndmask_b32 v44, v44, v46, vcc
    s_waitcnt lgkmcnt(6)
    v_add_f32 v196, v196, v56
    v_add_f32 v197, v197, v57
    v_add_f32 v198, v198, v58
    v_add_f32 v199, v199, v59
    s_waitcnt lgkmcnt(5)
    v_add_f32 v196, v196, v60
    v_add_f32 v197, v197, v61
    v_add_f32 v198, v198, v62
    v_add_f32 v199, v199, v63
    s_waitcnt lgkmcnt(4)
    v_add_f32 v196, v196, v64
    v_add_f32 v197, v197, v65
    v_add_f32 v198, v198, v66
    v_add_f32 v199, v199, v67
    s_waitcnt lgkmcnt(3)
    v_add_f32 v196, v196, v68
    v_add_f32 v197, v197, v69
    v_add_f32 v198, v198, v70
    v_add_f32 v199, v199, v71
    s_waitcnt lgkmcnt(2)
    v_add_f32 v196, v196, v72
    v_add_f32 v197, v197, v73
    v_add_f32 v198, v198, v74
    v_add_f32 v199, v199, v75
    s_waitcnt lgkmcnt(1)
    v_add_f32 v196, v196, v76
    v_add_f32 v197, v197, v77
    v_add_f32 v198, v198, v78
    v_add_f32 v199, v199, v79
    s_waitcnt lgkmcnt(0)
    v_add_f32 v196, v196, v80
    v_add_f32 v197, v197, v81
    v_add_f32 v198, v198, v82
    v_add_f32 v199, v199, v83
    v_cvt_pk_bf16_f32 v48, v196, v197
    v_cvt_pk_bf16_f32 v49, v198, v199
    buffer_store_dwordx2 v[48:49], v44, s[4:7], s25 offen sc1
KF_NOKV:
    buffer_load_dwordx4 v[140:143], v3, s[4:7], s37 offen offset:0
    buffer_load_dwordx4 v[144:147], v3, s[4:7], s37 offen offset:1024
    buffer_load_dwordx4 v[148:151], v3, s[4:7], s37 offen offset:2048
    buffer_load_dwordx4 v[152:155], v3, s[4:7], s37 offen offset:3072
    s_add_u32 s47, s37, 4096
    buffer_load_dwordx4 v[156:159], v3, s[4:7], s47 offen offset:0
    buffer_load_dwordx4 v[160:163], v3, s[4:7], s47 offen offset:1024
    s_lshl_b32 s33, s3, 10
    s_add_u32 s37, s33, 0xe80000
    s_add_u32 s38, s37, 0x10000
    v_add_u32 v1, s33, v3
    ds_read_b128 v[52:55], v9 offset:0
    ds_read_b128 v[56:59], v9 offset:1056
    ds_read_b128 v[60:63], v9 offset:2112
    ds_read_b128 v[64:67], v9 offset:3168
    ds_read_b128 v[68:71], v9 offset:4224
    ds_read_b128 v[72:75], v9 offset:5280
    ds_read_b128 v[76:79], v9 offset:6336
    ds_read_b128 v[80:83], v9 offset:7392
    s_waitcnt vmcnt(15) lgkmcnt(7)
    v_mfma_f32_32x32x16_bf16 v[84:99], v[100:103], v[52:55], 0
    ds_read_b128 v[52:55], v9 offset:8448
    s_waitcnt vmcnt(14) lgkmcnt(7)
    v_mfma_f32_32x32x16_bf16 v[84:99], v[104:107], v[56:59], v[84:99]
    ds_read_b128 v[56:59], v9 offset:9504
    s_waitcnt vmcnt(13) lgkmcnt(7)
    v_mfma_f32_32x32x16_bf16 v[84:99], v[108:111], v[60:63], v[84:99]
    ds_read_b128 v[60:63], v9 offset:10560
    s_waitcnt vmcnt(12) lgkmcnt(7)
    v_mfma_f32_32x32x16_bf16 v[84:99], v[112:115], v[64:67], v[84:99]
    ds_read_b128 v[64:67], v9 offset:11616
    s_waitcnt vmcnt(11) lgkmcnt(7)
    v_mfma_f32_32x32x16_bf16 v[84:99], v[116:119], v[68:71], v[84:99]
    ds_read_b128 v[68:71], v9 offset:12672
    s_waitcnt vmcnt(10) lgkmcnt(7)
    v_mfma_f32_32x32x16_bf16 v[84:99], v[120:123], v[72:75], v[84:99]
    ds_read_b128 v[72:75], v9 offset:13728
    s_waitcnt vmcnt(9) lgkmcnt(7)
    v_mfma_f32_32x32x16_bf16 v[84:99], v[124:127], v[76:79], v[84:99]
    ds_read_b128 v[76:79], v9 offset:14784
    s_waitcnt vmcnt(8) lgkmcnt(7)
    v_mfma_f32_32x32x16_bf16 v[84:99], v[128:131], v[80:83], v[84:99]
    ds_read_b128 v[80:83], v9 offset:15840
    s_waitcnt vmcnt(7) lgkmcnt(7)
    v_mfma_f32_32x32x16_bf16 v[84:99], v[132:135], v[52:55], v[84:99]
    s_waitcnt vmcnt(6) lgkmcnt(6)
    v_mfma_f32_32x32x16_bf16 v[84:99], v[136:139], v[56:59], v[84:99]
    s_waitcnt vmcnt(5) lgkmcnt(5)
    v_mfma_f32_32x32x16_bf16 v[84:99], v[140:143], v[60:63], v[84:99]
    s_waitcnt vmcnt(4) lgkmcnt(4)
    v_mfma_f32_32x32x16_bf16 v[84:99], v[144:147], v[64:67], v[84:99]
    s_waitcnt vmcnt(3) lgkmcnt(3)
    v_mfma_f32_32x32x16_bf16 v[84:99], v[148:151], v[68:71], v[84:99]
    s_waitcnt vmcnt(2) lgkmcnt(2)
    v_mfma_f32_32x32x16_bf16 v[84:99], v[152:155], v[72:75], v[84:99]
    s_waitcnt vmcnt(1) lgkmcnt(1)
    v_mfma_f32_32x32x16_bf16 v[84:99], v[156:159], v[76:79], v[84:99]
    s_waitcnt vmcnt(0) lgkmcnt(0)
    v_mfma_f32_32x32x16_bf16 v[84:99], v[160:163], v[80:83], v[84:99]
    s_lshl_b32 s25, s3, 11
    s_add_u32 s25, s25, 143360
    v_add_u32 v10, s25, v3
    s_xor_b32 s25, s25, 0x800
    v_add_u32 v11, s25, v3
    s_bitcmp1_b32 s3, 0
    s_cbranch_scc1 KF_QODD
    s_nop 4
    ds_write_b128 v10, v[92:95]
    ds_write_b128 v10, v[96:99] offset:1024
    v_mov_b32 v12, v84
    v_mov_b32 v13, v85
    v_mov_b32 v14, v86
    v_mov_b32 v15, v87
    v_mov_b32 v16, v88
    v_mov_b32 v17, v89
    v_mov_b32 v18, v90
    v_mov_b32 v19, v91
    s_branch KF_QW
KF_QODD:
    s_nop 4
    ds_write_b128 v10, v[84:87]
    ds_write_b128 v10, v[88:91] offset:1024
    v_mov_b32 v12, v92
    v_mov_b32 v13, v93
    v_mov_b32 v14, v94
    v_mov_b32 v15, v95
    v_mov_b32 v16, v96
    v_mov_b32 v17, v97
    v_mov_b32 v18, v98
    v_mov_b32 v19, v99
KF_QW:
    s_waitcnt lgkmcnt(0)
    s_barrier
    ds_read_b128 v[52:55], v11
    ds_read_b128 v[56:59], v11 offset:1024
    s_add_u32 s25, s37, 0
    s_add_u32 s32, s38, 0
    buffer_load_dwordx4 v[172:175], v3, s[4:7], s25 offen sc1
    buffer_load_dwordx4 v[176:179], v3, s[4:7], s32 offen sc1
    s_add_u32 s25, s37, 8192
    s_add_u32 s32, s38, 8192
    buffer_load_dwordx4 v[180:183], v3, s[4:7], s25 offen sc1
    buffer_load_dwordx4 v[184:187], v3, s[4:7], s32 offen sc1
    s_add_u32 s25, s37, 16384
    s_add_u32 s32, s38, 16384
    buffer_load_dwordx4 v[116:119], v3, s[4:7], s25 offen sc1
    buffer_load_dwordx4 v[120:123], v3, s[4:7], s32 offen sc1
    s_add_u32 s25, s37, 24576
    s_add_u32 s32, s38, 24576
    buffer_load_dwordx4 v[124:127], v3, s[4:7], s25 offen sc1
    buffer_load_dwordx4 v[128:131], v3, s[4:7], s32 offen sc1
    s_mov_b32 s25, 0x3eb8aa3b
    v_mov_b32 v8, 0xdddddddd
    v_and_b32 v11, 15, v2
    v_lshlrev_b32 v11, 4, v11
    v_lshrrev_b32 v10, 5, v2
    v_lshl_add_u32 v10, v10, 8, v11
    v_add_u32 v10, 0x10000, v10
    s_mov_b32 s50, 0x0000ffff
    s_mov_b32 s51, 0x0000ffff
    v_and_b32 v11, 27, v2
    v_cmp_eq_u32 vcc, 16, v11
    v_mov_b32 v11, 0x3f803f80
    s_nop 0
    v_cndmask_b32 v11, 0, v11, vcc
    v_add_u32 v9, 0x10000, v1
    s_waitcnt lgkmcnt(0)
    v_add_f32 v84, v12, v52
    v_add_f32 v85, v13, v53
    v_add_f32 v86, v14, v54
    v_add_f32 v87, v15, v55
    v_add_f32 v88, v16, v56
    v_add_f32 v89, v17, v57
    v_add_f32 v90, v18, v58
    v_add_f32 v91, v19, v59
    v_mul_f32 v84, s25, v84
    v_mul_f32 v85, s25, v85
    v_mul_f32 v86, s25, v86
    v_mul_f32 v87, s25, v87
    v_mul_f32 v88, s25, v88
    v_mul_f32 v89, s25, v89
    v_mul_f32 v90, s25, v90
    v_mul_f32 v91, s25, v91
    v_cvt_pk_bf16_f32 v4, v84, v85
    v_cvt_pk_bf16_f32 v5, v86, v87
    v_cvt_pk_bf16_f32 v6, v88, v89
    v_cvt_pk_bf16_f32 v7, v90, v91
    v_mov_b32 v20, v11
    v_mov_b32 v21, v11
    v_mov_b32 v22, v11
    v_mov_b32 v23, v11
    v_mov_b32 v24, v11
    v_mov_b32 v25, v11
    v_mov_b32 v26, v11
    v_mov_b32 v27, v11
    v_mov_b32 v28, v11
    v_mov_b32 v29, v11
    v_mov_b32 v30, v11
    v_mov_b32 v31, v11
    v_mov_b32 v32, v11
    v_mov_b32 v33, v11
    v_mov_b32 v34, v11
    v_mov_b32 v35, v11
    v_mov_b32 v52, 0
    v_mov_b32 v53, 0
    v_mov_b32 v54, 0
    v_mov_b32 v55, 0
    v_mov_b32 v56, 0
    v_mov_b32 v57, 0
    v_mov_b32 v58, 0
    v_mov_b32 v59, 0
    v_mov_b32 v60, 0
    v_mov_b32 v61, 0
    v_mov_b32 v62, 0
    v_mov_b32 v63, 0
    v_mov_b32 v64, 0
    v_mov_b32 v65, 0
    v_mov_b32 v66, 0
    v_mov_b32 v67, 0
    s_mov_b32 s41, 65536
    s_waitcnt vmcnt(6)
    s_mov_b32 s36, 0
KF_CK1:
    v_max3_u32 v11, v172, v173, v174
    v_max3_u32 v11, v11, v175, v176
    v_max3_u32 v11, v11, v177, v178
    v_max_u32 v11, v11, v179
    v_cmp_eq_u32 s[34:35], -1, v11
    s_nop 0
    s_cmp_lg_u64 s[34:35], 0
    s_cbranch_scc1 KF_CK1_R
KF_CK1_C:
    ds_write_b128 v1, v[172:175] offset:0
    ds_write_b128 v9, v[176:179] offset:0
    v_mfma_f32_32x32x16_bf16 v[84:99], v[172:175], v[4:7], 0
    s_waitcnt vmcnt(4)
    s_mov_b32 s36, 0
KF_CK2:
    v_max3_u32 v11, v180, v181, v182
    v_max3_u32 v11, v11, v183, v184
    v_max3_u32 v11, v11, v185, v186
    v_max_u32 v11, v11, v187
    v_cmp_eq_u32 s[34:35], -1, v11
    s_nop 0
    s_cmp_lg_u64 s[34:35], 0
    s_cbranch_scc1 KF_CK2_R
KF_CK2_C:
    ds_write_b128 v1, v[180:183] offset:8192
    ds_write_b128 v9, v[184:187] offset:8192
    v_max3_f32 v84, v84, v85, v86
    v_max3_f32 v84, v84, v87, v88
    v_max3_f32 v84, v84, v89, v90
    v_max3_f32 v84, v84, v91, v92
    v_max3_f32 v84, v84, v93, v94
    v_max3_f32 v84, v84, v95, v96
    v_max3_f32 v84, v84, v97, v98
    v_max_f32 v84, v84, v99
    v_mov_b32 v11, v84
    s_nop 1
    v_permlane32_swap_b32 v11, v84
    v_max_f32 v84, v11, v84
    v_sub_f32 v36, 0, v84
    v_sub_f32 v37, 0, v84
    v_sub_f32 v38, 0, v84
    v_sub_f32 v39, 0, v84
    v_sub_f32 v40, 0, v84
    v_sub_f32 v41, 0, v84
    v_sub_f32 v42, 0, v84
    v_sub_f32 v43, 0, v84
    v_sub_f32 v44, 0, v84
    v_sub_f32 v45, 0, v84
    v_sub_f32 v46, 0, v84
    v_sub_f32 v47, 0, v84
    v_sub_f32 v48, 0, v84
    v_sub_f32 v49, 0, v84
    v_sub_f32 v50, 0, v84
    v_sub_f32 v51, 0, v84
    s_cmp_lt_u32 s3, 4
    s_cselect_b64 vcc, -1, 0
    s_waitcnt lgkmcnt(0)
    s_barrier
    ds_read_b128 v[12:15], v3 offset:0
    ds_read_b128 v[16:19], v3 offset:1024
    s_mov_b64 exec, s[50:51]
    ds_read_b128 v[20:23], v10 offset:0
    ds_read_b128 v[24:27], v10 offset:512
    s_mov_b64 exec, -1
    s_waitcnt lgkmcnt(3)
    v_mfma_f32_32x32x16_bf16 v[68:83], v[12:15], v[4:7], v[36:51]
    v_mov_b32 v240, -1
    v_mov_b32 v241, -1
    v_mov_b32 v242, -1
    v_mov_b32 v243, -1
    v_mov_b32 v244, 1
    s_nop 6
    s_cbranch_vccnz KF_PR3
    s_setprio 1
KF_PR3:
    v_lshlrev_b32 v239, 1, v2
    buffer_load_ushort v212, v239, s[12:15], s48 offen offset:0
    buffer_load_ushort v213, v239, s[12:15], s48 offen offset:3584
    s_add_u32 s48, s48, 7168
    v_exp_f32 v68, v68
    v_exp_f32 v69, v69
    ds_read_b128 v[12:15], v3 offset:2048
    v_exp_f32 v70, v70
    s_mov_b64 exec, s[50:51]
    ds_read_b128 v[28:31], v10 offset:1024
    ds_read_b128 v[32:35], v10 offset:1536
    s_mov_b64 exec, -1
    v_exp_f32 v71, v71
    v_exp_f32 v72, v72
    s_waitcnt lgkmcnt(3)
    v_mfma_f32_32x32x16_bf16 v[84:99], v[16:19], v[4:7], v[36:51]
    v_exp_f32 v73, v73
    v_exp_f32 v74, v74
    v_exp_f32 v75, v75
    v_exp_f32 v76, v76
    v_exp_f32 v77, v77
    v_smfmac_f32_32x32x32_bf16 v[52:67], v[20:23], v[68:75], v8
    v_exp_f32 v78, v78
    v_exp_f32 v79, v79
    v_exp_f32 v80, v80
    v_exp_f32 v81, v81
    v_exp_f32 v82, v82
    v_exp_f32 v83, v83
    buffer_load_ushort v214, v239, s[12:15], s48 offen offset:0
    buffer_load_ushort v215, v239, s[12:15], s48 offen offset:3584
    s_add_u32 s48, s48, 7168
    v_exp_f32 v84, v84
    v_exp_f32 v85, v85
    v_smfmac_f32_32x32x32_bf16 v[52:67], v[24:27], v[76:83], v8
    ds_read_b128 v[16:19], v3 offset:3072
    v_exp_f32 v86, v86
    s_mov_b64 exec, s[50:51]
    ds_read_b128 v[20:23], v10 offset:2048
    ds_read_b128 v[24:27], v10 offset:2560
    s_mov_b64 exec, -1
    v_exp_f32 v87, v87
    v_exp_f32 v88, v88
    s_waitcnt lgkmcnt(3)
    v_mfma_f32_32x32x16_bf16 v[68:83], v[12:15], v[4:7], v[36:51]
    v_exp_f32 v89, v89
    v_exp_f32 v90, v90
    v_exp_f32 v91, v91
    v_exp_f32 v92, v92
    v_exp_f32 v93, v93
    v_smfmac_f32_32x32x32_bf16 v[52:67], v[28:31], v[84:91], v8
    v_exp_f32 v94, v94
    v_exp_f32 v95, v95
    v_exp_f32 v96, v96
    v_exp_f32 v97, v97
    v_exp_f32 v98, v98
    v_exp_f32 v99, v99
    buffer_load_ushort v216, v239, s[12:15], s48 offen offset:0
    buffer_load_ushort v217, v239, s[12:15], s48 offen offset:3584
    s_add_u32 s48, s48, 7168
    v_exp_f32 v68, v68
    v_exp_f32 v69, v69
    v_smfmac_f32_32x32x32_bf16 v[52:67], v[32:35], v[92:99], v8
    ds_read_b128 v[12:15], v3 offset:4096
    v_exp_f32 v70, v70
    s_mov_b64 exec, s[50:51]
    ds_read_b128 v[28:31], v10 offset:3072
    ds_read_b128 v[32:35], v10 offset:3584
    s_mov_b64 exec, -1
    v_exp_f32 v71, v71
    v_exp_f32 v72, v72
    s_waitcnt lgkmcnt(3)
    v_mfma_f32_32x32x16_bf16 v[84:99], v[16:19], v[4:7], v[36:51]
    v_exp_f32 v73, v73
    v_exp_f32 v74, v74
    v_exp_f32 v75, v75
    v_exp_f32 v76, v76
    v_exp_f32 v77, v77
    v_smfmac_f32_32x32x32_bf16 v[52:67], v[20:23], v[68:75], v8
    v_exp_f32 v78, v78
    v_exp_f32 v79, v79
    s_cbranch_vccnz KF_PR4
    s_setprio 0
KF_PR4:
    v_exp_f32 v80, v80
    v_exp_f32 v81, v81
    v_exp_f32 v82, v82
    v_exp_f32 v83, v83
    buffer_load_ushort v218, v239, s[12:15], s48 offen offset:0
    buffer_load_ushort v219, v239, s[12:15], s48 offen offset:3584
    s_add_u32 s48, s48, 7168
    s_waitcnt vmcnt(10)
    s_mov_b32 s36, 0
KF_CK5:
    v_max3_u32 v11, v116, v117, v118
    v_max3_u32 v11, v11, v119, v120
    v_max3_u32 v11, v11, v121, v122
    v_max_u32 v11, v11, v123
    v_cmp_eq_u32 s[34:35], -1, v11
    s_nop 0
    s_cmp_lg_u64 s[34:35], 0
    s_cbranch_scc1 KF_CK5_R
KF_CK5_C:
    ds_write_b128 v1, v[116:119] offset:16384
    ds_write_b128 v9, v[120:123] offset:16384
    v_exp_f32 v84, v84
    v_exp_f32 v85, v85
    v_smfmac_f32_32x32x32_bf16 v[52:67], v[24:27], v[76:83], v8
    ds_read_b128 v[16:19], v3 offset:5120
    v_exp_f32 v86, v86
    s_mov_b64 exec, s[50:51]
    ds_read_b128 v[20:23], v10 offset:4096
    ds_read_b128 v[24:27], v10 offset:4608
    s_mov_b64 exec, -1
    v_exp_f32 v87, v87
    v_exp_f32 v88, v88
    s_waitcnt lgkmcnt(3)
    v_mfma_f32_32x32x16_bf16 v[68:83], v[12:15], v[4:7], v[36:51]
    v_exp_f32 v89, v89
    v_exp_f32 v90, v90
    v_exp_f32 v91, v91
    v_exp_f32 v92, v92
    v_exp_f32 v93, v93
    v_smfmac_f32_32x32x32_bf16 v[52:67], v[28:31], v[84:91], v8
    v_exp_f32 v94, v94
    v_exp_f32 v95, v95
    v_exp_f32 v96, v96
    v_exp_f32 v97, v97
    v_exp_f32 v98, v98
    v_exp_f32 v99, v99
    s_cbranch_vccnz KF_PR6
    s_setprio 1
KF_PR6:
    buffer_load_ushort v220, v239, s[12:15], s48 offen offset:0
    buffer_load_ushort v221, v239, s[12:15], s48 offen offset:3584
    s_add_u32 s48, s48, 7168
    v_exp_f32 v68, v68
    v_exp_f32 v69, v69
    v_smfmac_f32_32x32x32_bf16 v[52:67], v[32:35], v[92:99], v8
    ds_read_b128 v[12:15], v3 offset:6144
    v_exp_f32 v70, v70
    s_mov_b64 exec, s[50:51]
    ds_read_b128 v[28:31], v10 offset:5120
    ds_read_b128 v[32:35], v10 offset:5632
    s_mov_b64 exec, -1
    v_exp_f32 v71, v71
    v_exp_f32 v72, v72
    s_waitcnt lgkmcnt(3)
    v_mfma_f32_32x32x16_bf16 v[84:99], v[16:19], v[4:7], v[36:51]
    v_exp_f32 v73, v73
    v_exp_f32 v74, v74
    v_exp_f32 v75, v75
    v_exp_f32 v76, v76
    v_exp_f32 v77, v77
    v_smfmac_f32_32x32x32_bf16 v[52:67], v[20:23], v[68:75], v8
    v_exp_f32 v78, v78
    v_exp_f32 v79, v79
    v_exp_f32 v80, v80
    v_exp_f32 v81, v81
    v_exp_f32 v82, v82
    v_exp_f32 v83, v83
    buffer_load_ushort v222, v239, s[12:15], s48 offen offset:0
    buffer_load_ushort v223, v239, s[12:15], s48 offen offset:3584
    s_add_u32 s48, s48, 7168
    s_waitcnt vmcnt(12)
    s_mov_b32 s36, 0
KF_CK7:
    v_max3_u32 v11, v124, v125, v126
    v_max3_u32 v11, v11, v127, v128
    v_max3_u32 v11, v11, v129, v130
    v_max_u32 v11, v11, v131
    v_cmp_eq_u32 s[34:35], -1, v11
    s_nop 0
    s_cmp_lg_u64 s[34:35], 0
    s_cbranch_scc1 KF_CK7_R
KF_CK7_C:
    ds_write_b128 v1, v[124:127] offset:24576
    ds_write_b128 v9, v[128:131] offset:24576
    v_exp_f32 v84, v84
    v_exp_f32 v85, v85
    v_smfmac_f32_32x32x32_bf16 v[52:67], v[24:27], v[76:83], v8
    ds_read_b128 v[16:19], v3 offset:7168
    v_exp_f32 v86, v86
    s_mov_b64 exec, s[50:51]
    ds_read_b128 v[20:23], v10 offset:6144
    ds_read_b128 v[24:27], v10 offset:6656
    s_mov_b64 exec, -1
    v_exp_f32 v87, v87
    v_exp_f32 v88, v88
    s_waitcnt lgkmcnt(3)
    v_mfma_f32_32x32x16_bf16 v[68:83], v[12:15], v[4:7], v[36:51]
    v_exp_f32 v89, v89
    v_exp_f32 v90, v90
    v_exp_f32 v91, v91
    v_exp_f32 v92, v92
    v_exp_f32 v93, v93
    v_smfmac_f32_32x32x32_bf16 v[52:67], v[28:31], v[84:91], v8
    v_exp_f32 v94, v94
    v_exp_f32 v95, v95
    v_exp_f32 v96, v96
    v_exp_f32 v97, v97
    v_exp_f32 v98, v98
    v_exp_f32 v99, v99
    buffer_load_ushort v224, v239, s[12:15], s48 offen offset:0
    buffer_load_ushort v225, v239, s[12:15], s48 offen offset:3584
    s_add_u32 s48, s48, 7168
    s_mov_b64 exec, 1
    ds_add_u32 v0, v244 offset:48
    s_mov_b64 exec, -1
    v_exp_f32 v68, v68
    v_exp_f32 v69, v69
    v_smfmac_f32_32x32x32_bf16 v[52:67], v[32:35], v[92:99], v8
    ds_read_b128 v[12:15], v3 offset:8192
    v_exp_f32 v70, v70
    s_mov_b64 exec, s[50:51]
    ds_read_b128 v[28:31], v10 offset:7168
    ds_read_b128 v[32:35], v10 offset:7680
    s_mov_b64 exec, -1
    v_exp_f32 v71, v71
    v_exp_f32 v72, v72
    s_waitcnt lgkmcnt(3)
    v_mfma_f32_32x32x16_bf16 v[84:99], v[16:19], v[4:7], v[36:51]
    v_exp_f32 v73, v73
    v_exp_f32 v74, v74
    v_exp_f32 v75, v75
    v_exp_f32 v76, v76
    v_exp_f32 v77, v77
    v_smfmac_f32_32x32x32_bf16 v[52:67], v[20:23], v[68:75], v8
    v_exp_f32 v78, v78
    v_exp_f32 v79, v79
    s_cbranch_vccnz KF_PR8
    s_setprio 0
KF_PR8:
    v_exp_f32 v80, v80
    v_exp_f32 v81, v81
    v_exp_f32 v82, v82
    v_exp_f32 v83, v83
    buffer_load_ushort v226, v239, s[12:15], s48 offen offset:0
    buffer_load_ushort v227, v239, s[12:15], s48 offen offset:3584
    s_add_u32 s48, s48, 7168
    s_mov_b32 s12, s18
    s_mov_b32 s13, s19
    s_mov_b32 s14, 2097152
    s_mov_b32 s15, 0x00020000
    v_exp_f32 v84, v84
    v_exp_f32 v85, v85
    v_smfmac_f32_32x32x32_bf16 v[52:67], v[24:27], v[76:83], v8
    ds_read_b128 v[16:19], v3 offset:9216
    v_exp_f32 v86, v86
    s_mov_b64 exec, s[50:51]
    ds_read_b128 v[20:23], v10 offset:8192
    ds_read_b128 v[24:27], v10 offset:8704
    s_mov_b64 exec, -1
    v_exp_f32 v87, v87
    v_exp_f32 v88, v88
    s_waitcnt lgkmcnt(3)
    v_mfma_f32_32x32x16_bf16 v[68:83], v[12:15], v[4:7], v[36:51]
    v_exp_f32 v89, v89
    v_exp_f32 v90, v90
    v_exp_f32 v91, v91
    v_exp_f32 v92, v92
    v_exp_f32 v93, v93
    v_smfmac_f32_32x32x32_bf16 v[52:67], v[28:31], v[84:91], v8
    v_exp_f32 v94, v94
    v_exp_f32 v95, v95
    v_exp_f32 v96, v96
    v_exp_f32 v97, v97
    v_exp_f32 v98, v98
    v_exp_f32 v99, v99
    s_cbranch_vccnz KF_PR9
    s_setprio 1
KF_PR9:
    s_add_u32 s25, s37, 32768
    s_add_u32 s32, s38, 32768
    buffer_load_dwordx4 v[164:167], v3, s[4:7], s25 offen sc1
    buffer_load_dwordx4 v[168:171], v3, s[4:7], s32 offen sc1
    v_exp_f32 v68, v68
    v_exp_f32 v69, v69
    v_smfmac_f32_32x32x32_bf16 v[52:67], v[32:35], v[92:99], v8
    ds_read_b128 v[12:15], v3 offset:10240
    v_exp_f32 v70, v70
    s_mov_b64 exec, s[50:51]
    ds_read_b128 v[28:31], v10 offset:9216
    ds_read_b128 v[32:35], v10 offset:9728
    s_mov_b64 exec, -1
    v_exp_f32 v71, v71
    v_exp_f32 v72, v72
    s_waitcnt lgkmcnt(3)
    v_mfma_f32_32x32x16_bf16 v[84:99], v[16:19], v[4:7], v[36:51]
    v_exp_f32 v73, v73
    v_exp_f32 v74, v74
    v_exp_f32 v75, v75
    v_exp_f32 v76, v76
    v_exp_f32 v77, v77
    v_smfmac_f32_32x32x32_bf16 v[52:67], v[20:23], v[68:75], v8
    v_exp_f32 v78, v78
    v_exp_f32 v79, v79
    v_exp_f32 v80, v80
    v_exp_f32 v81, v81
    v_exp_f32 v82, v82
    v_exp_f32 v83, v83
    s_add_u32 s25, s37, 40960
    s_add_u32 s32, s38, 40960
    buffer_load_dwordx4 v[172:175], v3, s[4:7], s25 offen sc1
    buffer_load_dwordx4 v[176:179], v3, s[4:7], s32 offen sc1
    v_exp_f32 v84, v84
    v_exp_f32 v85, v85
    v_smfmac_f32_32x32x32_bf16 v[52:67], v[24:27], v[76:83], v8
    ds_read_b128 v[16:19], v3 offset:11264
    v_exp_f32 v86, v86
    s_mov_b64 exec, s[50:51]
    ds_read_b128 v[20:23], v10 offset:10240
    ds_read_b128 v[24:27], v10 offset:10752
    s_mov_b64 exec, -1
    v_exp_f32 v87, v87
    v_exp_f32 v88, v88
    s_waitcnt lgkmcnt(3)
    v_mfma_f32_32x32x16_bf16 v[68:83], v[12:15], v[4:7], v[36:51]
    v_exp_f32 v89, v89
    v_exp_f32 v90, v90
    v_exp_f32 v91, v91
    v_exp_f32 v92, v92
    v_exp_f32 v93, v93
    v_smfmac_f32_32x32x32_bf16 v[52:67], v[28:31], v[84:91], v8
    v_exp_f32 v94, v94
    v_exp_f32 v95, v95
    v_exp_f32 v96, v96
    v_exp_f32 v97, v97
    v_exp_f32 v98, v98
    v_exp_f32 v99, v99
    s_add_u32 s25, s37, 49152
    s_add_u32 s32, s38, 49152
    buffer_load_dwordx4 v[180:183], v3, s[4:7], s25 offen sc1
    buffer_load_dwordx4 v[184:187], v3, s[4:7], s32 offen sc1
    v_exp_f32 v68, v68
    v_exp_f32 v69, v69
    v_smfmac_f32_32x32x32_bf16 v[52:67], v[32:35], v[92:99], v8
    ds_read_b128 v[12:15], v3 offset:12288
    v_exp_f32 v70, v70
    s_mov_b64 exec, s[50:51]
    ds_read_b128 v[28:31], v10 offset:11264
    ds_read_b128 v[32:35], v10 offset:11776
    s_mov_b64 exec, -1
    v_exp_f32 v71, v71
    v_exp_f32 v72, v72
    s_waitcnt lgkmcnt(3)
    v_mfma_f32_32x32x16_bf16 v[84:99], v[16:19], v[4:7], v[36:51]
    v_exp_f32 v73, v73
    v_exp_f32 v74, v74
    v_exp_f32 v75, v75
    v_exp_f32 v76, v76
    v_exp_f32 v77, v77
    v_smfmac_f32_32x32x32_bf16 v[52:67], v[20:23], v[68:75], v8
    v_exp_f32 v78, v78
    v_exp_f32 v79, v79
    s_cbranch_vccnz KF_PR10
    s_setprio 0
KF_PR10:
    v_exp_f32 v80, v80
    v_exp_f32 v81, v81
    v_exp_f32 v82, v82
    v_exp_f32 v83, v83
    s_add_u32 s25, s37, 57344
    s_add_u32 s32, s38, 57344
    buffer_load_dwordx4 v[188:191], v3, s[4:7], s25 offen sc1
    buffer_load_dwordx4 v[192:195], v3, s[4:7], s32 offen sc1
    v_exp_f32 v84, v84
    v_exp_f32 v85, v85
    v_smfmac_f32_32x32x32_bf16 v[52:67], v[24:27], v[76:83], v8
    ds_read_b128 v[16:19], v3 offset:13312
    v_exp_f32 v86, v86
    s_mov_b64 exec, s[50:51]
    ds_read_b128 v[20:23], v10 offset:12288
    ds_read_b128 v[24:27], v10 offset:12800
    s_mov_b64 exec, -1
    v_exp_f32 v87, v87
    v_exp_f32 v88, v88
    s_waitcnt lgkmcnt(3)
    v_mfma_f32_32x32x16_bf16 v[68:83], v[12:15], v[4:7], v[36:51]
    v_exp_f32 v89, v89
    v_exp_f32 v90, v90
    v_exp_f32 v91, v91
    v_exp_f32 v92, v92
    v_exp_f32 v93, v93
    v_smfmac_f32_32x32x32_bf16 v[52:67], v[28:31], v[84:91], v8
    v_exp_f32 v94, v94
    v_exp_f32 v95, v95
    v_exp_f32 v96, v96
    v_exp_f32 v97, v97
    v_exp_f32 v98, v98
    v_exp_f32 v99, v99
    s_cbranch_vccnz KF_PR11
    s_setprio 1
KF_PR11:
    v_exp_f32 v68, v68
    v_exp_f32 v69, v69
    v_smfmac_f32_32x32x32_bf16 v[52:67], v[32:35], v[92:99], v8
    ds_read_b128 v[12:15], v3 offset:14336
    v_exp_f32 v70, v70
    s_mov_b64 exec, s[50:51]
    ds_read_b128 v[28:31], v10 offset:13312
    ds_read_b128 v[32:35], v10 offset:13824
    s_mov_b64 exec, -1
    v_exp_f32 v71, v71
    v_exp_f32 v72, v72
    s_waitcnt lgkmcnt(3)
    v_mfma_f32_32x32x16_bf16 v[84:99], v[16:19], v[4:7], v[36:51]
    v_exp_f32 v73, v73
    v_exp_f32 v74, v74
    v_exp_f32 v75, v75
    v_exp_f32 v76, v76
    v_exp_f32 v77, v77
    v_smfmac_f32_32x32x32_bf16 v[52:67], v[20:23], v[68:75], v8
    v_exp_f32 v78, v78
    v_exp_f32 v79, v79
    v_exp_f32 v80, v80
    v_exp_f32 v81, v81
    v_exp_f32 v82, v82
    v_exp_f32 v83, v83
    v_and_b32 v238, 3, v2
    v_and_b32 v11, 4, v2
    v_lshl_or_b32 v238, v11, 1, v238
    v_and_b32 v11, 8, v2
    v_lshrrev_b32 v11, 1, v11
    v_or_b32 v238, v238, v11
    s_and_b32 s25, s57, 1
    s_lshl_b32 s25, s25, 4
    v_add_u32 v238, s25, v238
    v_lshlrev_b32 v238, 4, v238
    v_lshrrev_b32 v11, 4, v2
    v_mul_u32_u24 v11, 33792, v11
    v_add_u32 v238, v238, v11
    s_mul_i32 s48, s21, 135168
    s_add_u32 s48, s48, 0x400000
    s_cmp_ge_u32 s57, 224
    s_cselect_b32 s48, 0x10000000, s48
    s_lshl_b32 s46, s39, 10
    s_add_u32 s46, s46, s48
    s_mov_b32 s33, 0x3f803f80
    v_mov_b32 v236, 0
    v_mov_b32 v237, 0
    s_lshl_b32 s25, s3, 9
    v_lshlrev_b32 v246, 3, v2
    v_add_u32 v246, 159744, v246
    v_add_u32 v239, s25, v246
    s_mov_b32 s36, 0
KF_SP12_L:
    ds_read_b32 v11, v0 offset:48
    s_add_u32 s36, s36, 1
    s_waitcnt lgkmcnt(0)
    v_readfirstlane_b32 s35, v11
    s_nop 0
    s_cmp_ge_u32 s35, 8
    s_cbranch_scc1 KF_SP12_D
    s_sleep 4
    s_cmp_lt_u32 s36, 524288
    s_cbranch_scc1 KF_SP12_L
KF_SP12_D:
    v_exp_f32 v84, v84
    v_exp_f32 v85, v85
    v_smfmac_f32_32x32x32_bf16 v[52:67], v[24:27], v[76:83], v8
    ds_read_b128 v[16:19], v3 offset:15360
    v_exp_f32 v86, v86
    s_mov_b64 exec, s[50:51]
    ds_read_b128 v[20:23], v10 offset:14336
    ds_read_b128 v[24:27], v10 offset:14848
    s_mov_b64 exec, -1
    v_exp_f32 v87, v87
    v_exp_f32 v88, v88
    s_waitcnt lgkmcnt(3)
    v_mfma_f32_32x32x16_bf16 v[68:83], v[12:15], v[4:7], v[36:51]
    v_exp_f32 v89, v89
    v_exp_f32 v90, v90
    v_exp_f32 v91, v91
    v_exp_f32 v92, v92
    v_exp_f32 v93, v93
    v_smfmac_f32_32x32x32_bf16 v[52:67], v[28:31], v[84:91], v8
    v_exp_f32 v94, v94
    v_exp_f32 v95, v95
    v_exp_f32 v96, v96
    v_exp_f32 v97, v97
    v_exp_f32 v98, v98
    v_exp_f32 v99, v99
    s_waitcnt vmcnt(8)
    v_lshlrev_b32 v212, 16, v212
    v_fmac_f32 v237, s76, v212
    v_mul_f32 v212, s60, v212
    v_lshlrev_b32 v213, 16, v213
    v_fmac_f32 v237, s77, v213
    v_mul_f32 v213, s61, v213
    v_lshlrev_b32 v214, 16, v214
    v_fmac_f32 v237, s78, v214
    v_mul_f32 v214, s62, v214
    v_lshlrev_b32 v215, 16, v215
    v_fmac_f32 v237, s79, v215
    v_mul_f32 v215, s63, v215
    v_lshlrev_b32 v216, 16, v216
    v_fmac_f32 v237, s80, v216
    v_mul_f32 v216, s64, v216
    v_lshlrev_b32 v217, 16, v217
    v_fmac_f32 v237, s81, v217
    v_mul_f32 v217, s65, v217
    v_lshlrev_b32 v218, 16, v218
    v_fmac_f32 v237, s82, v218
    v_mul_f32 v218, s66, v218
    v_lshlrev_b32 v219, 16, v219
    v_fmac_f32 v237, s83, v219
    v_mul_f32 v219, s67, v219
    v_cvt_pk_bf16_f32 v228, v212, v213
    v_cvt_pk_bf16_f32 v229, v214, v215
    v_cvt_pk_bf16_f32 v230, v216, v217
    v_cvt_pk_bf16_f32 v231, v218, v219
    v_dot2_f32_bf16 v236, v228, s33, v236
    v_dot2_f32_bf16 v236, v229, s33, v236
    v_dot2_f32_bf16 v236, v230, s33, v236
    v_dot2_f32_bf16 v236, v231, s33, v236
    buffer_store_dwordx4 v[228:231], v238, s[4:7], s46 offen offset:0 sc1
    v_exp_f32 v68, v68
    v_exp_f32 v69, v69
    v_smfmac_f32_32x32x32_bf16 v[52:67], v[32:35], v[92:99], v8
    ds_read_b128 v[12:15], v3 offset:16384
    v_exp_f32 v70, v70
    s_mov_b64 exec, s[50:51]
    ds_read_b128 v[28:31], v10 offset:15360
    ds_read_b128 v[32:35], v10 offset:15872
    s_mov_b64 exec, -1
    v_exp_f32 v71, v71
    v_exp_f32 v72, v72
    s_waitcnt lgkmcnt(3)
    v_mfma_f32_32x32x16_bf16 v[84:99], v[16:19], v[4:7], v[36:51]
    v_exp_f32 v73, v73
    v_exp_f32 v74, v74
    v_exp_f32 v75, v75
    v_exp_f32 v76, v76
    v_exp_f32 v77, v77
    v_smfmac_f32_32x32x32_bf16 v[52:67], v[20:23], v[68:75], v8
    v_exp_f32 v78, v78
    v_exp_f32 v79, v79
    s_cbranch_vccnz KF_PR13
    s_setprio 0
KF_PR13:
    v_exp_f32 v80, v80
    v_exp_f32 v81, v81
    v_exp_f32 v82, v82
    v_exp_f32 v83, v83
    v_lshlrev_b32 v220, 16, v220
    v_fmac_f32 v237, s84, v220
    v_mul_f32 v220, s68, v220
    v_lshlrev_b32 v221, 16, v221
    v_fmac_f32 v237, s85, v221
    v_mul_f32 v221, s69, v221
    v_lshlrev_b32 v222, 16, v222
    v_fmac_f32 v237, s86, v222
    v_mul_f32 v222, s70, v222
    v_lshlrev_b32 v223, 16, v223
    v_fmac_f32 v237, s87, v223
    v_mul_f32 v223, s71, v223
    v_lshlrev_b32 v224, 16, v224
    v_fmac_f32 v237, s88, v224
    v_mul_f32 v224, s72, v224
    v_lshlrev_b32 v225, 16, v225
    v_fmac_f32 v237, s89, v225
    v_mul_f32 v225, s73, v225
    v_lshlrev_b32 v226, 16, v226
    v_fmac_f32 v237, s90, v226
    v_mul_f32 v226, s74, v226
    v_lshlrev_b32 v227, 16, v227
    v_fmac_f32 v237, s91, v227
    v_mul_f32 v227, s75, v227
    v_cvt_pk_bf16_f32 v232, v220, v221
    v_cvt_pk_bf16_f32 v233, v222, v223
    v_cvt_pk_bf16_f32 v234, v224, v225
    v_cvt_pk_bf16_f32 v235, v226, v227
    v_dot2_f32_bf16 v236, v232, s33, v236
    v_dot2_f32_bf16 v236, v233, s33, v236
    v_dot2_f32_bf16 v236, v234, s33, v236
    v_dot2_f32_bf16 v236, v235, s33, v236
    buffer_store_dwordx4 v[232:235], v238, s[4:7], s46 offen offset:512 sc1
    s_nop 1
    ds_write_b64 v239, v[236:237]
    v_exp_f32 v84, v84
    v_exp_f32 v85, v85
    v_smfmac_f32_32x32x32_bf16 v[52:67], v[24:27], v[76:83], v8
    ds_read_b128 v[16:19], v3 offset:17408
    v_exp_f32 v86, v86
    s_mov_b64 exec, s[50:51]
    ds_read_b128 v[20:23], v10 offset:16384
    ds_read_b128 v[24:27], v10 offset:16896
    s_mov_b64 exec, -1
    v_exp_f32 v87, v87
    v_exp_f32 v88, v88
    s_waitcnt lgkmcnt(3)
    v_mfma_f32_32x32x16_bf16 v[68:83], v[12:15], v[4:7], v[36:51]
    v_exp_f32 v89, v89
    v_exp_f32 v90, v90
    v_exp_f32 v91, v91
    v_exp_f32 v92, v92
    v_exp_f32 v93, v93
    v_smfmac_f32_32x32x32_bf16 v[52:67], v[28:31], v[84:91], v8
    v_exp_f32 v94, v94
    v_exp_f32 v95, v95
    v_exp_f32 v96, v96
    v_exp_f32 v97, v97
    v_exp_f32 v98, v98
    v_exp_f32 v99, v99
    s_cbranch_vccnz KF_PR14
    s_setprio 1
KF_PR14:
    s_mov_b64 exec, 1
    ds_add_rtn_u32 v11, v0, v244 offset:12
    s_waitcnt lgkmcnt(0)
    v_readfirstlane_b32 s35, v11
    s_mov_b64 exec, -1
    s_cmp_lg_u32 s35, 7
    s_cbranch_scc1 KF_NOUT
    ds_read_b64 v[212:213], v246 offset:0
    ds_read_b64 v[214:215], v246 offset:512
    ds_read_b64 v[216:217], v246 offset:1024
    ds_read_b64 v[218:219], v246 offset:1536
    ds_read_b64 v[220:221], v246 offset:2048
    ds_read_b64 v[222:223], v246 offset:2560
    ds_read_b64 v[224:225], v246 offset:3072
    ds_read_b64 v[226:227], v246 offset:3584
    s_waitcnt lgkmcnt(0)
    v_add_f32 v212, v212, v214
    v_add_f32 v213, v213, v215
    v_add_f32 v212, v212, v216
    v_add_f32 v213, v213, v217
    v_add_f32 v212, v212, v218
    v_add_f32 v213, v213, v219
    v_add_f32 v212, v212, v220
    v_add_f32 v213, v213, v221
    v_add_f32 v212, v212, v222
    v_add_f32 v213, v213, v223
    v_add_f32 v212, v212, v224
    v_add_f32 v213, v213, v225
    v_add_f32 v212, v212, v226
    v_add_f32 v213, v213, v227
    v_cvt_pk_bf16_f32 v214, v212, v212
    v_lshlrev_b32 v214, 16, v214
    v_cvt_pk_bf16_f32 v215, v213, v213
    v_lshlrev_b32 v215, 16, v215
    v_sub_f32 v212, v212, v214
    v_sub_f32 v213, v213, v215
    v_cvt_pk_bf16_f32 v236, v214, v212
    v_cvt_pk_bf16_f32 v237, v215, v213
    s_bfe_u32 s25, s57, 0x10002
    s_lshl_b32 s25, s25, 9
    s_bfe_u32 s32, s57, 0x10001
    s_lshl_b32 s32, s32, 3
    s_add_u32 s25, s25, s32
    s_add_u32 s25, s25, s48
    s_add_u32 s25, s25, 32768
    buffer_store_dwordx2 v[236:237], v238, s[4:7], s25 offen sc1
KF_NOUT:
    s_add_u32 s25, s26, 0
    buffer_load_dwordx4 v[100:103], v3, s[4:7], s25 offen
    v_exp_f32 v68, v68
    v_exp_f32 v69, v69
    v_smfmac_f32_32x32x32_bf16 v[52:67], v[32:35], v[92:99], v8
    ds_read_b128 v[12:15], v3 offset:18432
    v_exp_f32 v70, v70
    s_mov_b64 exec, s[50:51]
    ds_read_b128 v[28:31], v10 offset:17408
    ds_read_b128 v[32:35], v10 offset:17920
    s_mov_b64 exec, -1
    v_exp_f32 v71, v71
    v_exp_f32 v72, v72
    s_waitcnt lgkmcnt(3)
    v_mfma_f32_32x32x16_bf16 v[84:99], v[16:19], v[4:7], v[36:51]
    v_exp_f32 v73, v73
    v_exp_f32 v74, v74
    v_exp_f32 v75, v75
    v_exp_f32 v76, v76
    v_exp_f32 v77, v77
    v_smfmac_f32_32x32x32_bf16 v[52:67], v[20:23], v[68:75], v8
    v_exp_f32 v78, v78
    v_exp_f32 v79, v79
    v_exp_f32 v80, v80
    v_exp_f32 v81, v81
    v_exp_f32 v82, v82
    v_exp_f32 v83, v83
    s_add_u32 s25, s26, 1024
    buffer_load_dwordx4 v[104:107], v3, s[4:7], s25 offen
    v_exp_f32 v84, v84
    v_exp_f32 v85, v85
    v_smfmac_f32_32x32x32_bf16 v[52:67], v[24:27], v[76:83], v8
    ds_read_b128 v[16:19], v3 offset:19456
    v_exp_f32 v86, v86
    s_mov_b64 exec, s[50:51]
    ds_read_b128 v[20:23], v10 offset:18432
    ds_read_b128 v[24:27], v10 offset:18944
    s_mov_b64 exec, -1
    v_exp_f32 v87, v87
    v_exp_f32 v88, v88
    s_waitcnt lgkmcnt(3)
    v_mfma_f32_32x32x16_bf16 v[68:83], v[12:15], v[4:7], v[36:51]
    v_exp_f32 v89, v89
    v_exp_f32 v90, v90
    v_exp_f32 v91, v91
    v_exp_f32 v92, v92
    v_exp_f32 v93, v93
    v_smfmac_f32_32x32x32_bf16 v[52:67], v[28:31], v[84:91], v8
    v_exp_f32 v94, v94
    v_exp_f32 v95, v95
    v_exp_f32 v96, v96
    v_exp_f32 v97, v97
    v_exp_f32 v98, v98
    v_exp_f32 v99, v99
    s_add_u32 s25, s26, 2048
    buffer_load_dwordx4 v[108:111], v3, s[4:7], s25 offen
    v_exp_f32 v68, v68
    v_exp_f32 v69, v69
    v_smfmac_f32_32x32x32_bf16 v[52:67], v[32:35], v[92:99], v8
    ds_read_b128 v[12:15], v3 offset:20480
    v_exp_f32 v70, v70
    s_mov_b64 exec, s[50:51]
    ds_read_b128 v[28:31], v10 offset:19456
    ds_read_b128 v[32:35], v10 offset:19968
    s_mov_b64 exec, -1
    v_exp_f32 v71, v71
    v_exp_f32 v72, v72
    s_waitcnt lgkmcnt(3)
    v_mfma_f32_32x32x16_bf16 v[84:99], v[16:19], v[4:7], v[36:51]
    v_exp_f32 v73, v73
    v_exp_f32 v74, v74
    v_exp_f32 v75, v75
    v_exp_f32 v76, v76
    v_exp_f32 v77, v77
    v_smfmac_f32_32x32x32_bf16 v[52:67], v[20:23], v[68:75], v8
    v_exp_f32 v78, v78
    v_exp_f32 v79, v79
    s_cbranch_vccnz KF_PR15
    s_setprio 0
KF_PR15:
    v_exp_f32 v80, v80
    v_exp_f32 v81, v81
    v_exp_f32 v82, v82
    v_exp_f32 v83, v83
    s_waitcnt vmcnt(11)
    s_mov_b32 s36, 0
KF_CK16:
    v_max3_u32 v11, v164, v165, v166
    v_max3_u32 v11, v11, v167, v168
    v_max3_u32 v11, v11, v169, v170
    v_max_u32 v11, v11, v171
    v_cmp_eq_u32 s[34:35], -1, v11
    s_nop 0
    s_cmp_lg_u64 s[34:35], 0
    s_cbranch_scc1 KF_CK16_R
KF_CK16_C:
    ds_write_b128 v1, v[164:167] offset:32768
    ds_write_b128 v9, v[168:171] offset:32768
    s_add_u32 s25, s26, 3072
    buffer_load_dwordx4 v[112:115], v3, s[4:7], s25 offen
    v_exp_f32 v84, v84
    v_exp_f32 v85, v85
    v_smfmac_f32_32x32x32_bf16 v[52:67], v[24:27], v[76:83], v8
    ds_read_b128 v[16:19], v3 offset:21504
    v_exp_f32 v86, v86
    s_mov_b64 exec, s[50:51]
    ds_read_b128 v[20:23], v10 offset:20480
    ds_read_b128 v[24:27], v10 offset:20992
    s_mov_b64 exec, -1
    v_exp_f32 v87, v87
    v_exp_f32 v88, v88
    s_waitcnt lgkmcnt(3)
    v_mfma_f32_32x32x16_bf16 v[68:83], v[12:15], v[4:7], v[36:51]
    v_exp_f32 v89, v89
    v_exp_f32 v90, v90
    v_exp_f32 v91, v91
    v_exp_f32 v92, v92
    v_exp_f32 v93, v93
    v_smfmac_f32_32x32x32_bf16 v[52:67], v[28:31], v[84:91], v8
    v_exp_f32 v94, v94
    v_exp_f32 v95, v95
    v_exp_f32 v96, v96
    v_exp_f32 v97, v97
    v_exp_f32 v98, v98
    v_exp_f32 v99, v99
    s_cbranch_vccnz KF_PR17
    s_setprio 1
KF_PR17:
    s_add_u32 s25, s26, 4096
    buffer_load_dwordx4 v[116:119], v3, s[4:7], s25 offen
    s_waitcnt vmcnt(5)
    s_mov_b64 exec, 1
    ds_add_rtn_u32 v11, v0, v244
    s_lshl_b32 s25, s57, 7
    s_add_u32 s25, s25, 0x40000
    s_waitcnt lgkmcnt(0)
    v_readfirstlane_b32 s35, v11
    s_mov_b64 exec, 0xffff
    s_cmp_lg_u32 s35, 7
    s_cbranch_scc1 KF_AR18
    v_lshlrev_b32 v11, 2, v2
    buffer_store_dword v244, v11, s[4:7], s25 offen sc1
KF_AR18:
    s_mov_b64 exec, -1
    v_exp_f32 v68, v68
    v_exp_f32 v69, v69
    v_smfmac_f32_32x32x32_bf16 v[52:67], v[32:35], v[92:99], v8
    ds_read_b128 v[12:15], v3 offset:22528
    v_exp_f32 v70, v70
    s_mov_b64 exec, s[50:51]
    ds_read_b128 v[28:31], v10 offset:21504
    ds_read_b128 v[32:35], v10 offset:22016
    s_mov_b64 exec, -1
    v_exp_f32 v71, v71
    v_exp_f32 v72, v72
    s_waitcnt lgkmcnt(3)
    v_mfma_f32_32x32x16_bf16 v[84:99], v[16:19], v[4:7], v[36:51]
    v_exp_f32 v73, v73
    v_exp_f32 v74, v74
    v_exp_f32 v75, v75
    v_exp_f32 v76, v76
    v_exp_f32 v77, v77
    v_smfmac_f32_32x32x32_bf16 v[52:67], v[20:23], v[68:75], v8
    v_exp_f32 v78, v78
    v_exp_f32 v79, v79
    v_exp_f32 v80, v80
    v_exp_f32 v81, v81
    v_exp_f32 v82, v82
    v_exp_f32 v83, v83
    s_waitcnt vmcnt(11)
    s_mov_b32 s36, 0
KF_CK19:
    v_max3_u32 v11, v172, v173, v174
    v_max3_u32 v11, v11, v175, v176
    v_max3_u32 v11, v11, v177, v178
    v_max_u32 v11, v11, v179
    v_cmp_eq_u32 s[34:35], -1, v11
    s_nop 0
    s_cmp_lg_u64 s[34:35], 0
    s_cbranch_scc1 KF_CK19_R
KF_CK19_C:
    ds_write_b128 v1, v[172:175] offset:40960
    ds_write_b128 v9, v[176:179] offset:40960
    s_add_u32 s25, s26, 5120
    buffer_load_dwordx4 v[120:123], v3, s[4:7], s25 offen
    v_exp_f32 v84, v84
    v_exp_f32 v85, v85
    v_smfmac_f32_32x32x32_bf16 v[52:67], v[24:27], v[76:83], v8
    ds_read_b128 v[16:19], v3 offset:23552
    v_exp_f32 v86, v86
    s_mov_b64 exec, s[50:51]
    ds_read_b128 v[20:23], v10 offset:22528
    ds_read_b128 v[24:27], v10 offset:23040
    s_mov_b64 exec, -1
    v_exp_f32 v87, v87
    v_exp_f32 v88, v88
    s_waitcnt lgkmcnt(3)
    v_mfma_f32_32x32x16_bf16 v[68:83], v[12:15], v[4:7], v[36:51]
    v_exp_f32 v89, v89
    v_exp_f32 v90, v90
    v_exp_f32 v91, v91
    v_exp_f32 v92, v92
    v_exp_f32 v93, v93
    v_smfmac_f32_32x32x32_bf16 v[52:67], v[28:31], v[84:91], v8
    v_exp_f32 v94, v94
    v_exp_f32 v95, v95
    v_exp_f32 v96, v96
    v_exp_f32 v97, v97
    v_exp_f32 v98, v98
    v_exp_f32 v99, v99
    s_add_u32 s25, s31, 0
    buffer_store_dwordx4 v[240:243], v3, s[4:7], s25 offen sc1
    s_add_u32 s25, s26, 6144
    buffer_load_dwordx4 v[124:127], v3, s[4:7], s25 offen
    v_exp_f32 v68, v68
    v_exp_f32 v69, v69
    v_smfmac_f32_32x32x32_bf16 v[52:67], v[32:35], v[92:99], v8
    ds_read_b128 v[12:15], v3 offset:24576
    v_exp_f32 v70, v70
    s_mov_b64 exec, s[50:51]
    ds_read_b128 v[28:31], v10 offset:23552
    ds_read_b128 v[32:35], v10 offset:24064
    s_mov_b64 exec, -1
    v_exp_f32 v71, v71
    v_exp_f32 v72, v72
    s_waitcnt lgkmcnt(3)
    v_mfma_f32_32x32x16_bf16 v[84:99], v[16:19], v[4:7], v[36:51]
    v_exp_f32 v73, v73
    v_exp_f32 v74, v74
    v_exp_f32 v75, v75
    v_exp_f32 v76, v76
    v_exp_f32 v77, v77
    v_smfmac_f32_32x32x32_bf16 v[52:67], v[20:23], v[68:75], v8
    v_exp_f32 v78, v78
    v_exp_f32 v79, v79
    s_cbranch_vccnz KF_PR20
    s_setprio 0
KF_PR20:
    v_exp_f32 v80, v80
    v_exp_f32 v81, v81
    v_exp_f32 v82, v82
    v_exp_f32 v83, v83
    s_waitcnt vmcnt(12)
    s_mov_b32 s36, 0
KF_CK21:
    v_max3_u32 v11, v180, v181, v182
    v_max3_u32 v11, v11, v183, v184
    v_max3_u32 v11, v11, v185, v186
    v_max_u32 v11, v11, v187
    v_cmp_eq_u32 s[34:35], -1, v11
    s_nop 0
    s_cmp_lg_u64 s[34:35], 0
    s_cbranch_scc1 KF_CK21_R
KF_CK21_C:
    ds_write_b128 v1, v[180:183] offset:49152
    ds_write_b128 v9, v[184:187] offset:49152
    s_add_u32 s25, s26, 7168
    buffer_load_dwordx4 v[128:131], v3, s[4:7], s25 offen
    v_exp_f32 v84, v84
    v_exp_f32 v85, v85
    v_smfmac_f32_32x32x32_bf16 v[52:67], v[24:27], v[76:83], v8
    ds_read_b128 v[16:19], v3 offset:25600
    v_exp_f32 v86, v86
    s_mov_b64 exec, s[50:51]
    ds_read_b128 v[20:23], v10 offset:24576
    ds_read_b128 v[24:27], v10 offset:25088
    s_mov_b64 exec, -1
    v_exp_f32 v87, v87
    v_exp_f32 v88, v88
    s_waitcnt lgkmcnt(3)
    v_mfma_f32_32x32x16_bf16 v[68:83], v[12:15], v[4:7], v[36:51]
    v_exp_f32 v89, v89
    v_exp_f32 v90, v90
    v_exp_f32 v91, v91
    v_exp_f32 v92, v92
    v_exp_f32 v93, v93
    v_smfmac_f32_32x32x32_bf16 v[52:67], v[28:31], v[84:91], v8
    v_exp_f32 v94, v94
    v_exp_f32 v95, v95
    v_exp_f32 v96, v96
    v_exp_f32 v97, v97
    v_exp_f32 v98, v98
    v_exp_f32 v99, v99
    s_cbranch_vccnz KF_PR22
    s_setprio 1
KF_PR22:
    s_add_u32 s25, s26, 32768
    buffer_load_dwordx4 v[132:135], v3, s[4:7], s25 offen
    v_exp_f32 v68, v68
    v_exp_f32 v69, v69
    v_smfmac_f32_32x32x32_bf16 v[52:67], v[32:35], v[92:99], v8
    ds_read_b128 v[12:15], v3 offset:26624
    v_exp_f32 v70, v70
    s_mov_b64 exec, s[50:51]
    ds_read_b128 v[28:31], v10 offset:25600
    ds_read_b128 v[32:35], v10 offset:26112
    s_mov_b64 exec, -1
    v_exp_f32 v71, v71
    v_exp_f32 v72, v72
    s_waitcnt lgkmcnt(3)
    v_mfma_f32_32x32x16_bf16 v[84:99], v[16:19], v[4:7], v[36:51]
    v_exp_f32 v73, v73
    v_exp_f32 v74, v74
    v_exp_f32 v75, v75
    v_exp_f32 v76, v76
    v_exp_f32 v77, v77
    v_smfmac_f32_32x32x32_bf16 v[52:67], v[20:23], v[68:75], v8
    v_exp_f32 v78, v78
    v_exp_f32 v79, v79
    v_exp_f32 v80, v80
    v_exp_f32 v81, v81
    v_exp_f32 v82, v82
    v_exp_f32 v83, v83
    s_waitcnt vmcnt(12)
    s_mov_b32 s36, 0
KF_CK23:
    v_max3_u32 v11, v188, v189, v190
    v_max3_u32 v11, v11, v191, v192
    v_max3_u32 v11, v11, v193, v194
    v_max_u32 v11, v11, v195
    v_cmp_eq_u32 s[34:35], -1, v11
    s_nop 0
    s_cmp_lg_u64 s[34:35], 0
    s_cbranch_scc1 KF_CK23_R
KF_CK23_C:
    ds_write_b128 v1, v[188:191] offset:57344
    ds_write_b128 v9, v[192:195] offset:57344
    s_add_u32 s25, s26, 33792
    buffer_load_dwordx4 v[136:139], v3, s[4:7], s25 offen
    v_exp_f32 v84, v84
    v_exp_f32 v85, v85
    v_smfmac_f32_32x32x32_bf16 v[52:67], v[24:27], v[76:83], v8
    ds_read_b128 v[16:19], v3 offset:27648
    v_exp_f32 v86, v86
    s_mov_b64 exec, s[50:51]
    ds_read_b128 v[20:23], v10 offset:26624
    ds_read_b128 v[24:27], v10 offset:27136
    s_mov_b64 exec, -1
    v_exp_f32 v87, v87
    v_exp_f32 v88, v88
    s_waitcnt lgkmcnt(3)
    v_mfma_f32_32x32x16_bf16 v[68:83], v[12:15], v[4:7], v[36:51]
    v_exp_f32 v89, v89
    v_exp_f32 v90, v90
    v_exp_f32 v91, v91
    v_exp_f32 v92, v92
    v_exp_f32 v93, v93
    v_smfmac_f32_32x32x32_bf16 v[52:67], v[28:31], v[84:91], v8
    v_exp_f32 v94, v94
    v_exp_f32 v95, v95
    v_exp_f32 v96, v96
    v_exp_f32 v97, v97
    v_exp_f32 v98, v98
    v_exp_f32 v99, v99
    s_add_u32 s25, s31, 114688
    buffer_store_dwordx4 v[240:243], v3, s[4:7], s25 offen sc1
    s_mov_b64 exec, 1
    ds_add_u32 v0, v244 offset:52
    s_mov_b64 exec, -1
    s_add_u32 s25, s26, 34816
    buffer_load_dwordx4 v[140:143], v3, s[4:7], s25 offen
    v_exp_f32 v68, v68
    v_exp_f32 v69, v69
    v_smfmac_f32_32x32x32_bf16 v[52:67], v[32:35], v[92:99], v8
    ds_read_b128 v[12:15], v3 offset:28672
    v_exp_f32 v70, v70
    s_mov_b64 exec, s[50:51]
    ds_read_b128 v[28:31], v10 offset:27648
    ds_read_b128 v[32:35], v10 offset:28160
    s_mov_b64 exec, -1
    v_exp_f32 v71, v71
    v_exp_f32 v72, v72
    s_waitcnt lgkmcnt(3)
    v_mfma_f32_32x32x16_bf16 v[84:99], v[16:19], v[4:7], v[36:51]
    v_exp_f32 v73, v73
    v_exp_f32 v74, v74
    v_exp_f32 v75, v75
    v_exp_f32 v76, v76
    v_exp_f32 v77, v77
    v_smfmac_f32_32x32x32_bf16 v[52:67], v[20:23], v[68:75], v8
    v_exp_f32 v78, v78
    v_exp_f32 v79, v79
    s_cbranch_vccnz KF_PR24
    s_setprio 0
KF_PR24:
    v_exp_f32 v80, v80
    v_exp_f32 v81, v81
    v_exp_f32 v82, v82
    v_exp_f32 v83, v83
    s_add_u32 s25, s26, 35840
    buffer_load_dwordx4 v[144:147], v3, s[4:7], s25 offen
    v_exp_f32 v84, v84
    v_exp_f32 v85, v85
    v_smfmac_f32_32x32x32_bf16 v[52:67], v[24:27], v[76:83], v8
    ds_read_b128 v[16:19], v3 offset:29696
    v_exp_f32 v86, v86
    s_mov_b64 exec, s[50:51]
    ds_read_b128 v[20:23], v10 offset:28672
    ds_read_b128 v[24:27], v10 offset:29184
    s_mov_b64 exec, -1
    v_exp_f32 v87, v87
    v_exp_f32 v88, v88
    s_waitcnt lgkmcnt(3)
    v_mfma_f32_32x32x16_bf16 v[68:83], v[12:15], v[4:7], v[36:51]
    v_exp_f32 v89, v89
    v_exp_f32 v90, v90
    v_exp_f32 v91, v91
    v_exp_f32 v92, v92
    v_exp_f32 v93, v93
    v_smfmac_f32_32x32x32_bf16 v[52:67], v[28:31], v[84:91], v8
    v_exp_f32 v94, v94
    v_exp_f32 v95, v95
    v_exp_f32 v96, v96
    v_exp_f32 v97, v97
    v_exp_f32 v98, v98
    v_exp_f32 v99, v99
    s_cbranch_vccnz KF_PR25
    s_setprio 1
KF_PR25:
    s_add_u32 s25, s26, 36864
    buffer_load_dwordx4 v[148:151], v3, s[4:7], s25 offen
    v_exp_f32 v68, v68
    v_exp_f32 v69, v69
    v_smfmac_f32_32x32x32_bf16 v[52:67], v[32:35], v[92:99], v8
    ds_read_b128 v[12:15], v3 offset:30720
    v_exp_f32 v70, v70
    s_mov_b64 exec, s[50:51]
    ds_read_b128 v[28:31], v10 offset:29696
    ds_read_b128 v[32:35], v10 offset:30208
    s_mov_b64 exec, -1
    v_exp_f32 v71, v71
    v_exp_f32 v72, v72
    s_waitcnt lgkmcnt(3)
    v_mfma_f32_32x32x16_bf16 v[84:99], v[16:19], v[4:7], v[36:51]
    v_exp_f32 v73, v73
    v_exp_f32 v74, v74
    v_exp_f32 v75, v75
    v_exp_f32 v76, v76
    v_exp_f32 v77, v77
    v_smfmac_f32_32x32x32_bf16 v[52:67], v[20:23], v[68:75], v8
    v_exp_f32 v78, v78
    v_exp_f32 v79, v79
    v_exp_f32 v80, v80
    v_exp_f32 v81, v81
    v_exp_f32 v82, v82
    v_exp_f32 v83, v83
    s_mov_b32 s36, 0
KF_SP26_L:
    ds_read_b32 v11, v0 offset:52
    s_add_u32 s36, s36, 1
    s_waitcnt lgkmcnt(0)
    v_readfirstlane_b32 s35, v11
    s_nop 0
    s_cmp_ge_u32 s35, 8
    s_cbranch_scc1 KF_SP26_D
    s_sleep 4
    s_cmp_lt_u32 s36, 524288
    s_cbranch_scc1 KF_SP26_L
KF_SP26_D:
    s_mov_b64 exec, 1
    ds_add_u32 v0, v244 offset:56
    s_mov_b64 exec, -1
    s_add_u32 s25, s26, 37888
    buffer_load_dwordx4 v[152:155], v3, s[4:7], s25 offen
    s_mul_i32 s25, s22, 7
    s_add_u32 s32, s25, 6
    s_lshr_b32 s25, s25, 2
    s_lshr_b32 s32, s32, 2
    s_sub_u32 s32, s32, s25
    s_add_u32 s32, s32, 1
    s_lshl_b32 s32, s32, 3
    s_bfm_b32 s52, s32, 0
    s_mov_b32 s53, 0
    s_lshl_b32 s25, s25, 10
    v_lshlrev_b32 v245, 7, v2
    v_add_u32 v246, s25, v245
    s_mov_b32 s46, 0x40000
    s_cmp_lg_u32 s3, 7
    s_cbranch_scc1 KF_PG_A
    s_mov_b64 exec, s[52:53]
    buffer_load_dword v245, v246, s[4:7], s46 offen sc1
    s_mov_b64 exec, -1
KF_PG_A:
    v_exp_f32 v84, v84
    v_exp_f32 v85, v85
    v_smfmac_f32_32x32x32_bf16 v[52:67], v[24:27], v[76:83], v8
    ds_read_b128 v[16:19], v3 offset:31744
    v_exp_f32 v86, v86
    s_mov_b64 exec, s[50:51]
    ds_read_b128 v[20:23], v10 offset:30720
    ds_read_b128 v[24:27], v10 offset:31232
    s_mov_b64 exec, -1
    v_exp_f32 v87, v87
    v_exp_f32 v88, v88
    s_waitcnt lgkmcnt(3)
    v_mfma_f32_32x32x16_bf16 v[68:83], v[12:15], v[4:7], v[36:51]
    v_exp_f32 v89, v89
    v_exp_f32 v90, v90
    v_exp_f32 v91, v91
    v_exp_f32 v92, v92
    v_exp_f32 v93, v93
    v_smfmac_f32_32x32x32_bf16 v[52:67], v[28:31], v[84:91], v8
    v_exp_f32 v94, v94
    v_exp_f32 v95, v95
    v_exp_f32 v96, v96
    v_exp_f32 v97, v97
    v_exp_f32 v98, v98
    v_exp_f32 v99, v99
    s_add_u32 s25, s26, 38912
    buffer_load_dwordx4 v[156:159], v3, s[4:7], s25 offen
    v_exp_f32 v68, v68
    v_exp_f32 v69, v69
    v_smfmac_f32_32x32x32_bf16 v[52:67], v[32:35], v[92:99], v8
    ds_read_b128 v[12:15], v3 offset:32768
    v_exp_f32 v70, v70
    s_mov_b64 exec, s[50:51]
    ds_read_b128 v[28:31], v10 offset:31744
    ds_read_b128 v[32:35], v10 offset:32256
    s_mov_b64 exec, -1
    v_exp_f32 v71, v71
    v_exp_f32 v72, v72
    s_waitcnt lgkmcnt(3)
    v_mfma_f32_32x32x16_bf16 v[84:99], v[16:19], v[4:7], v[36:51]
    v_exp_f32 v73, v73
    v_exp_f32 v74, v74
    v_exp_f32 v75, v75
    v_exp_f32 v76, v76
    v_exp_f32 v77, v77
    v_smfmac_f32_32x32x32_bf16 v[52:67], v[20:23], v[68:75], v8
    v_exp_f32 v78, v78
    v_exp_f32 v79, v79
    s_cbranch_vccnz KF_PR27
    s_setprio 0
KF_PR27:
    v_exp_f32 v80, v80
    v_exp_f32 v81, v81
    v_exp_f32 v82, v82
    v_exp_f32 v83, v83
    s_add_u32 s25, s26, 39936
    buffer_load_dwordx4 v[160:163], v3, s[4:7], s25 offen
    v_exp_f32 v84, v84
    v_exp_f32 v85, v85
    v_smfmac_f32_32x32x32_bf16 v[52:67], v[24:27], v[76:83], v8
    ds_read_b128 v[16:19], v3 offset:33792
    v_exp_f32 v86, v86
    s_mov_b64 exec, s[50:51]
    ds_read_b128 v[20:23], v10 offset:32768
    ds_read_b128 v[24:27], v10 offset:33280
    s_mov_b64 exec, -1
    v_exp_f32 v87, v87
    v_exp_f32 v88, v88
    s_waitcnt lgkmcnt(3)
    v_mfma_f32_32x32x16_bf16 v[68:83], v[12:15], v[4:7], v[36:51]
    v_exp_f32 v89, v89
    v_exp_f32 v90, v90
    v_exp_f32 v91, v91
    v_exp_f32 v92, v92
    v_exp_f32 v93, v93
    v_smfmac_f32_32x32x32_bf16 v[52:67], v[28:31], v[84:91], v8
    v_exp_f32 v94, v94
    v_exp_f32 v95, v95
    v_exp_f32 v96, v96
    v_exp_f32 v97, v97
    v_exp_f32 v98, v98
    v_exp_f32 v99, v99
    s_cbranch_vccnz KF_PR28
    s_setprio 1
KF_PR28:
    s_cmp_lg_u32 s3, 7
    s_cbranch_scc1 KF_PG_X
    s_mov_b64 exec, s[52:53]
    s_mov_b32 s36, 0
    s_waitcnt vmcnt(2)
KF_PG_L:
    v_cmp_ne_u32 s[34:35], 0, v245
    s_add_u32 s36, s36, 1
    s_cmp_eq_u64 s[34:35], s[52:53]
    s_cbranch_scc1 KF_PG_D
    s_cmp_ge_u32 s36, 65536
    s_cbranch_scc1 KF_PG_D
    s_sleep 8
    buffer_load_dword v245, v246, s[4:7], s46 offen sc1
    s_waitcnt vmcnt(0)
    s_branch KF_PG_L
KF_PG_D:
    s_mov_b64 exec, -1
    ds_write_b32 v0, v244 offset:4
KF_PG_X:
    v_exp_f32 v68, v68
    v_exp_f32 v69, v69
    v_smfmac_f32_32x32x32_bf16 v[52:67], v[32:35], v[92:99], v8
    ds_read_b128 v[12:15], v3 offset:34816
    v_exp_f32 v70, v70
    s_mov_b64 exec, s[50:51]
    ds_read_b128 v[28:31], v10 offset:33792
    ds_read_b128 v[32:35], v10 offset:34304
    s_mov_b64 exec, -1
    v_exp_f32 v71, v71
    v_exp_f32 v72, v72
    s_waitcnt lgkmcnt(3)
    v_mfma_f32_32x32x16_bf16 v[84:99], v[16:19], v[4:7], v[36:51]
    v_exp_f32 v73, v73
    v_exp_f32 v74, v74
    v_exp_f32 v75, v75
    v_exp_f32 v76, v76
    v_exp_f32 v77, v77
    v_smfmac_f32_32x32x32_bf16 v[52:67], v[20:23], v[68:75], v8
    v_exp_f32 v78, v78
    v_exp_f32 v79, v79
    v_exp_f32 v80, v80
    v_exp_f32 v81, v81
    v_exp_f32 v82, v82
    v_exp_f32 v83, v83
    s_add_u32 s25, s31, 229376
    buffer_store_dwordx4 v[240:243], v3, s[4:7], s25 offen sc1
    s_mov_b32 s36, 0
KF_SP29_L:
    ds_read_b32 v11, v0 offset:56
    s_add_u32 s36, s36, 1
    s_waitcnt lgkmcnt(0)
    v_readfirstlane_b32 s35, v11
    s_nop 0
    s_cmp_ge_u32 s35, 8
    s_cbranch_scc1 KF_SP29_D
    s_sleep 4
    s_cmp_lt_u32 s36, 524288
    s_cbranch_scc1 KF_SP29_L
KF_SP29_D:
    s_mul_i32 s37, s20, 229376
    s_mul_i32 s33, s3, 14336
    s_add_u32 s37, s37, s33
    s_add_u32 s37, s37, 0x200000
    s_mul_i32 s38, s24, 114688
    s_add_u32 s38, s38, s33
    s_add_u32 s38, s38, 0x1000000
    s_lshl_b32 s39, s3, 10
    s_lshr_b32 s29, s3, 2
    s_lshl_b32 s33, s29, 16
    s_lshl_b32 s29, s29, 1
    s_add_u32 s29, s29, s24
    s_lshl_b32 s49, s20, 2
    s_and_b32 s25, s3, 3
    s_add_u32 s49, s49, s25
    s_lshl_b32 s25, s25, 10
    s_add_u32 s33, s33, s25
    s_add_u32 s54, s33, 24576
    s_lshl_b32 s30, s29, 15
    s_lshl_b32 s25, s49, 5
    s_add_u32 s30, s30, s25
    v_and_b32 v1, 31, v2
    v_lshlrev_b32 v1, 10, v1
    v_lshrrev_b32 v11, 5, v2
    v_lshl_add_u32 v1, v11, 4, v1
    s_mov_b32 m0, s54
    v_lshrrev_b32 v11, 4, v2
    buffer_load_dwordx4 v1, s[8:11], s30 offen lds
    v_mul_u32_u24 v11, 6144, v11
    v_and_b32 v9, 15, v2
    v_lshl_add_u32 v11, v9, 2, v11
    s_lshl_b32 s25, s49, 6
    s_add_u32 s25, s25, 4096
    s_lshl_b32 s33, s3, 8
    s_add_u32 m0, s33, 159744
    s_mov_b32 exec_hi, 0
    buffer_load_dword v11, s[4:7], s25 offen lds
    s_mov_b32 exec_hi, -1
    v_lshrrev_b32 v9, 5, v2
    v_lshlrev_b32 v9, 5, v9
    s_add_u32 s33, s33, 159744
    v_add_u32 v9, s33, v9
    v_exp_f32 v84, v84
    v_exp_f32 v85, v85
    v_smfmac_f32_32x32x32_bf16 v[52:67], v[24:27], v[76:83], v8
    ds_read_b128 v[16:19], v3 offset:35840
    v_exp_f32 v86, v86
    s_mov_b64 exec, s[50:51]
    ds_read_b128 v[20:23], v10 offset:34816
    ds_read_b128 v[24:27], v10 offset:35328
    s_mov_b64 exec, -1
    v_exp_f32 v87, v87
    v_exp_f32 v88, v88
    s_waitcnt lgkmcnt(3)
    v_mfma_f32_32x32x16_bf16 v[68:83], v[12:15], v[4:7], v[36:51]
    v_exp_f32 v89, v89
    v_exp_f32 v90, v90
    v_exp_f32 v91, v91
    v_exp_f32 v92, v92
    v_exp_f32 v93, v93
    v_smfmac_f32_32x32x32_bf16 v[52:67], v[28:31], v[84:91], v8
    v_exp_f32 v94, v94
    v_exp_f32 v95, v95
    v_exp_f32 v96, v96
    v_exp_f32 v97, v97
    v_exp_f32 v98, v98
    v_exp_f32 v99, v99
    s_mov_b32 s36, 0
KF_SP30_L:
    ds_read_b32 v11, v0 offset:4
    s_add_u32 s36, s36, 1
    s_waitcnt lgkmcnt(0)
    v_readfirstlane_b32 s35, v11
    s_nop 0
    s_cmp_ge_u32 s35, 1
    s_cbranch_scc1 KF_SP30_D
    s_sleep 4
    s_cmp_lt_u32 s36, 524288
    s_cbranch_scc1 KF_SP30_L
KF_SP30_D:
    s_add_u32 s25, s27, 29696
    s_add_u32 m0, s39, 131072
    s_nop 0
    buffer_load_dwordx4 v3, s[4:7], s25 offen sc1 lds
    v_exp_f32 v68, v68
    v_exp_f32 v69, v69
    v_smfmac_f32_32x32x32_bf16 v[52:67], v[32:35], v[92:99], v8
    ds_read_b128 v[12:15], v3 offset:36864
    v_exp_f32 v70, v70
    s_mov_b64 exec, s[50:51]
    ds_read_b128 v[28:31], v10 offset:35840
    ds_read_b128 v[32:35], v10 offset:36352
    s_mov_b64 exec, -1
    v_exp_f32 v71, v71
    v_exp_f32 v72, v72
    s_waitcnt lgkmcnt(3)
    v_mfma_f32_32x32x16_bf16 v[84:99], v[16:19], v[4:7], v[36:51]
    v_exp_f32 v73, v73
    v_exp_f32 v74, v74
    v_exp_f32 v75, v75
    v_exp_f32 v76, v76
    v_exp_f32 v77, v77
    v_smfmac_f32_32x32x32_bf16 v[52:67], v[20:23], v[68:75], v8
    v_exp_f32 v78, v78
    v_exp_f32 v79, v79
    s_cbranch_vccnz KF_PR31
    s_setprio 0
KF_PR31:
    v_exp_f32 v80, v80
    v_exp_f32 v81, v81
    v_exp_f32 v82, v82
    v_exp_f32 v83, v83
    s_add_u32 s25, s27, 31744
    s_add_u32 m0, s39, 143360
    s_nop 0
    buffer_load_dwordx4 v3, s[4:7], s25 offen sc1 lds
    s_add_u32 s25, s27, 23552
    s_add_u32 m0, s39, 0
    s_nop 0
    buffer_load_dwordx4 v3, s[4:7], s25 offen sc1 lds
    v_exp_f32 v84, v84
    v_exp_f32 v85, v85
    v_smfmac_f32_32x32x32_bf16 v[52:67], v[24:27], v[76:83], v8
    ds_read_b128 v[16:19], v3 offset:37888
    v_exp_f32 v86, v86
    s_mov_b64 exec, s[50:51]
    ds_read_b128 v[20:23], v10 offset:36864
    ds_read_b128 v[24:27], v10 offset:37376
    s_mov_b64 exec, -1
    v_exp_f32 v87, v87
    v_exp_f32 v88, v88
    s_waitcnt lgkmcnt(3)
    v_mfma_f32_32x32x16_bf16 v[68:83], v[12:15], v[4:7], v[36:51]
    v_exp_f32 v89, v89
    v_exp_f32 v90, v90
    v_exp_f32 v91, v91
    v_exp_f32 v92, v92
    v_exp_f32 v93, v93
    v_smfmac_f32_32x32x32_bf16 v[52:67], v[28:31], v[84:91], v8
    v_exp_f32 v94, v94
    v_exp_f32 v95, v95
    v_exp_f32 v96, v96
    v_exp_f32 v97, v97
    v_exp_f32 v98, v98
    v_exp_f32 v99, v99
    s_cbranch_vccnz KF_PR32
    s_setprio 1
KF_PR32:
    s_add_u32 s25, s27, 32768
    s_add_u32 m0, s39, 151552
    s_nop 0
    buffer_load_dwordx4 v3, s[4:7], s25 offen sc1 lds
    v_exp_f32 v68, v68
    v_exp_f32 v69, v69
    v_smfmac_f32_32x32x32_bf16 v[52:67], v[32:35], v[92:99], v8
    ds_read_b128 v[12:15], v3 offset:38912
    v_exp_f32 v70, v70
    s_mov_b64 exec, s[50:51]
    ds_read_b128 v[28:31], v10 offset:37888
    ds_read_b128 v[32:35], v10 offset:38400
    s_mov_b64 exec, -1
    v_exp_f32 v71, v71
    v_exp_f32 v72, v72
    s_waitcnt lgkmcnt(3)
    v_mfma_f32_32x32x16_bf16 v[84:99], v[16:19], v[4:7], v[36:51]
    v_exp_f32 v73, v73
    v_exp_f32 v74, v74
    v_exp_f32 v75, v75
    v_exp_f32 v76, v76
    v_exp_f32 v77, v77
    v_smfmac_f32_32x32x32_bf16 v[52:67], v[20:23], v[68:75], v8
    v_exp_f32 v78, v78
    v_exp_f32 v79, v79
    v_exp_f32 v80, v80
    v_exp_f32 v81, v81
    v_exp_f32 v82, v82
    v_exp_f32 v83, v83
    s_add_u32 s25, s27, 0
    buffer_load_dwordx4 v[164:167], v3, s[4:7], s25 offen sc1
    v_exp_f32 v84, v84
    v_exp_f32 v85, v85
    v_smfmac_f32_32x32x32_bf16 v[52:67], v[24:27], v[76:83], v8
    ds_read_b128 v[16:19], v3 offset:39936
    v_exp_f32 v86, v86
    s_mov_b64 exec, s[50:51]
    ds_read_b128 v[20:23], v10 offset:38912
    ds_read_b128 v[24:27], v10 offset:39424
    s_mov_b64 exec, -1
    v_exp_f32 v87, v87
    v_exp_f32 v88, v88
    s_waitcnt lgkmcnt(3)
    v_mfma_f32_32x32x16_bf16 v[68:83], v[12:15], v[4:7], v[36:51]
    v_exp_f32 v89, v89
    v_exp_f32 v90, v90
    v_exp_f32 v91, v91
    v_exp_f32 v92, v92
    v_exp_f32 v93, v93
    v_smfmac_f32_32x32x32_bf16 v[52:67], v[28:31], v[84:91], v8
    v_exp_f32 v94, v94
    v_exp_f32 v95, v95
    v_exp_f32 v96, v96
    v_exp_f32 v97, v97
    v_exp_f32 v98, v98
    v_exp_f32 v99, v99
    s_add_u32 s25, s31, 344064
    buffer_store_dwordx4 v[240:243], v3, s[4:7], s25 offen sc1
    s_add_u32 s25, s27, 1024
    buffer_load_dwordx4 v[168:171], v3, s[4:7], s25 offen sc1
    v_exp_f32 v68, v68
    v_exp_f32 v69, v69
    v_smfmac_f32_32x32x32_bf16 v[52:67], v[32:35], v[92:99], v8
    ds_read_b128 v[12:15], v3 offset:40960
    v_exp_f32 v70, v70
    s_mov_b64 exec, s[50:51]
    ds_read_b128 v[28:31], v10 offset:39936
    ds_read_b128 v[32:35], v10 offset:40448
    s_mov_b64 exec, -1
    v_exp_f32 v71, v71
    v_exp_f32 v72, v72
    s_waitcnt lgkmcnt(3)
    v_mfma_f32_32x32x16_bf16 v[84:99], v[16:19], v[4:7], v[36:51]
    v_exp_f32 v73, v73
    v_exp_f32 v74, v74
    v_exp_f32 v75, v75
    v_exp_f32 v76, v76
    v_exp_f32 v77, v77
    v_smfmac_f32_32x32x32_bf16 v[52:67], v[20:23], v[68:75], v8
    v_exp_f32 v78, v78
    v_exp_f32 v79, v79
    s_cbranch_vccnz KF_PR33
    s_setprio 0
KF_PR33:
    v_exp_f32 v80, v80
    v_exp_f32 v81, v81
    v_exp_f32 v82, v82
    v_exp_f32 v83, v83
    s_add_u32 s25, s27, 2048
    buffer_load_dwordx4 v[172:175], v3, s[4:7], s25 offen sc1
    s_add_u32 s25, s27, 24576
    s_add_u32 m0, s39, 8192
    s_nop 0
    buffer_load_dwordx4 v3, s[4:7], s25 offen sc1 lds
    v_exp_f32 v84, v84
    v_exp_f32 v85, v85
    v_smfmac_f32_32x32x32_bf16 v[52:67], v[24:27], v[76:83], v8
    ds_read_b128 v[16:19], v3 offset:41984
    v_exp_f32 v86, v86
    s_mov_b64 exec, s[50:51]
    ds_read_b128 v[20:23], v10 offset:40960
    ds_read_b128 v[24:27], v10 offset:41472
    s_mov_b64 exec, -1
    v_exp_f32 v87, v87
    v_exp_f32 v88, v88
    s_waitcnt lgkmcnt(3)
    v_mfma_f32_32x32x16_bf16 v[68:83], v[12:15], v[4:7], v[36:51]
    v_exp_f32 v89, v89
    v_exp_f32 v90, v90
    v_exp_f32 v91, v91
    v_exp_f32 v92, v92
    v_exp_f32 v93, v93
    v_smfmac_f32_32x32x32_bf16 v[52:67], v[28:31], v[84:91], v8
    v_exp_f32 v94, v94
    v_exp_f32 v95, v95
    v_exp_f32 v96, v96
    v_exp_f32 v97, v97
    v_exp_f32 v98, v98
    v_exp_f32 v99, v99
    s_cbranch_vccnz KF_PR34
    s_setprio 1
KF_PR34:
    s_add_u32 s25, s27, 3072
    buffer_load_dwordx4 v[176:179], v3, s[4:7], s25 offen sc1
    v_exp_f32 v68, v68
    v_exp_f32 v69, v69
    v_smfmac_f32_32x32x32_bf16 v[52:67], v[32:35], v[92:99], v8
    ds_read_b128 v[12:15], v3 offset:43008
    v_exp_f32 v70, v70
    s_mov_b64 exec, s[50:51]
    ds_read_b128 v[28:31], v10 offset:41984
    ds_read_b128 v[32:35], v10 offset:42496
    s_mov_b64 exec, -1
    v_exp_f32 v71, v71
    v_exp_f32 v72, v72
    s_waitcnt lgkmcnt(3)
    v_mfma_f32_32x32x16_bf16 v[84:99], v[16:19], v[4:7], v[36:51]
    v_exp_f32 v73, v73
    v_exp_f32 v74, v74
    v_exp_f32 v75, v75
    v_exp_f32 v76, v76
    v_exp_f32 v77, v77
    v_smfmac_f32_32x32x32_bf16 v[52:67], v[20:23], v[68:75], v8
    v_exp_f32 v78, v78
    v_exp_f32 v79, v79
    v_exp_f32 v80, v80
    v_exp_f32 v81, v81
    v_exp_f32 v82, v82
    v_exp_f32 v83, v83
    s_add_u32 s25, s27, 4096
    buffer_load_dwordx4 v[180:183], v3, s[4:7], s25 offen sc1
    v_exp_f32 v84, v84
    v_exp_f32 v85, v85
    v_smfmac_f32_32x32x32_bf16 v[52:67], v[24:27], v[76:83], v8
    ds_read_b128 v[16:19], v3 offset:44032
    v_exp_f32 v86, v86
    s_mov_b64 exec, s[50:51]
    ds_read_b128 v[20:23], v10 offset:43008
    ds_read_b128 v[24:27], v10 offset:43520
    s_mov_b64 exec, -1
    v_exp_f32 v87, v87
    v_exp_f32 v88, v88
    s_waitcnt lgkmcnt(3)
    v_mfma_f32_32x32x16_bf16 v[68:83], v[12:15], v[4:7], v[36:51]
    v_exp_f32 v89, v89
    v_exp_f32 v90, v90
    v_exp_f32 v91, v91
    v_exp_f32 v92, v92
    v_exp_f32 v93, v93
    v_smfmac_f32_32x32x32_bf16 v[52:67], v[28:31], v[84:91], v8
    v_exp_f32 v94, v94
    v_exp_f32 v95, v95
    v_exp_f32 v96, v96
    v_exp_f32 v97, v97
    v_exp_f32 v98, v98
    v_exp_f32 v99, v99
    buffer_store_dwordx4 v[240:243], v3, s[4:7], s28 offen sc1
    s_add_u32 s25, s27, 5120
    buffer_load_dwordx4 v[184:187], v3, s[4:7], s25 offen sc1
    v_exp_f32 v68, v68
    v_exp_f32 v69, v69
    v_smfmac_f32_32x32x32_bf16 v[52:67], v[32:35], v[92:99], v8
    ds_read_b128 v[12:15], v3 offset:45056
    v_exp_f32 v70, v70
    s_mov_b64 exec, s[50:51]
    ds_read_b128 v[28:31], v10 offset:44032
    ds_read_b128 v[32:35], v10 offset:44544
    s_mov_b64 exec, -1
    v_exp_f32 v71, v71
    v_exp_f32 v72, v72
    s_waitcnt lgkmcnt(3)
    v_mfma_f32_32x32x16_bf16 v[84:99], v[16:19], v[4:7], v[36:51]
    v_exp_f32 v73, v73
    v_exp_f32 v74, v74
    v_exp_f32 v75, v75
    v_exp_f32 v76, v76
    v_exp_f32 v77, v77
    v_smfmac_f32_32x32x32_bf16 v[52:67], v[20:23], v[68:75], v8
    v_exp_f32 v78, v78
    v_exp_f32 v79, v79
    s_cbranch_vccnz KF_PR35
    s_setprio 0
KF_PR35:
    v_exp_f32 v80, v80
    v_exp_f32 v81, v81
    v_exp_f32 v82, v82
    v_exp_f32 v83, v83
    s_add_u32 s25, s27, 6144
    buffer_load_dwordx4 v[188:191], v3, s[4:7], s25 offen sc1
    s_add_u32 s25, s27, 25600
    s_add_u32 m0, s39, 16384
    s_nop 0
    buffer_load_dwordx4 v3, s[4:7], s25 offen sc1 lds
    v_exp_f32 v84, v84
    v_exp_f32 v85, v85
    v_smfmac_f32_32x32x32_bf16 v[52:67], v[24:27], v[76:83], v8
    ds_read_b128 v[16:19], v3 offset:46080
    v_exp_f32 v86, v86
    s_mov_b64 exec, s[50:51]
    ds_read_b128 v[20:23], v10 offset:45056
    ds_read_b128 v[24:27], v10 offset:45568
    s_mov_b64 exec, -1
    v_exp_f32 v87, v87
    v_exp_f32 v88, v88
    s_waitcnt lgkmcnt(3)
    v_mfma_f32_32x32x16_bf16 v[68:83], v[12:15], v[4:7], v[36:51]
    v_exp_f32 v89, v89
    v_exp_f32 v90, v90
    v_exp_f32 v91, v91
    v_exp_f32 v92, v92
    v_exp_f32 v93, v93
    v_smfmac_f32_32x32x32_bf16 v[52:67], v[28:31], v[84:91], v8
    v_exp_f32 v94, v94
    v_exp_f32 v95, v95
    v_exp_f32 v96, v96
    v_exp_f32 v97, v97
    v_exp_f32 v98, v98
    v_exp_f32 v99, v99
    s_cbranch_vccnz KF_PR36
    s_setprio 1
KF_PR36:
    s_add_u32 s25, s27, 7168
    buffer_load_dwordx4 v[192:195], v3, s[4:7], s25 offen sc1
    v_exp_f32 v68, v68
    v_exp_f32 v69, v69
    v_smfmac_f32_32x32x32_bf16 v[52:67], v[32:35], v[92:99], v8
    ds_read_b128 v[12:15], v3 offset:47104
    v_exp_f32 v70, v70
    s_mov_b64 exec, s[50:51]
    ds_read_b128 v[28:31], v10 offset:46080
    ds_read_b128 v[32:35], v10 offset:46592
    s_mov_b64 exec, -1
    v_exp_f32 v71, v71
    v_exp_f32 v72, v72
    s_waitcnt lgkmcnt(3)
    v_mfma_f32_32x32x16_bf16 v[84:99], v[16:19], v[4:7], v[36:51]
    v_exp_f32 v73, v73
    v_exp_f32 v74, v74
    v_exp_f32 v75, v75
    v_exp_f32 v76, v76
    v_exp_f32 v77, v77
    v_smfmac_f32_32x32x32_bf16 v[52:67], v[20:23], v[68:75], v8
    v_exp_f32 v78, v78
    v_exp_f32 v79, v79
    v_exp_f32 v80, v80
    v_exp_f32 v81, v81
    v_exp_f32 v82, v82
    v_exp_f32 v83, v83
    s_add_u32 s25, s27, 8192
    buffer_load_dwordx4 v[196:199], v3, s[4:7], s25 offen sc1
    v_exp_f32 v84, v84
    v_exp_f32 v85, v85
    v_smfmac_f32_32x32x32_bf16 v[52:67], v[24:27], v[76:83], v8
    ds_read_b128 v[16:19], v3 offset:48128
    v_exp_f32 v86, v86
    s_mov_b64 exec, s[50:51]
    ds_read_b128 v[20:23], v10 offset:47104
    ds_read_b128 v[24:27], v10 offset:47616
    s_mov_b64 exec, -1
    v_exp_f32 v87, v87
    v_exp_f32 v88, v88
    s_waitcnt lgkmcnt(3)
    v_mfma_f32_32x32x16_bf16 v[68:83], v[12:15], v[4:7], v[36:51]
    v_exp_f32 v89, v89
    v_exp_f32 v90, v90
    v_exp_f32 v91, v91
    v_exp_f32 v92, v92
    v_exp_f32 v93, v93
    v_smfmac_f32_32x32x32_bf16 v[52:67], v[28:31], v[84:91], v8
    v_exp_f32 v94, v94
    v_exp_f32 v95, v95
    v_exp_f32 v96, v96
    v_exp_f32 v97, v97
    v_exp_f32 v98, v98
    v_exp_f32 v99, v99
    s_lshr_b32 s25, s3, 2
    s_lshl_b32 s25, s25, 1
    s_add_u32 s25, s25, s24
    s_lshl_b32 s25, s25, 5
    s_lshl_b32 s32, s20, 2
    s_add_u32 s25, s25, s32
    s_and_b32 s32, s3, 3
    s_add_u32 s25, s25, s32
    s_lshl_b32 s25, s25, 10
    s_add_u32 s25, s25, 0xc00000
    buffer_store_dwordx4 v[240:243], v3, s[4:7], s25 offen sc1
    s_add_u32 s25, s27, 9216
    buffer_load_dwordx4 v[200:203], v3, s[4:7], s25 offen sc1
    v_exp_f32 v68, v68
    v_exp_f32 v69, v69
    v_smfmac_f32_32x32x32_bf16 v[52:67], v[32:35], v[92:99], v8
    ds_read_b128 v[12:15], v3 offset:49152
    v_exp_f32 v70, v70
    s_mov_b64 exec, s[50:51]
    ds_read_b128 v[28:31], v10 offset:48128
    ds_read_b128 v[32:35], v10 offset:48640
    s_mov_b64 exec, -1
    v_exp_f32 v71, v71
    v_exp_f32 v72, v72
    s_waitcnt lgkmcnt(3)
    v_mfma_f32_32x32x16_bf16 v[84:99], v[16:19], v[4:7], v[36:51]
    v_exp_f32 v73, v73
    v_exp_f32 v74, v74
    v_exp_f32 v75, v75
    v_exp_f32 v76, v76
    v_exp_f32 v77, v77
    v_smfmac_f32_32x32x32_bf16 v[52:67], v[20:23], v[68:75], v8
    v_exp_f32 v78, v78
    v_exp_f32 v79, v79
    s_cbranch_vccnz KF_PR37
    s_setprio 0
KF_PR37:
    v_exp_f32 v80, v80
    v_exp_f32 v81, v81
    v_exp_f32 v82, v82
    v_exp_f32 v83, v83
    s_add_u32 s25, s27, 10240
    buffer_load_dwordx4 v[204:207], v3, s[4:7], s25 offen sc1
    s_add_u32 s25, s27, 26624
    s_add_u32 m0, s39, 65536
    s_nop 0
    buffer_load_dwordx4 v3, s[4:7], s25 offen sc1 lds
    v_exp_f32 v84, v84
    v_exp_f32 v85, v85
    v_smfmac_f32_32x32x32_bf16 v[52:67], v[24:27], v[76:83], v8
    ds_read_b128 v[16:19], v3 offset:50176
    v_exp_f32 v86, v86
    s_mov_b64 exec, s[50:51]
    ds_read_b128 v[20:23], v10 offset:49152
    ds_read_b128 v[24:27], v10 offset:49664
    s_mov_b64 exec, -1
    v_exp_f32 v87, v87
    v_exp_f32 v88, v88
    s_waitcnt lgkmcnt(3)
    v_mfma_f32_32x32x16_bf16 v[68:83], v[12:15], v[4:7], v[36:51]
    v_exp_f32 v89, v89
    v_exp_f32 v90, v90
    v_exp_f32 v91, v91
    v_exp_f32 v92, v92
    v_exp_f32 v93, v93
    v_smfmac_f32_32x32x32_bf16 v[52:67], v[28:31], v[84:91], v8
    v_exp_f32 v94, v94
    v_exp_f32 v95, v95
    v_exp_f32 v96, v96
    v_exp_f32 v97, v97
    v_exp_f32 v98, v98
    v_exp_f32 v99, v99
    s_cbranch_vccnz KF_PR38
    s_setprio 1
KF_PR38:
    s_add_u32 s25, s27, 11264
    buffer_load_dwordx4 v[208:211], v3, s[4:7], s25 offen sc1
    v_exp_f32 v68, v68
    v_exp_f32 v69, v69
    v_smfmac_f32_32x32x32_bf16 v[52:67], v[32:35], v[92:99], v8
    ds_read_b128 v[12:15], v3 offset:51200
    v_exp_f32 v70, v70
    s_mov_b64 exec, s[50:51]
    ds_read_b128 v[28:31], v10 offset:50176
    ds_read_b128 v[32:35], v10 offset:50688
    s_mov_b64 exec, -1
    v_exp_f32 v71, v71
    v_exp_f32 v72, v72
    s_waitcnt lgkmcnt(3)
    v_mfma_f32_32x32x16_bf16 v[84:99], v[16:19], v[4:7], v[36:51]
    v_exp_f32 v73, v73
    v_exp_f32 v74, v74
    v_exp_f32 v75, v75
    v_exp_f32 v76, v76
    v_exp_f32 v77, v77
    v_smfmac_f32_32x32x32_bf16 v[52:67], v[20:23], v[68:75], v8
    v_exp_f32 v78, v78
    v_exp_f32 v79, v79
    v_exp_f32 v80, v80
    v_exp_f32 v81, v81
    v_exp_f32 v82, v82
    v_exp_f32 v83, v83
    s_add_u32 s25, s27, 12288
    buffer_load_dwordx4 v[212:215], v3, s[4:7], s25 offen sc1
    v_exp_f32 v84, v84
    v_exp_f32 v85, v85
    v_smfmac_f32_32x32x32_bf16 v[52:67], v[24:27], v[76:83], v8
    ds_read_b128 v[16:19], v3 offset:52224
    v_exp_f32 v86, v86
    s_mov_b64 exec, s[50:51]
    ds_read_b128 v[20:23], v10 offset:51200
    ds_read_b128 v[24:27], v10 offset:51712
    s_mov_b64 exec, -1
    v_exp_f32 v87, v87
    v_exp_f32 v88, v88
    s_waitcnt lgkmcnt(3)
    v_mfma_f32_32x32x16_bf16 v[68:83], v[12:15], v[4:7], v[36:51]
    v_exp_f32 v89, v89
    v_exp_f32 v90, v90
    v_exp_f32 v91, v91
    v_exp_f32 v92, v92
    v_exp_f32 v93, v93
    v_smfmac_f32_32x32x32_bf16 v[52:67], v[28:31], v[84:91], v8
    v_exp_f32 v94, v94
    v_exp_f32 v95, v95
    v_exp_f32 v96, v96
    v_exp_f32 v97, v97
    v_exp_f32 v98, v98
    v_exp_f32 v99, v99
    s_lshr_b32 s25, s3, 2
    s_lshl_b32 s25, s25, 1
    s_add_u32 s25, s25, s24
    s_lshl_b32 s25, s25, 5
    s_lshl_b32 s32, s20, 2
    s_add_u32 s25, s25, s32
    s_and_b32 s32, s3, 3
    s_add_u32 s25, s25, s32
    s_lshr_b32 s32, s25, 2
    s_lshl_b32 s32, s32, 8
    s_add_u32 s32, s32, 0xe00000
    v_lshlrev_b32 v11, 2, v2
    buffer_store_dword v240, v11, s[4:7], s32 offen sc1
    s_add_u32 s25, s27, 13312
    buffer_load_dwordx4 v[216:219], v3, s[4:7], s25 offen sc1
    v_exp_f32 v68, v68
    v_exp_f32 v69, v69
    v_smfmac_f32_32x32x32_bf16 v[52:67], v[32:35], v[92:99], v8
    ds_read_b128 v[12:15], v3 offset:53248
    v_exp_f32 v70, v70
    s_mov_b64 exec, s[50:51]
    ds_read_b128 v[28:31], v10 offset:52224
    ds_read_b128 v[32:35], v10 offset:52736
    s_mov_b64 exec, -1
    v_exp_f32 v71, v71
    v_exp_f32 v72, v72
    s_waitcnt lgkmcnt(3)
    v_mfma_f32_32x32x16_bf16 v[84:99], v[16:19], v[4:7], v[36:51]
    v_exp_f32 v73, v73
    v_exp_f32 v74, v74
    v_exp_f32 v75, v75
    v_exp_f32 v76, v76
    v_exp_f32 v77, v77
    v_smfmac_f32_32x32x32_bf16 v[52:67], v[20:23], v[68:75], v8
    v_exp_f32 v78, v78
    v_exp_f32 v79, v79
    s_cbranch_vccnz KF_PR39
    s_setprio 0
KF_PR39:
    v_exp_f32 v80, v80
    v_exp_f32 v81, v81
    v_exp_f32 v82, v82
    v_exp_f32 v83, v83
    s_add_u32 s25, s27, 14336
    buffer_load_dwordx4 v[220:223], v3, s[4:7], s25 offen sc1
    s_add_u32 s25, s27, 27648
    s_add_u32 m0, s39, 73728
    s_nop 0
    buffer_load_dwordx4 v3, s[4:7], s25 offen sc1 lds
    v_exp_f32 v84, v84
    v_exp_f32 v85, v85
    v_smfmac_f32_32x32x32_bf16 v[52:67], v[24:27], v[76:83], v8
    ds_read_b128 v[16:19], v3 offset:54272
    v_exp_f32 v86, v86
    s_mov_b64 exec, s[50:51]
    ds_read_b128 v[20:23], v10 offset:53248
    ds_read_b128 v[24:27], v10 offset:53760
    s_mov_b64 exec, -1
    v_exp_f32 v87, v87
    v_exp_f32 v88, v88
    s_waitcnt lgkmcnt(3)
    v_mfma_f32_32x32x16_bf16 v[68:83], v[12:15], v[4:7], v[36:51]
    v_exp_f32 v89, v89
    v_exp_f32 v90, v90
    v_exp_f32 v91, v91
    v_exp_f32 v92, v92
    v_exp_f32 v93, v93
    v_smfmac_f32_32x32x32_bf16 v[52:67], v[28:31], v[84:91], v8
    v_exp_f32 v94, v94
    v_exp_f32 v95, v95
    v_exp_f32 v96, v96
    v_exp_f32 v97, v97
    v_exp_f32 v98, v98
    v_exp_f32 v99, v99
    s_cbranch_vccnz KF_PR40
    s_setprio 1
KF_PR40:
    s_add_u32 s25, s27, 15360
    buffer_load_dwordx4 v[224:227], v3, s[4:7], s25 offen sc1
    v_exp_f32 v68, v68
    v_exp_f32 v69, v69
    v_smfmac_f32_32x32x32_bf16 v[52:67], v[32:35], v[92:99], v8
    ds_read_b128 v[12:15], v3 offset:55296
    v_exp_f32 v70, v70
    s_mov_b64 exec, s[50:51]
    ds_read_b128 v[28:31], v10 offset:54272
    ds_read_b128 v[32:35], v10 offset:54784
    s_mov_b64 exec, -1
    v_exp_f32 v71, v71
    v_exp_f32 v72, v72
    s_waitcnt lgkmcnt(3)
    v_mfma_f32_32x32x16_bf16 v[84:99], v[16:19], v[4:7], v[36:51]
    v_exp_f32 v73, v73
    v_exp_f32 v74, v74
    v_exp_f32 v75, v75
    v_exp_f32 v76, v76
    v_exp_f32 v77, v77
    v_smfmac_f32_32x32x32_bf16 v[52:67], v[20:23], v[68:75], v8
    v_exp_f32 v78, v78
    v_exp_f32 v79, v79
    v_exp_f32 v80, v80
    v_exp_f32 v81, v81
    v_exp_f32 v82, v82
    v_exp_f32 v83, v83
    s_add_u32 s25, s27, 16384
    buffer_load_dwordx4 v[228:231], v3, s[4:7], s25 offen sc1
    v_exp_f32 v84, v84
    v_exp_f32 v85, v85
    v_smfmac_f32_32x32x32_bf16 v[52:67], v[24:27], v[76:83], v8
    ds_read_b128 v[16:19], v3 offset:56320
    v_exp_f32 v86, v86
    s_mov_b64 exec, s[50:51]
    ds_read_b128 v[20:23], v10 offset:55296
    ds_read_b128 v[24:27], v10 offset:55808
    s_mov_b64 exec, -1
    v_exp_f32 v87, v87
    v_exp_f32 v88, v88
    s_waitcnt lgkmcnt(3)
    v_mfma_f32_32x32x16_bf16 v[68:83], v[12:15], v[4:7], v[36:51]
    v_exp_f32 v89, v89
    v_exp_f32 v90, v90
    v_exp_f32 v91, v91
    v_exp_f32 v92, v92
    v_exp_f32 v93, v93
    v_smfmac_f32_32x32x32_bf16 v[52:67], v[28:31], v[84:91], v8
    v_exp_f32 v94, v94
    v_exp_f32 v95, v95
    v_exp_f32 v96, v96
    v_exp_f32 v97, v97
    v_exp_f32 v98, v98
    v_exp_f32 v99, v99
    s_add_u32 s25, s27, 17408
    buffer_load_dwordx4 v[232:235], v3, s[4:7], s25 offen sc1
    v_exp_f32 v68, v68
    v_exp_f32 v69, v69
    v_smfmac_f32_32x32x32_bf16 v[52:67], v[32:35], v[92:99], v8
    ds_read_b128 v[12:15], v3 offset:57344
    v_exp_f32 v70, v70
    s_mov_b64 exec, s[50:51]
    ds_read_b128 v[28:31], v10 offset:56320
    ds_read_b128 v[32:35], v10 offset:56832
    s_mov_b64 exec, -1
    v_exp_f32 v71, v71
    v_exp_f32 v72, v72
    s_waitcnt lgkmcnt(3)
    v_mfma_f32_32x32x16_bf16 v[84:99], v[16:19], v[4:7], v[36:51]
    v_exp_f32 v73, v73
    v_exp_f32 v74, v74
    v_exp_f32 v75, v75
    v_exp_f32 v76, v76
    v_exp_f32 v77, v77
    v_smfmac_f32_32x32x32_bf16 v[52:67], v[20:23], v[68:75], v8
    v_exp_f32 v78, v78
    v_exp_f32 v79, v79
    s_cbranch_vccnz KF_PR41
    s_setprio 0
KF_PR41:
    v_exp_f32 v80, v80
    v_exp_f32 v81, v81
    v_exp_f32 v82, v82
    v_exp_f32 v83, v83
    s_add_u32 s25, s27, 18432
    buffer_load_dwordx4 v[236:239], v3, s[4:7], s25 offen sc1
    s_add_u32 s25, s27, 28672
    s_add_u32 m0, s39, 81920
    s_nop 0
    buffer_load_dwordx4 v3, s[4:7], s25 offen sc1 lds
    v_exp_f32 v84, v84
    v_exp_f32 v85, v85
    v_smfmac_f32_32x32x32_bf16 v[52:67], v[24:27], v[76:83], v8
    ds_read_b128 v[16:19], v3 offset:58368
    v_exp_f32 v86, v86
    s_mov_b64 exec, s[50:51]
    ds_read_b128 v[20:23], v10 offset:57344
    ds_read_b128 v[24:27], v10 offset:57856
    s_mov_b64 exec, -1
    v_exp_f32 v87, v87
    v_exp_f32 v88, v88
    s_waitcnt lgkmcnt(3)
    v_mfma_f32_32x32x16_bf16 v[68:83], v[12:15], v[4:7], v[36:51]
    v_exp_f32 v89, v89
    v_exp_f32 v90, v90
    v_exp_f32 v91, v91
    v_exp_f32 v92, v92
    v_exp_f32 v93, v93
    v_smfmac_f32_32x32x32_bf16 v[52:67], v[28:31], v[84:91], v8
    v_exp_f32 v94, v94
    v_exp_f32 v95, v95
    v_exp_f32 v96, v96
    v_exp_f32 v97, v97
    v_exp_f32 v98, v98
    v_exp_f32 v99, v99
    s_cbranch_vccnz KF_PR42
    s_setprio 1
KF_PR42:
    s_add_u32 s25, s27, 19456
    buffer_load_dwordx4 v[240:243], v3, s[4:7], s25 offen sc1
    v_exp_f32 v68, v68
    v_exp_f32 v69, v69
    v_smfmac_f32_32x32x32_bf16 v[52:67], v[32:35], v[92:99], v8
    ds_read_b128 v[12:15], v3 offset:59392
    v_exp_f32 v70, v70
    s_mov_b64 exec, s[50:51]
    ds_read_b128 v[28:31], v10 offset:58368
    ds_read_b128 v[32:35], v10 offset:58880
    s_mov_b64 exec, -1
    v_exp_f32 v71, v71
    v_exp_f32 v72, v72
    s_waitcnt lgkmcnt(3)
    v_mfma_f32_32x32x16_bf16 v[84:99], v[16:19], v[4:7], v[36:51]
    v_exp_f32 v73, v73
    v_exp_f32 v74, v74
    v_exp_f32 v75, v75
    v_exp_f32 v76, v76
    v_exp_f32 v77, v77
    v_smfmac_f32_32x32x32_bf16 v[52:67], v[20:23], v[68:75], v8
    v_exp_f32 v78, v78
    v_exp_f32 v79, v79
    v_exp_f32 v80, v80
    v_exp_f32 v81, v81
    v_exp_f32 v82, v82
    v_exp_f32 v83, v83
    s_add_u32 s25, s27, 20480
    buffer_load_dwordx4 v[244:247], v3, s[4:7], s25 offen sc1
    v_exp_f32 v84, v84
    v_exp_f32 v85, v85
    v_smfmac_f32_32x32x32_bf16 v[52:67], v[24:27], v[76:83], v8
    ds_read_b128 v[16:19], v3 offset:60416
    v_exp_f32 v86, v86
    s_mov_b64 exec, s[50:51]
    ds_read_b128 v[20:23], v10 offset:59392
    ds_read_b128 v[24:27], v10 offset:59904
    s_mov_b64 exec, -1
    v_exp_f32 v87, v87
    v_exp_f32 v88, v88
    s_waitcnt lgkmcnt(3)
    v_mfma_f32_32x32x16_bf16 v[68:83], v[12:15], v[4:7], v[36:51]
    v_exp_f32 v89, v89
    v_exp_f32 v90, v90
    v_exp_f32 v91, v91
    v_exp_f32 v92, v92
    v_exp_f32 v93, v93
    v_smfmac_f32_32x32x32_bf16 v[52:67], v[28:31], v[84:91], v8
    v_exp_f32 v94, v94
    v_exp_f32 v95, v95
    v_exp_f32 v96, v96
    v_exp_f32 v97, v97
    v_exp_f32 v98, v98
    v_exp_f32 v99, v99
    s_add_u32 s25, s27, 21504
    buffer_load_dwordx4 v[248:251], v3, s[4:7], s25 offen sc1
    v_exp_f32 v68, v68
    v_exp_f32 v69, v69
    v_smfmac_f32_32x32x32_bf16 v[52:67], v[32:35], v[92:99], v8
    ds_read_b128 v[12:15], v3 offset:61440
    v_exp_f32 v70, v70
    s_mov_b64 exec, s[50:51]
    ds_read_b128 v[28:31], v10 offset:60416
    ds_read_b128 v[32:35], v10 offset:60928
    s_mov_b64 exec, -1
    v_exp_f32 v71, v71
    v_exp_f32 v72, v72
    s_waitcnt lgkmcnt(3)
    v_mfma_f32_32x32x16_bf16 v[84:99], v[16:19], v[4:7], v[36:51]
    v_exp_f32 v73, v73
    v_exp_f32 v74, v74
    v_exp_f32 v75, v75
    v_exp_f32 v76, v76
    v_exp_f32 v77, v77
    v_smfmac_f32_32x32x32_bf16 v[52:67], v[20:23], v[68:75], v8
    v_exp_f32 v78, v78
    v_exp_f32 v79, v79
    s_cbranch_vccnz KF_PR43
    s_setprio 0
KF_PR43:
    v_exp_f32 v80, v80
    v_exp_f32 v81, v81
    v_exp_f32 v82, v82
    v_exp_f32 v83, v83
    s_add_u32 s25, s27, 22528
    buffer_load_dwordx4 v[252:255], v3, s[4:7], s25 offen sc1
    v_exp_f32 v84, v84
    v_exp_f32 v85, v85
    v_smfmac_f32_32x32x32_bf16 v[52:67], v[24:27], v[76:83], v8
    ds_read_b128 v[16:19], v3 offset:62464
    v_exp_f32 v86, v86
    s_mov_b64 exec, s[50:51]
    ds_read_b128 v[20:23], v10 offset:61440
    ds_read_b128 v[24:27], v10 offset:61952
    s_mov_b64 exec, -1
    v_exp_f32 v87, v87
    v_exp_f32 v88, v88
    s_waitcnt lgkmcnt(3)
    v_mfma_f32_32x32x16_bf16 v[68:83], v[12:15], v[4:7], v[36:51]
    v_exp_f32 v89, v89
    v_exp_f32 v90, v90
    v_exp_f32 v91, v91
    v_exp_f32 v92, v92
    v_exp_f32 v93, v93
    v_smfmac_f32_32x32x32_bf16 v[52:67], v[28:31], v[84:91], v8
    v_exp_f32 v94, v94
    v_exp_f32 v95, v95
    v_exp_f32 v96, v96
    v_exp_f32 v97, v97
    v_exp_f32 v98, v98
    v_exp_f32 v99, v99
    s_cbranch_vccnz KF_PR44
    s_setprio 1
KF_PR44:
    v_exp_f32 v68, v68
    v_exp_f32 v69, v69
    v_smfmac_f32_32x32x32_bf16 v[52:67], v[32:35], v[92:99], v8
    ds_read_b128 v[12:15], v3 offset:63488
    v_exp_f32 v70, v70
    s_mov_b64 exec, s[50:51]
    ds_read_b128 v[28:31], v10 offset:62464
    ds_read_b128 v[32:35], v10 offset:62976
    s_mov_b64 exec, -1
    v_exp_f32 v71, v71
    v_exp_f32 v72, v72
    s_waitcnt lgkmcnt(3)
    v_mfma_f32_32x32x16_bf16 v[84:99], v[16:19], v[4:7], v[36:51]
    v_exp_f32 v73, v73
    v_exp_f32 v74, v74
    v_exp_f32 v75, v75
    v_exp_f32 v76, v76
    v_exp_f32 v77, v77
    v_smfmac_f32_32x32x32_bf16 v[52:67], v[20:23], v[68:75], v8
    v_exp_f32 v78, v78
    v_exp_f32 v79, v79
    v_exp_f32 v80, v80
    v_exp_f32 v81, v81
    v_exp_f32 v82, v82
    v_exp_f32 v83, v83
    v_exp_f32 v84, v84
    v_exp_f32 v85, v85
    v_smfmac_f32_32x32x32_bf16 v[52:67], v[24:27], v[76:83], v8
    ds_read_b128 v[16:19], v3 offset:64512
    v_exp_f32 v86, v86
    s_mov_b64 exec, s[50:51]
    ds_read_b128 v[20:23], v10 offset:63488
    ds_read_b128 v[24:27], v10 offset:64000
    s_mov_b64 exec, -1
    v_exp_f32 v87, v87
    v_exp_f32 v88, v88
    s_waitcnt lgkmcnt(3)
    v_mfma_f32_32x32x16_bf16 v[68:83], v[12:15], v[4:7], v[36:51]
    v_exp_f32 v89, v89
    v_exp_f32 v90, v90
    v_exp_f32 v91, v91
    v_exp_f32 v92, v92
    v_exp_f32 v93, v93
    v_smfmac_f32_32x32x32_bf16 v[52:67], v[28:31], v[84:91], v8
    v_exp_f32 v94, v94
    v_exp_f32 v95, v95
    v_exp_f32 v96, v96
    v_exp_f32 v97, v97
    v_exp_f32 v98, v98
    v_exp_f32 v99, v99
    v_exp_f32 v68, v68
    v_exp_f32 v69, v69
    v_smfmac_f32_32x32x32_bf16 v[52:67], v[32:35], v[92:99], v8
    v_exp_f32 v70, v70
    s_mov_b64 exec, s[50:51]
    ds_read_b128 v[28:31], v10 offset:64512
    ds_read_b128 v[32:35], v10 offset:65024
    s_mov_b64 exec, -1
    v_exp_f32 v71, v71
    v_exp_f32 v72, v72
    s_waitcnt lgkmcnt(2)
    v_mfma_f32_32x32x16_bf16 v[84:99], v[16:19], v[4:7], v[36:51]
    v_exp_f32 v73, v73
    v_exp_f32 v74, v74
    v_exp_f32 v75, v75
    v_exp_f32 v76, v76
    v_exp_f32 v77, v77
    v_smfmac_f32_32x32x32_bf16 v[52:67], v[20:23], v[68:75], v8
    v_exp_f32 v78, v78
    v_exp_f32 v79, v79
    s_cbranch_vccnz KF_PR45
    s_setprio 0
KF_PR45:
    v_exp_f32 v80, v80
    v_exp_f32 v81, v81
    v_exp_f32 v82, v82
    v_exp_f32 v83, v83
    v_exp_f32 v84, v84
    v_exp_f32 v85, v85
    v_smfmac_f32_32x32x32_bf16 v[52:67], v[24:27], v[76:83], v8
    v_exp_f32 v86, v86
    v_exp_f32 v87, v87
    v_exp_f32 v88, v88
    s_waitcnt lgkmcnt(0)
    v_exp_f32 v89, v89
    v_exp_f32 v90, v90
    v_exp_f32 v91, v91
    v_exp_f32 v92, v92
    v_exp_f32 v93, v93
    v_smfmac_f32_32x32x32_bf16 v[52:67], v[28:31], v[84:91], v8
    v_exp_f32 v94, v94
    v_exp_f32 v95, v95
    v_exp_f32 v96, v96
    v_exp_f32 v97, v97
    v_exp_f32 v98, v98
    v_exp_f32 v99, v99
    s_nop 1
    v_smfmac_f32_32x32x32_bf16 v[52:67], v[32:35], v[92:99], v8
    s_mov_b32 s56, 0x76800000
    s_nop 10
    v_add_f32 v11, v60, abs(v52)
    v_add_f32 v11, v11, abs(v53)
    v_add_f32 v11, v11, abs(v54)
    v_add_f32 v11, v11, abs(v55)
    v_add_f32 v11, v11, abs(v56)
    v_add_f32 v11, v11, abs(v57)
    v_add_f32 v11, v11, abs(v58)
    v_add_f32 v11, v11, abs(v59)
    v_cmp_nle_f32 vcc, v11, s56
    s_cbranch_vccnz KF_FALLBACK
KF_FIN:
    v_rcp_f32 v11, v60
    s_nop 0
    v_mul_f32 v52, v52, v11
    v_mul_f32 v53, v53, v11
    v_mul_f32 v54, v54, v11
    v_mul_f32 v55, v55, v11
    v_mul_f32 v56, v56, v11
    v_mul_f32 v57, v57, v11
    v_mul_f32 v58, v58, v11
    v_mul_f32 v59, v59, v11
    v_cvt_pk_bf16_f32 v16, v52, v53
    v_cvt_pk_bf16_f32 v17, v54, v55
    v_cvt_pk_bf16_f32 v18, v56, v57
    v_cvt_pk_bf16_f32 v19, v58, v59
    s_waitcnt vmcnt(0)
    buffer_store_dwordx4 v[16:19], v3, s[4:7], s28 offen sc1
    s_nop 1
    v_mov_b32 v19, 1
    s_mov_b64 exec, 1
    ds_add_rtn_u32 v52, v0, v19 offset:16
    s_waitcnt lgkmcnt(0)
    v_readfirstlane_b32 s56, v52
    s_nop 0
    s_cmp_lg_u32 s56, 7
    s_cbranch_scc1 KF_TS46_M
    v_mov_b32 v52, 1
    buffer_atomic_add v52, off, s[4:7], s55 offset:0 sc0 sc1
KF_TS46_M:
    s_mov_b64 exec, -1
    s_and_b32 s48, s3, 1
    s_lshl_b32 s33, s48, 16
    s_lshl_b32 s48, s48, 1
    s_add_u32 s48, s48, s24
    s_lshl_b32 s48, s48, 2
    s_lshr_b32 s32, s3, 1
    s_add_u32 s48, s48, s32
    s_lshl_b32 s48, s48, 13
    s_add_u32 s48, s48, 0xa00000
    s_lshl_b32 s32, s32, 12
    s_add_u32 s33, s33, s32
    s_add_u32 s33, s33, 0x8000
    v_add_u32 v16, s33, v3
    s_lshr_b32 s32, s3, 2
    s_lshl_b32 s32, s32, 16
    s_bfe_u32 s33, s3, 0x10001
    s_lshl_b32 s33, s33, 14
    s_add_u32 s32, s32, s33
    s_and_b32 s33, s3, 1
    s_lshl_b32 s33, s33, 11
    s_add_u32 s32, s32, s33
    s_add_u32 s32, s32, 0x8000
    v_add_u32 v18, s32, v3
    v_mov_b32 v17, v9
    v_add_u32 v84, s54, v3
    ds_read_b128 v[4:7], v84
    ds_read_b128 v[8:11], v17
    ds_read_b128 v[12:15], v17 offset:16
    s_mov_b32 s52, 0
    s_cmp_lg_u32 s56, 7
    s_cbranch_scc1 KF_TS46
    s_mov_b64 exec, 1
    s_waitcnt vmcnt(0)
    v_readfirstlane_b32 s35, v52
    s_nop 0
    s_cmp_ge_u32 s35, 15
    s_cbranch_scc1 KF_TS46
    s_mov_b32 s36, 0
KF_TS46_L:
    v_mov_b32 v52, 0
    buffer_atomic_add v52, off, s[4:7], s55 offset:0 sc0 sc1
    s_add_u32 s36, s36, 1
    s_waitcnt vmcnt(0)
    v_readfirstlane_b32 s35, v52
    s_cmp_ge_u32 s36, 65536
    s_cbranch_scc1 KF_TS46
    s_cmp_lt_u32 s35, 16
    s_cbranch_scc1 KF_TS46_L
KF_TS46:
    s_mov_b64 exec, -1
    s_waitcnt lgkmcnt(0)
    s_barrier
    buffer_load_dwordx4 v[20:23], v3, s[4:7], s48 offen offset:0 sc1
    buffer_load_dwordx4 v[24:27], v3, s[4:7], s48 offen offset:1024 sc1
    buffer_load_dwordx4 v[28:31], v3, s[4:7], s48 offen offset:2048 sc1
    buffer_load_dwordx4 v[32:35], v3, s[4:7], s48 offen offset:3072 sc1
    s_add_u32 s47, s48, 4096
    buffer_load_dwordx4 v[36:39], v3, s[4:7], s47 offen offset:0 sc1
    buffer_load_dwordx4 v[40:43], v3, s[4:7], s47 offen offset:1024 sc1
    buffer_load_dwordx4 v[44:47], v3, s[4:7], s47 offen offset:2048 sc1
    buffer_load_dwordx4 v[48:51], v3, s[4:7], s47 offen offset:3072 sc1
    s_add_u32 s25, s27, 30720
    buffer_load_dwordx4 v[96:99], v3, s[4:7], s25 offen sc1
KF_WO:
    s_waitcnt vmcnt(8)
    v_mfma_f32_32x32x16_bf16 v[52:67], v[100:103], v[20:23], 0
    v_mfma_f32_32x32x16_bf16 v[68:83], v[132:135], v[20:23], 0
    s_waitcnt vmcnt(7)
    v_mfma_f32_32x32x16_bf16 v[52:67], v[104:107], v[24:27], v[52:67]
    v_mfma_f32_32x32x16_bf16 v[68:83], v[136:139], v[24:27], v[68:83]
    s_waitcnt vmcnt(6)
    v_mfma_f32_32x32x16_bf16 v[52:67], v[108:111], v[28:31], v[52:67]
    v_mfma_f32_32x32x16_bf16 v[68:83], v[140:143], v[28:31], v[68:83]
    s_waitcnt vmcnt(5)
    v_mfma_f32_32x32x16_bf16 v[52:67], v[112:115], v[32:35], v[52:67]
    v_mfma_f32_32x32x16_bf16 v[68:83], v[144:147], v[32:35], v[68:83]
    s_waitcnt vmcnt(4)
    v_mfma_f32_32x32x16_bf16 v[52:67], v[116:119], v[36:39], v[52:67]
    v_mfma_f32_32x32x16_bf16 v[68:83], v[148:151], v[36:39], v[68:83]
    s_waitcnt vmcnt(3)
    v_mfma_f32_32x32x16_bf16 v[52:67], v[120:123], v[40:43], v[52:67]
    v_mfma_f32_32x32x16_bf16 v[68:83], v[152:155], v[40:43], v[68:83]
    s_waitcnt vmcnt(2)
    v_mfma_f32_32x32x16_bf16 v[52:67], v[124:127], v[44:47], v[52:67]
    v_mfma_f32_32x32x16_bf16 v[68:83], v[156:159], v[44:47], v[68:83]
    s_waitcnt vmcnt(1)
    v_mfma_f32_32x32x16_bf16 v[52:67], v[128:131], v[48:51], v[52:67]
    v_mfma_f32_32x32x16_bf16 v[68:83], v[160:163], v[48:51], v[68:83]
    s_lshl_b32 s25, s29, 5
    s_add_u32 s25, s25, s49
    s_lshl_b32 s33, s24, 3
    s_add_u32 s33, s33, s20
    s_lshl_b32 s33, s33, 8
    s_add_u32 s33, s33, 0xe00000
    s_lshl_b32 s25, s25, 10
    s_add_u32 s25, s25, 0xc00000
    s_mov_b32 s32, 0x3f803f80
    s_nop 1
    v_cmp_u_f32 vcc, v52, v52
    s_cbranch_vccnz KF_WO_SLOW
KF_WO_OK:
    ds_write_b128 v16, v[52:55] offset:0
    ds_write_b128 v16, v[56:59] offset:1024
    ds_write_b128 v16, v[60:63] offset:2048
    ds_write_b128 v16, v[64:67] offset:3072
    ds_write_b128 v16, v[68:71] offset:16384
    ds_write_b128 v16, v[72:75] offset:17408
    ds_write_b128 v16, v[76:79] offset:18432
    ds_write_b128 v16, v[80:83] offset:19456
    s_waitcnt lgkmcnt(0)
    s_barrier
    ds_read_b128 v[20:23], v18 offset:0
    ds_read_b128 v[24:27], v18 offset:1024
    ds_read_b128 v[28:31], v18 offset:4096
    ds_read_b128 v[32:35], v18 offset:5120
    ds_read_b128 v[36:39], v18 offset:8192
    ds_read_b128 v[40:43], v18 offset:9216
    ds_read_b128 v[44:47], v18 offset:12288
    ds_read_b128 v[48:51], v18 offset:13312
    v_lshlrev_b32 v52, 16, v4
    v_and_b32 v53, 0xffff0000, v4
    v_lshlrev_b32 v54, 16, v5
    v_and_b32 v55, 0xffff0000, v5
    v_lshlrev_b32 v56, 16, v6
    v_and_b32 v57, 0xffff0000, v6
    v_lshlrev_b32 v58, 16, v7
    v_and_b32 v59, 0xffff0000, v7
    s_waitcnt lgkmcnt(4)
    v_add_f32 v20, v20, v28
    v_add_f32 v21, v21, v29
    v_add_f32 v22, v22, v30
    v_add_f32 v23, v23, v31
    v_add_f32 v24, v24, v32
    v_add_f32 v25, v25, v33
    v_add_f32 v26, v26, v34
    v_add_f32 v27, v27, v35
    s_waitcnt lgkmcnt(2)
    v_add_f32 v20, v20, v36
    v_add_f32 v21, v21, v37
    v_add_f32 v22, v22, v38
    v_add_f32 v23, v23, v39
    v_add_f32 v24, v24, v40
    v_add_f32 v25, v25, v41
    v_add_f32 v26, v26, v42
    v_add_f32 v27, v27, v43
    s_waitcnt lgkmcnt(0)
    v_add_f32 v20, v20, v44
    v_add_f32 v21, v21, v45
    v_add_f32 v22, v22, v46
    v_add_f32 v23, v23, v47
    v_add_f32 v24, v24, v48
    v_add_f32 v25, v25, v49
    v_add_f32 v26, v26, v50
    v_add_f32 v27, v27, v51
    v_fmac_f32 v52, v8, v20
    v_fmac_f32 v53, v9, v21
    v_fmac_f32 v54, v10, v22
    v_fmac_f32 v55, v11, v23
    v_fmac_f32 v56, v12, v24
    v_fmac_f32 v57, v13, v25
    v_fmac_f32 v58, v14, v26
    v_fmac_f32 v59, v15, v27
    v_cvt_pk_bf16_f32 v4, v52, v53
    v_cvt_pk_bf16_f32 v5, v54, v55
    v_cvt_pk_bf16_f32 v6, v56, v57
    v_cvt_pk_bf16_f32 v7, v58, v59
    buffer_store_dwordx4 v[4:7], v3, s[4:7], s25 offen sc1
    v_mov_b32 v53, 0
    v_mov_b32 v54, 0
    v_dot2_f32_bf16 v53, v4, s32, v53
    v_dot2_f32_bf16 v54, v4, v4, v54
    v_dot2_f32_bf16 v53, v5, s32, v53
    v_dot2_f32_bf16 v54, v5, v5, v54
    v_dot2_f32_bf16 v53, v6, s32, v53
    v_dot2_f32_bf16 v54, v6, v6, v54
    v_dot2_f32_bf16 v53, v7, s32, v53
    v_dot2_f32_bf16 v54, v7, v7, v54
    s_nop 2
    v_permlane32_swap_b32 v53, v54
    v_add_f32 v53, v53, v54
    v_lshlrev_b32 v54, 2, v2
    s_lshl_b32 s25, s3, 8
    v_add_u32 v55, 161792, v54
    v_add_u32 v52, s25, v55
    ds_write_b32 v52, v53
    s_mov_b64 exec, 1
    ds_add_rtn_u32 v64, v0, v19 offset:20
    s_waitcnt lgkmcnt(0)
    v_readfirstlane_b32 s56, v64
    s_nop 0
    s_cmp_lg_u32 s56, 7
    s_cbranch_scc1 KF_TS48_M
    s_mov_b64 exec, -1
    ds_read_b32 v20, v55 offset:0
    ds_read_b32 v21, v55 offset:256
    ds_read_b32 v22, v55 offset:512
    ds_read_b32 v23, v55 offset:768
    ds_read_b32 v24, v55 offset:1024
    ds_read_b32 v25, v55 offset:1280
    ds_read_b32 v26, v55 offset:1536
    ds_read_b32 v27, v55 offset:1792
    s_add_u32 s25, s33, 4096
    s_waitcnt lgkmcnt(0)
    v_add_f32 v20, v20, v21
    v_add_f32 v22, v22, v23
    v_add_f32 v24, v24, v25
    v_add_f32 v26, v26, v27
    v_add_f32 v20, v20, v22
    v_add_f32 v24, v24, v26
    buffer_store_dword v20, v54, s[4:7], s33 offen sc1
    buffer_store_dword v24, v54, s[4:7], s25 offen sc1
    s_mov_b64 exec, 1
    v_mov_b32 v64, 1
    buffer_atomic_add v64, off, s[4:7], s55 offset:128 sc0 sc1
KF_TS48_M:
    s_mov_b64 exec, -1
    v_add_u32 v56, s39, v3
    v_add_u32 v57, 0x10000, v56
    v_add_u32 v58, 0x20000, v56
    ds_read_b128 v[68:71], v56 offset:0
    ds_read_b128 v[72:75], v56 offset:8192
    ds_read_b128 v[76:79], v56 offset:16384
    ds_read_b128 v[80:83], v57 offset:0
    ds_read_b128 v[84:87], v57 offset:8192
    ds_read_b128 v[88:91], v57 offset:16384
    ds_read_b128 v[92:95], v58 offset:0
    ds_read_b128 v[156:159], v58 offset:12288
    ds_read_b128 v[160:163], v58 offset:20480
    s_lshl_b32 s48, s23, 17
    s_add_u32 s48, s48, 0xc00000
    s_lshl_b32 s32, s3, 12
    s_add_u32 s46, s48, s32
    v_and_b32 v11, 31, v2
    v_lshlrev_b32 v11, 4, v11
    v_add_u32 v11, 135168, v11
    v_add_u32 v65, 33792, v3
    v_add_u32 v66, 67584, v3
    v_add_u32 v67, 101376, v3
    s_cmp_lg_u32 s56, 7
    s_cbranch_scc1 KF_TS48
    s_mov_b64 exec, 1
    s_waitcnt vmcnt(0)
    v_readfirstlane_b32 s35, v64
    s_nop 0
    s_cmp_ge_u32 s35, 15
    s_cbranch_scc1 KF_TS48
    s_mov_b32 s36, 0
KF_TS48_L:
    v_mov_b32 v64, 0
    buffer_atomic_add v64, off, s[4:7], s55 offset:128 sc0 sc1
    s_add_u32 s36, s36, 1
    s_waitcnt vmcnt(0)
    v_readfirstlane_b32 s35, v64
    s_cmp_ge_u32 s36, 65536
    s_cbranch_scc1 KF_TS48
    s_cmp_lt_u32 s35, 16
    s_cbranch_scc1 KF_TS48_L
KF_TS48:
    s_mov_b64 exec, -1
    s_waitcnt lgkmcnt(0)
    s_barrier
    s_add_u32 m0, s32, 0
    s_add_u32 s25, s46, 0
    buffer_load_dwordx4 v3, s[4:7], s25 offen offset:0 sc1 lds
    buffer_load_dwordx4 v3, s[4:7], s25 offen offset:1024 sc1 lds
    buffer_load_dwordx4 v3, s[4:7], s25 offen offset:2048 sc1 lds
    buffer_load_dwordx4 v3, s[4:7], s25 offen offset:3072 sc1 lds
    s_cmp_eq_u32 s3, 7
    s_cbranch_scc1 KF_STATS
    s_add_u32 m0, s32, 33792
    s_add_u32 s25, s46, 32768
    buffer_load_dwordx4 v3, s[4:7], s25 offen offset:0 sc1 lds
    buffer_load_dwordx4 v3, s[4:7], s25 offen offset:1024 sc1 lds
    buffer_load_dwordx4 v3, s[4:7], s25 offen offset:2048 sc1 lds
    buffer_load_dwordx4 v3, s[4:7], s25 offen offset:3072 sc1 lds
    s_waitcnt vmcnt(4)
    s_barrier
    s_lshl_b32 s33, s23, 2
    s_add_u32 s33, s33, s3
    s_lshl_b32 s33, s33, 11
    s_add_u32 s33, s33, 0xe00000
    s_cmp_ge_u32 s3, 4
    s_cbranch_scc1 KF_NSL
    buffer_load_dwordx4 v[116:119], v3, s[4:7], s33 offen offset:0 sc1
    buffer_load_dwordx4 v[120:123], v3, s[4:7], s33 offen offset:1024 sc1
KF_NSL:
    ds_read_b128 v[20:23], v3 offset:0
    ds_read_b128 v[24:27], v3 offset:1024
    ds_read_b128 v[28:31], v3 offset:2048
    ds_read_b128 v[32:35], v3 offset:3072
    ds_read_b128 v[36:39], v3 offset:4096
    ds_read_b128 v[40:43], v3 offset:5120
    ds_read_b128 v[44:47], v3 offset:6144
    ds_read_b128 v[48:51], v3 offset:7168
    s_waitcnt lgkmcnt(7)
    v_mfma_f32_32x32x16_bf16 v[100:115], v[164:167], v[20:23], 0
    ds_read_b128 v[20:23], v3 offset:8192
    s_add_u32 m0, s32, 67584
    s_add_u32 s25, s46, 65536
    buffer_load_dwordx4 v3, s[4:7], s25 offen offset:0 sc1 lds
    s_waitcnt lgkmcnt(7)
    v_mfma_f32_32x32x16_bf16 v[100:115], v[168:171], v[24:27], v[100:115]
    ds_read_b128 v[24:27], v3 offset:9216
    s_waitcnt lgkmcnt(7)
    v_mfma_f32_32x32x16_bf16 v[100:115], v[172:175], v[28:31], v[100:115]
    ds_read_b128 v[28:31], v3 offset:10240
    s_add_u32 m0, s32, 67584
    s_add_u32 s25, s46, 65536
    buffer_load_dwordx4 v3, s[4:7], s25 offen offset:1024 sc1 lds
    s_waitcnt lgkmcnt(7)
    v_mfma_f32_32x32x16_bf16 v[100:115], v[176:179], v[32:35], v[100:115]
    ds_read_b128 v[32:35], v3 offset:11264
    s_waitcnt lgkmcnt(7)
    v_mfma_f32_32x32x16_bf16 v[100:115], v[180:183], v[36:39], v[100:115]
    ds_read_b128 v[36:39], v3 offset:12288
    s_add_u32 m0, s32, 67584
    s_add_u32 s25, s46, 65536
    buffer_load_dwordx4 v3, s[4:7], s25 offen offset:2048 sc1 lds
    s_waitcnt lgkmcnt(7)
    v_mfma_f32_32x32x16_bf16 v[100:115], v[184:187], v[40:43], v[100:115]
    ds_read_b128 v[40:43], v3 offset:13312
    s_waitcnt lgkmcnt(7)
    v_mfma_f32_32x32x16_bf16 v[100:115], v[188:191], v[44:47], v[100:115]
    ds_read_b128 v[44:47], v3 offset:14336
    s_add_u32 m0, s32, 67584
    s_add_u32 s25, s46, 65536
    buffer_load_dwordx4 v3, s[4:7], s25 offen offset:3072 sc1 lds
    s_waitcnt lgkmcnt(7)
    v_mfma_f32_32x32x16_bf16 v[100:115], v[192:195], v[48:51], v[100:115]
    ds_read_b128 v[48:51], v3 offset:15360
    s_waitcnt lgkmcnt(7)
    v_mfma_f32_32x32x16_bf16 v[100:115], v[196:199], v[20:23], v[100:115]
    ds_read_b128 v[20:23], v3 offset:16384
    s_add_u32 m0, s32, 101376
    s_add_u32 s25, s46, 98304
    buffer_load_dwordx4 v3, s[4:7], s25 offen offset:0 sc1 lds
    s_waitcnt lgkmcnt(7)
    v_mfma_f32_32x32x16_bf16 v[100:115], v[200:203], v[24:27], v[100:115]
    ds_read_b128 v[24:27], v3 offset:17408
    s_waitcnt lgkmcnt(7)
    v_mfma_f32_32x32x16_bf16 v[100:115], v[204:207], v[28:31], v[100:115]
    ds_read_b128 v[28:31], v3 offset:18432
    s_add_u32 m0, s32, 101376
    s_add_u32 s25, s46, 98304
    buffer_load_dwordx4 v3, s[4:7], s25 offen offset:1024 sc1 lds
    s_waitcnt lgkmcnt(7)
    v_mfma_f32_32x32x16_bf16 v[100:115], v[208:211], v[32:35], v[100:115]
    ds_read_b128 v[32:35], v3 offset:19456
    s_waitcnt lgkmcnt(7)
    v_mfma_f32_32x32x16_bf16 v[100:115], v[212:215], v[36:39], v[100:115]
    ds_read_b128 v[36:39], v3 offset:20480
    s_add_u32 m0, s32, 101376
    s_add_u32 s25, s46, 98304
    buffer_load_dwordx4 v3, s[4:7], s25 offen offset:2048 sc1 lds
    s_waitcnt lgkmcnt(7)
    v_mfma_f32_32x32x16_bf16 v[100:115], v[216:219], v[40:43], v[100:115]
    ds_read_b128 v[40:43], v3 offset:21504
    s_waitcnt lgkmcnt(7)
    v_mfma_f32_32x32x16_bf16 v[100:115], v[220:223], v[44:47], v[100:115]
    ds_read_b128 v[44:47], v3 offset:22528
    s_add_u32 m0, s32, 101376
    s_add_u32 s25, s46, 98304
    buffer_load_dwordx4 v3, s[4:7], s25 offen offset:3072 sc1 lds
    s_waitcnt lgkmcnt(7)
    v_mfma_f32_32x32x16_bf16 v[100:115], v[224:227], v[48:51], v[100:115]
    ds_read_b128 v[48:51], v3 offset:23552
    s_waitcnt lgkmcnt(7)
    v_mfma_f32_32x32x16_bf16 v[100:115], v[228:231], v[20:23], v[100:115]
    ds_read_b128 v[20:23], v3 offset:24576
    s_waitcnt lgkmcnt(7)
    v_mfma_f32_32x32x16_bf16 v[100:115], v[232:235], v[24:27], v[100:115]
    ds_read_b128 v[24:27], v3 offset:25600
    s_waitcnt lgkmcnt(7)
    v_mfma_f32_32x32x16_bf16 v[100:115], v[236:239], v[28:31], v[100:115]
    ds_read_b128 v[28:31], v3 offset:26624
    s_waitcnt lgkmcnt(7)
    v_mfma_f32_32x32x16_bf16 v[100:115], v[240:243], v[32:35], v[100:115]
    ds_read_b128 v[32:35], v3 offset:27648
    s_waitcnt lgkmcnt(7)
    v_mfma_f32_32x32x16_bf16 v[100:115], v[244:247], v[36:39], v[100:115]
    ds_read_b128 v[36:39], v3 offset:28672
    s_waitcnt lgkmcnt(7)
    v_mfma_f32_32x32x16_bf16 v[100:115], v[248:251], v[40:43], v[100:115]
    ds_read_b128 v[40:43], v3 offset:29696
    s_waitcnt lgkmcnt(7)
    v_mfma_f32_32x32x16_bf16 v[100:115], v[252:255], v[44:47], v[100:115]
    ds_read_b128 v[44:47], v3 offset:30720
    s_waitcnt lgkmcnt(7)
    v_mfma_f32_32x32x16_bf16 v[100:115], v[68:71], v[48:51], v[100:115]
    ds_read_b128 v[48:51], v3 offset:31744
    s_waitcnt lgkmcnt(7)
    v_mfma_f32_32x32x16_bf16 v[100:115], v[72:75], v[20:23], v[100:115]
    s_waitcnt lgkmcnt(6)
    v_mfma_f32_32x32x16_bf16 v[100:115], v[76:79], v[24:27], v[100:115]
    s_waitcnt lgkmcnt(5)
    v_mfma_f32_32x32x16_bf16 v[100:115], v[80:83], v[28:31], v[100:115]
    s_waitcnt lgkmcnt(4)
    v_mfma_f32_32x32x16_bf16 v[100:115], v[84:87], v[32:35], v[100:115]
    s_waitcnt lgkmcnt(3)
    v_mfma_f32_32x32x16_bf16 v[100:115], v[88:91], v[36:39], v[100:115]
    s_waitcnt lgkmcnt(2)
    v_mfma_f32_32x32x16_bf16 v[100:115], v[92:95], v[40:43], v[100:115]
    s_waitcnt lgkmcnt(1)
    v_mfma_f32_32x32x16_bf16 v[100:115], v[96:99], v[44:47], v[100:115]
    s_waitcnt lgkmcnt(0)
    v_mfma_f32_32x32x16_bf16 v[100:115], v[156:159], v[48:51], v[100:115]
    s_cmp_ge_u32 s3, 4
    s_cbranch_scc1 KF_NST
    s_lshl_b32 s25, s3, 10
    s_add_u32 s25, s25, 137216
    v_add_u32 v52, s25, v3
    v_and_b32 v53, 31, v2
    v_lshl_add_u32 v53, v53, 2, s25
    s_mul_i32 s25, s3, 33792
    s_add_u32 s25, s25, 32768
    v_add_u32 v54, s25, v3
    s_lshl_b32 s25, s3, 9
    v_add_u32 v55, s25, v11
    s_mov_b32 s36, 0
    s_waitcnt vmcnt(8)
KF_ST_A:
    v_add_f32 v116, v116, v120
    v_add_f32 v117, v117, v121
    v_add_f32 v118, v118, v122
    v_add_f32 v119, v119, v123
    ds_write_b128 v52, v[116:119]
    v_add_f32 v56, v116, v117
    v_add_f32 v57, v118, v119
    v_cmp_u_f32 vcc, v56, v57
    s_cbranch_vccnz KF_ST_R
KF_ST_C:
    ds_read_b32 v120, v53 offset:0
    ds_read_b32 v121, v53 offset:128
    ds_read_b32 v122, v53 offset:256
    ds_read_b32 v123, v53 offset:384
    ds_read_b32 v124, v53 offset:512
    ds_read_b32 v125, v53 offset:640
    ds_read_b32 v126, v53 offset:768
    ds_read_b32 v127, v53 offset:896
    s_waitcnt lgkmcnt(0)
    v_add_f32 v120, v120, v122
    v_add_f32 v121, v121, v123
    v_add_f32 v124, v124, v126
    v_add_f32 v125, v125, v127
    v_add_f32 v120, v120, v124
    v_add_f32 v121, v121, v125
    v_mul_f32 v120, 0x3b000000, v120
    v_mul_f32 v121, 0x3b000000, v121
    v_fma_f32 v121, -v120, v120, v121
    v_max_f32 v121, 0, v121
    v_cvt_pk_bf16_f32 v121, v121, v121
    v_lshlrev_b32 v121, 16, v121
    v_add_f32 v121, 0x3727c5ac, v121
    v_cvt_pk_bf16_f32 v121, v121, v121
    v_lshlrev_b32 v121, 16, v121
    v_sqrt_f32 v121, v121
    s_nop 0
    v_cvt_pk_bf16_f32 v121, v121, v121
    v_lshlrev_b32 v121, 16, v121
    v_sub_f32 v120, 0, v120
    v_cvt_pk_bf16_f32 v128, v120, v120
    v_cvt_pk_bf16_f32 v129, v121, v121
    v_mov_b32 v130, v128
    v_mov_b32 v131, v129
    ds_write_b128 v54, v[128:131]
    v_rcp_f32 v122, v121
    v_mul_f32 v132, v121, v121
    v_mul_f32 v133, 0xc0135761, v122
    v_mul_f32 v134, v122, v122
    v_mul_f32 v134, v134, v133
    v_mul_f32 v134, 0x3d372713, v134
    ds_write_b128 v55, v[132:135]
    s_waitcnt lgkmcnt(0)
KF_NST:
    s_waitcnt vmcnt(0)
    s_barrier
    s_cmp_lt_u32 s3, 4
    s_cbranch_scc1 KF_GP
    s_setprio 1
KF_GP:
    ds_read_b96 v[8:10], v11
    ds_read_b96 v[12:14], v11 offset:512
    ds_read_b128 v[20:23], v3 offset:32768
    ds_read_b128 v[24:27], v65 offset:0
    ds_read_b128 v[28:31], v65 offset:1024
    ds_read_b128 v[32:35], v65 offset:2048
    ds_read_b128 v[36:39], v65 offset:3072
    ds_read_b128 v[40:43], v65 offset:4096
    ds_read_b128 v[44:47], v65 offset:5120
    ds_read_b128 v[48:51], v65 offset:6144
    s_waitcnt lgkmcnt(7)
    v_mfma_f32_32x32x16_bf16 v[100:115], v[160:163], v[20:23], v[100:115]
    ds_read_b128 v[20:23], v65 offset:7168
    s_waitcnt lgkmcnt(7)
    v_mfma_f32_32x32x16_bf16 v[116:131], v[164:167], v[24:27], 0
    ds_read_b128 v[24:27], v65 offset:8192
    s_waitcnt lgkmcnt(7)
    v_mfma_f32_32x32x16_bf16 v[116:131], v[168:171], v[28:31], v[116:131]
    ds_read_b128 v[28:31], v65 offset:9216
    s_waitcnt lgkmcnt(7)
    v_mfma_f32_32x32x16_bf16 v[116:131], v[172:175], v[32:35], v[116:131]
    ds_read_b128 v[32:35], v65 offset:10240
    s_waitcnt lgkmcnt(7)
    v_mfma_f32_32x32x16_bf16 v[116:131], v[176:179], v[36:39], v[116:131]
    ds_read_b128 v[36:39], v65 offset:11264
    s_waitcnt lgkmcnt(7)
    v_mfma_f32_32x32x16_bf16 v[116:131], v[180:183], v[40:43], v[116:131]
    ds_read_b128 v[40:43], v65 offset:12288
    v_cmp_u_f32 vcc, v100, v100
    s_cbranch_vccnz KF_GS0
KF_GS0_R:
    v_mul_f32 v132, v100, v100
    v_mul_f32 v133, v101, v101
    v_mul_f32 v134, v102, v102
    s_waitcnt lgkmcnt(7)
    v_mfma_f32_32x32x16_bf16 v[116:131], v[184:187], v[44:47], v[116:131]
    ds_read_b128 v[44:47], v65 offset:13312
    v_mul_f32 v135, v103, v103
    v_mul_f32 v136, v104, v104
    v_mul_f32 v137, v105, v105
    v_mul_f32 v138, v106, v106
    s_waitcnt lgkmcnt(7)
    v_mfma_f32_32x32x16_bf16 v[116:131], v[188:191], v[48:51], v[116:131]
    ds_read_b128 v[48:51], v65 offset:14336
    v_mul_f32 v139, v107, v107
    v_fma_f32 v132, v132, v10, v9
    v_fma_f32 v133, v133, v10, v9
    v_fma_f32 v134, v134, v10, v9
    s_waitcnt lgkmcnt(7)
    v_mfma_f32_32x32x16_bf16 v[116:131], v[192:195], v[20:23], v[116:131]
    ds_read_b128 v[20:23], v65 offset:15360
    v_fma_f32 v135, v135, v10, v9
    v_fma_f32 v136, v136, v10, v9
    v_fma_f32 v137, v137, v10, v9
    v_fma_f32 v138, v138, v10, v9
    s_waitcnt lgkmcnt(7)
    v_mfma_f32_32x32x16_bf16 v[116:131], v[196:199], v[24:27], v[116:131]
    ds_read_b128 v[24:27], v65 offset:16384
    v_fma_f32 v139, v139, v10, v9
    v_mul_f32 v132, v132, v100
    v_mul_f32 v133, v133, v101
    v_mul_f32 v134, v134, v102
    s_waitcnt lgkmcnt(7)
    v_mfma_f32_32x32x16_bf16 v[116:131], v[200:203], v[28:31], v[116:131]
    ds_read_b128 v[28:31], v65 offset:17408
    v_mul_f32 v135, v135, v103
    v_mul_f32 v136, v136, v104
    v_mul_f32 v137, v137, v105
    v_mul_f32 v138, v138, v106
    s_waitcnt lgkmcnt(7)
    v_mfma_f32_32x32x16_bf16 v[116:131], v[204:207], v[32:35], v[116:131]
    ds_read_b128 v[32:35], v65 offset:18432
    v_mul_f32 v139, v139, v107
    v_exp_f32 v132, v132
    v_exp_f32 v133, v133
    s_waitcnt lgkmcnt(7)
    v_mfma_f32_32x32x16_bf16 v[116:131], v[208:211], v[36:39], v[116:131]
    ds_read_b128 v[36:39], v65 offset:19456
    v_exp_f32 v134, v134
    v_exp_f32 v135, v135
    s_waitcnt lgkmcnt(7)
    v_mfma_f32_32x32x16_bf16 v[116:131], v[212:215], v[40:43], v[116:131]
    ds_read_b128 v[40:43], v65 offset:20480
    v_exp_f32 v136, v136
    v_exp_f32 v137, v137
    s_waitcnt lgkmcnt(7)
    v_mfma_f32_32x32x16_bf16 v[116:131], v[216:219], v[44:47], v[116:131]
    ds_read_b128 v[44:47], v65 offset:21504
    v_exp_f32 v138, v138
    v_exp_f32 v139, v139
    s_waitcnt lgkmcnt(7)
    v_mfma_f32_32x32x16_bf16 v[116:131], v[220:223], v[48:51], v[116:131]
    ds_read_b128 v[48:51], v65 offset:22528
    v_mul_f32 v140, v100, v108
    v_mul_f32 v141, v101, v109
    v_mul_f32 v142, v102, v110
    v_mul_f32 v143, v103, v111
    s_waitcnt lgkmcnt(7)
    v_mfma_f32_32x32x16_bf16 v[116:131], v[224:227], v[20:23], v[116:131]
    ds_read_b128 v[20:23], v65 offset:23552
    v_mul_f32 v144, v104, v112
    v_mul_f32 v145, v105, v113
    v_mul_f32 v146, v106, v114
    v_mul_f32 v147, v107, v115
    s_waitcnt lgkmcnt(7)
    v_mfma_f32_32x32x16_bf16 v[116:131], v[228:231], v[24:27], v[116:131]
    ds_read_b128 v[24:27], v65 offset:24576
    v_fma_f32 v132, v132, v8, v8
    v_fma_f32 v133, v133, v8, v8
    v_fma_f32 v134, v134, v8, v8
    v_fma_f32 v135, v135, v8, v8
    s_waitcnt lgkmcnt(7)
    v_mfma_f32_32x32x16_bf16 v[116:131], v[232:235], v[28:31], v[116:131]
    ds_read_b128 v[28:31], v65 offset:25600
    v_fma_f32 v136, v136, v8, v8
    v_fma_f32 v137, v137, v8, v8
    v_fma_f32 v138, v138, v8, v8
    v_fma_f32 v139, v139, v8, v8
    s_waitcnt lgkmcnt(7)
    v_mfma_f32_32x32x16_bf16 v[116:131], v[236:239], v[32:35], v[116:131]
    ds_read_b128 v[32:35], v65 offset:26624
    v_rcp_f32 v132, v132
    v_rcp_f32 v133, v133
    s_waitcnt lgkmcnt(7)
    v_mfma_f32_32x32x16_bf16 v[116:131], v[240:243], v[36:39], v[116:131]
    ds_read_b128 v[36:39], v65 offset:27648
    v_rcp_f32 v134, v134
    v_rcp_f32 v135, v135
    s_waitcnt lgkmcnt(7)
    v_mfma_f32_32x32x16_bf16 v[116:131], v[244:247], v[40:43], v[116:131]
    ds_read_b128 v[40:43], v65 offset:28672
    v_rcp_f32 v136, v136
    v_rcp_f32 v137, v137
    s_waitcnt lgkmcnt(7)
    v_mfma_f32_32x32x16_bf16 v[116:131], v[248:251], v[44:47], v[116:131]
    ds_read_b128 v[44:47], v65 offset:29696
    v_rcp_f32 v138, v138
    v_rcp_f32 v139, v139
    s_waitcnt lgkmcnt(7)
    v_mfma_f32_32x32x16_bf16 v[116:131], v[252:255], v[48:51], v[116:131]
    ds_read_b128 v[48:51], v65 offset:30720
    s_nop 0
    v_mul_f32 v140, v140, v132
    v_mul_f32 v141, v141, v133
    v_mul_f32 v142, v142, v134
    s_waitcnt lgkmcnt(7)
    v_mfma_f32_32x32x16_bf16 v[116:131], v[68:71], v[20:23], v[116:131]
    ds_read_b128 v[20:23], v65 offset:31744
    v_mul_f32 v143, v143, v135
    v_mul_f32 v144, v144, v136
    v_mul_f32 v145, v145, v137
    v_mul_f32 v146, v146, v138
    s_waitcnt lgkmcnt(7)
    v_mfma_f32_32x32x16_bf16 v[116:131], v[72:75], v[24:27], v[116:131]
    ds_read_b128 v[24:27], v65 offset:32768
    v_mul_f32 v147, v147, v139
    v_cvt_pk_bf16_f32 v148, v140, v141
    v_cvt_pk_bf16_f32 v149, v142, v143
    v_cvt_pk_bf16_f32 v150, v144, v145
    s_waitcnt lgkmcnt(7)
    v_mfma_f32_32x32x16_bf16 v[116:131], v[76:79], v[28:31], v[116:131]
    ds_read_b128 v[28:31], v66 offset:0
    v_cvt_pk_bf16_f32 v151, v146, v147
    buffer_store_dwordx4 v[148:151], v3, s[4:7], s31 offen sc1
    s_add_u32 s31, s31, 114688
    s_waitcnt lgkmcnt(7)
    v_mfma_f32_32x32x16_bf16 v[116:131], v[80:83], v[32:35], v[116:131]
    ds_read_b128 v[32:35], v66 offset:1024
    s_waitcnt lgkmcnt(7)
    v_mfma_f32_32x32x16_bf16 v[116:131], v[84:87], v[36:39], v[116:131]
    ds_read_b128 v[36:39], v66 offset:2048
    s_waitcnt lgkmcnt(7)
    v_mfma_f32_32x32x16_bf16 v[116:131], v[88:91], v[40:43], v[116:131]
    ds_read_b128 v[40:43], v66 offset:3072
    s_waitcnt lgkmcnt(7)
    v_mfma_f32_32x32x16_bf16 v[116:131], v[92:95], v[44:47], v[116:131]
    ds_read_b128 v[44:47], v66 offset:4096
    s_waitcnt lgkmcnt(7)
    v_mfma_f32_32x32x16_bf16 v[116:131], v[96:99], v[48:51], v[116:131]
    ds_read_b128 v[48:51], v66 offset:5120
    s_waitcnt lgkmcnt(7)
    v_mfma_f32_32x32x16_bf16 v[116:131], v[156:159], v[20:23], v[116:131]
    ds_read_b96 v[8:10], v11 offset:1024
    ds_read_b128 v[20:23], v66 offset:6144
    s_waitcnt lgkmcnt(7)
    v_mfma_f32_32x32x16_bf16 v[116:131], v[160:163], v[24:27], v[116:131]
    ds_read_b128 v[24:27], v66 offset:7168
    s_setprio 0
    s_nop 9
    v_cmp_u_f32 vcc, v116, v116
    s_cbranch_vccnz KF_GS1
KF_GS1_R:
    v_mul_f32 v132, v116, v116
    v_mul_f32 v133, v117, v117
    v_mul_f32 v134, v118, v118
    v_mul_f32 v135, v119, v119
    v_mul_f32 v136, v120, v120
    v_mul_f32 v137, v121, v121
    v_mul_f32 v138, v122, v122
    v_mul_f32 v139, v123, v123
    v_fma_f32 v132, v132, v14, v13
    v_fma_f32 v133, v133, v14, v13
    v_fma_f32 v134, v134, v14, v13
    v_fma_f32 v135, v135, v14, v13
    v_fma_f32 v136, v136, v14, v13
    v_fma_f32 v137, v137, v14, v13
    v_fma_f32 v138, v138, v14, v13
    v_fma_f32 v139, v139, v14, v13
    v_mul_f32 v132, v132, v116
    v_mul_f32 v133, v133, v117
    v_mul_f32 v134, v134, v118
    v_mul_f32 v135, v135, v119
    v_mul_f32 v136, v136, v120
    v_mul_f32 v137, v137, v121
    v_mul_f32 v138, v138, v122
    v_mul_f32 v139, v139, v123
    v_exp_f32 v132, v132
    v_exp_f32 v133, v133
    v_exp_f32 v134, v134
    v_exp_f32 v135, v135
    v_exp_f32 v136, v136
    v_exp_f32 v137, v137
    v_exp_f32 v138, v138
    v_exp_f32 v139, v139
    v_mul_f32 v140, v116, v124
    v_mul_f32 v141, v117, v125
    v_mul_f32 v142, v118, v126
    v_mul_f32 v143, v119, v127
    v_mul_f32 v144, v120, v128
    v_mul_f32 v145, v121, v129
    v_mul_f32 v146, v122, v130
    v_mul_f32 v147, v123, v131
    v_fma_f32 v132, v132, v12, v12
    v_fma_f32 v133, v133, v12, v12
    v_fma_f32 v134, v134, v12, v12
    v_fma_f32 v135, v135, v12, v12
    v_fma_f32 v136, v136, v12, v12
    v_fma_f32 v137, v137, v12, v12
    v_fma_f32 v138, v138, v12, v12
    v_fma_f32 v139, v139, v12, v12
    v_rcp_f32 v132, v132
    v_rcp_f32 v133, v133
    v_rcp_f32 v134, v134
    v_rcp_f32 v135, v135
    v_rcp_f32 v136, v136
    v_rcp_f32 v137, v137
    v_rcp_f32 v138, v138
    v_rcp_f32 v139, v139
    s_nop 0
    v_mul_f32 v140, v140, v132
    v_mul_f32 v141, v141, v133
    v_mul_f32 v142, v142, v134
    v_mul_f32 v143, v143, v135
    v_mul_f32 v144, v144, v136
    v_mul_f32 v145, v145, v137
    v_mul_f32 v146, v146, v138
    v_mul_f32 v147, v147, v139
    v_cvt_pk_bf16_f32 v148, v140, v141
    v_cvt_pk_bf16_f32 v149, v142, v143
    v_cvt_pk_bf16_f32 v150, v144, v145
    v_cvt_pk_bf16_f32 v151, v146, v147
    buffer_store_dwordx4 v[148:151], v3, s[4:7], s31 offen sc1
    s_add_u32 s31, s31, 114688
    s_mov_b64 exec, 1
    ds_add_rtn_u32 v64, v0, v19 offset:24
    s_waitcnt lgkmcnt(0)
    v_readfirstlane_b32 s35, v64
    s_nop 0
    s_cmp_lg_u32 s35, 6
    s_cbranch_scc1 KF_TA177
    buffer_atomic_add v19, off, s[4:7], s55 offset:256 sc1
KF_TA177:
    s_mov_b64 exec, -1
    s_waitcnt lgkmcnt(7)
    v_mfma_f32_32x32x16_bf16 v[100:115], v[164:167], v[28:31], 0
    ds_read_b128 v[28:31], v66 offset:8192
    s_waitcnt lgkmcnt(7)
    v_mfma_f32_32x32x16_bf16 v[100:115], v[168:171], v[32:35], v[100:115]
    ds_read_b128 v[32:35], v66 offset:9216
    s_waitcnt lgkmcnt(7)
    v_mfma_f32_32x32x16_bf16 v[100:115], v[172:175], v[36:39], v[100:115]
    ds_read_b128 v[36:39], v66 offset:10240
    s_waitcnt lgkmcnt(7)
    v_mfma_f32_32x32x16_bf16 v[100:115], v[176:179], v[40:43], v[100:115]
    ds_read_b128 v[40:43], v66 offset:11264
    s_waitcnt lgkmcnt(7)
    v_mfma_f32_32x32x16_bf16 v[100:115], v[180:183], v[44:47], v[100:115]
    ds_read_b128 v[44:47], v66 offset:12288
    s_waitcnt lgkmcnt(7)
    v_mfma_f32_32x32x16_bf16 v[100:115], v[184:187], v[48:51], v[100:115]
    ds_read_b128 v[48:51], v66 offset:13312
    s_waitcnt lgkmcnt(7)
    v_mfma_f32_32x32x16_bf16 v[100:115], v[188:191], v[20:23], v[100:115]
    ds_read_b128 v[20:23], v66 offset:14336
    s_add_u32 s25, s37, 8192
    buffer_load_dwordx4 v[52:55], v3, s[4:7], s25 offen
    s_waitcnt lgkmcnt(7)
    v_mfma_f32_32x32x16_bf16 v[100:115], v[192:195], v[24:27], v[100:115]
    ds_read_b128 v[24:27], v66 offset:15360
    s_waitcnt lgkmcnt(7)
    v_mfma_f32_32x32x16_bf16 v[100:115], v[196:199], v[28:31], v[100:115]
    ds_read_b128 v[28:31], v66 offset:16384
    s_waitcnt lgkmcnt(7)
    v_mfma_f32_32x32x16_bf16 v[100:115], v[200:203], v[32:35], v[100:115]
    ds_read_b128 v[32:35], v66 offset:17408
    s_waitcnt lgkmcnt(7)
    v_mfma_f32_32x32x16_bf16 v[100:115], v[204:207], v[36:39], v[100:115]
    ds_read_b128 v[36:39], v66 offset:18432
    s_waitcnt lgkmcnt(7)
    v_mfma_f32_32x32x16_bf16 v[100:115], v[208:211], v[40:43], v[100:115]
    ds_read_b128 v[40:43], v66 offset:19456
    s_waitcnt lgkmcnt(7)
    v_mfma_f32_32x32x16_bf16 v[100:115], v[212:215], v[44:47], v[100:115]
    ds_read_b128 v[44:47], v66 offset:20480
    s_waitcnt lgkmcnt(7)
    v_mfma_f32_32x32x16_bf16 v[100:115], v[216:219], v[48:51], v[100:115]
    ds_read_b128 v[48:51], v66 offset:21504
    s_waitcnt lgkmcnt(7)
    v_mfma_f32_32x32x16_bf16 v[100:115], v[220:223], v[20:23], v[100:115]
    ds_read_b128 v[20:23], v66 offset:22528
    s_add_u32 s25, s37, 9216
    buffer_load_dwordx4 v[56:59], v3, s[4:7], s25 offen
    s_waitcnt lgkmcnt(7)
    v_mfma_f32_32x32x16_bf16 v[100:115], v[224:227], v[24:27], v[100:115]
    ds_read_b128 v[24:27], v66 offset:23552
    s_waitcnt lgkmcnt(7)
    v_mfma_f32_32x32x16_bf16 v[100:115], v[228:231], v[28:31], v[100:115]
    ds_read_b128 v[28:31], v66 offset:24576
    s_waitcnt lgkmcnt(7)
    v_mfma_f32_32x32x16_bf16 v[100:115], v[232:235], v[32:35], v[100:115]
    ds_read_b128 v[32:35], v66 offset:25600
    s_waitcnt lgkmcnt(7)
    v_mfma_f32_32x32x16_bf16 v[100:115], v[236:239], v[36:39], v[100:115]
    ds_read_b128 v[36:39], v66 offset:26624
    s_waitcnt lgkmcnt(7)
    v_mfma_f32_32x32x16_bf16 v[100:115], v[240:243], v[40:43], v[100:115]
    ds_read_b128 v[40:43], v66 offset:27648
    s_waitcnt lgkmcnt(7)
    v_mfma_f32_32x32x16_bf16 v[100:115], v[244:247], v[44:47], v[100:115]
    ds_read_b128 v[44:47], v66 offset:28672
    s_waitcnt lgkmcnt(7)
    v_mfma_f32_32x32x16_bf16 v[100:115], v[248:251], v[48:51], v[100:115]
    ds_read_b128 v[48:51], v66 offset:29696
    s_waitcnt lgkmcnt(7)
    v_mfma_f32_32x32x16_bf16 v[100:115], v[252:255], v[20:23], v[100:115]
    ds_read_b128 v[20:23], v66 offset:30720
    s_add_u32 s25, s37, 10240
    buffer_load_dwordx4 v[60:63], v3, s[4:7], s25 offen
    s_waitcnt lgkmcnt(7)
    v_mfma_f32_32x32x16_bf16 v[100:115], v[68:71], v[24:27], v[100:115]
    ds_read_b128 v[24:27], v66 offset:31744
    s_waitcnt lgkmcnt(7)
    v_mfma_f32_32x32x16_bf16 v[100:115], v[72:75], v[28:31], v[100:115]
    ds_read_b128 v[28:31], v66 offset:32768
    s_waitcnt lgkmcnt(7)
    v_mfma_f32_32x32x16_bf16 v[100:115], v[76:79], v[32:35], v[100:115]
    ds_read_b128 v[32:35], v67 offset:0
    s_waitcnt lgkmcnt(7)
    v_mfma_f32_32x32x16_bf16 v[100:115], v[80:83], v[36:39], v[100:115]
    ds_read_b128 v[36:39], v67 offset:1024
    s_waitcnt lgkmcnt(7)
    v_mfma_f32_32x32x16_bf16 v[100:115], v[84:87], v[40:43], v[100:115]
    ds_read_b128 v[40:43], v67 offset:2048
    s_waitcnt lgkmcnt(7)
    v_mfma_f32_32x32x16_bf16 v[100:115], v[88:91], v[44:47], v[100:115]
    ds_read_b128 v[44:47], v67 offset:3072
    s_waitcnt lgkmcnt(7)
    v_mfma_f32_32x32x16_bf16 v[100:115], v[92:95], v[48:51], v[100:115]
    ds_read_b128 v[48:51], v67 offset:4096
    s_waitcnt lgkmcnt(7)
    v_mfma_f32_32x32x16_bf16 v[100:115], v[96:99], v[20:23], v[100:115]
    ds_read_b128 v[20:23], v67 offset:5120
    s_waitcnt lgkmcnt(7)
    v_mfma_f32_32x32x16_bf16 v[100:115], v[156:159], v[24:27], v[100:115]
    ds_read_b96 v[12:14], v11 offset:1536
    ds_read_b128 v[24:27], v67 offset:6144
    s_waitcnt lgkmcnt(7)
    v_mfma_f32_32x32x16_bf16 v[100:115], v[160:163], v[28:31], v[100:115]
    ds_read_b128 v[28:31], v67 offset:7168
    s_waitcnt lgkmcnt(7)
    v_mfma_f32_32x32x16_bf16 v[116:131], v[164:167], v[32:35], 0
    ds_read_b128 v[32:35], v67 offset:8192
    s_waitcnt lgkmcnt(7)
    v_mfma_f32_32x32x16_bf16 v[116:131], v[168:171], v[36:39], v[116:131]
    ds_read_b128 v[36:39], v67 offset:9216
    s_waitcnt lgkmcnt(7)
    v_mfma_f32_32x32x16_bf16 v[116:131], v[172:175], v[40:43], v[116:131]
    ds_read_b128 v[40:43], v67 offset:10240
    s_waitcnt lgkmcnt(7)
    v_mfma_f32_32x32x16_bf16 v[116:131], v[176:179], v[44:47], v[116:131]
    ds_read_b128 v[44:47], v67 offset:11264
    s_waitcnt lgkmcnt(7)
    v_mfma_f32_32x32x16_bf16 v[116:131], v[180:183], v[48:51], v[116:131]
    ds_read_b128 v[48:51], v67 offset:12288
    v_cmp_u_f32 vcc, v100, v100
    s_cbranch_vccnz KF_GS2
KF_GS2_R:
    v_mul_f32 v132, v100, v100
    v_mul_f32 v133, v101, v101
    v_mul_f32 v134, v102, v102
    s_waitcnt lgkmcnt(7)
    v_mfma_f32_32x32x16_bf16 v[116:131], v[184:187], v[20:23], v[116:131]
    ds_read_b128 v[20:23], v67 offset:13312
    v_mul_f32 v135, v103, v103
    v_mul_f32 v136, v104, v104
    v_mul_f32 v137, v105, v105
    v_mul_f32 v138, v106, v106
    s_waitcnt lgkmcnt(7)
    v_mfma_f32_32x32x16_bf16 v[116:131], v[188:191], v[24:27], v[116:131]
    ds_read_b128 v[24:27], v67 offset:14336
    v_mul_f32 v139, v107, v107
    v_fma_f32 v132, v132, v10, v9
    v_fma_f32 v133, v133, v10, v9
    v_fma_f32 v134, v134, v10, v9
    s_waitcnt lgkmcnt(7)
    v_mfma_f32_32x32x16_bf16 v[116:131], v[192:195], v[28:31], v[116:131]
    ds_read_b128 v[28:31], v67 offset:15360
    v_fma_f32 v135, v135, v10, v9
    v_fma_f32 v136, v136, v10, v9
    v_fma_f32 v137, v137, v10, v9
    v_fma_f32 v138, v138, v10, v9
    s_waitcnt lgkmcnt(7)
    v_mfma_f32_32x32x16_bf16 v[116:131], v[196:199], v[32:35], v[116:131]
    ds_read_b128 v[32:35], v67 offset:16384
    v_fma_f32 v139, v139, v10, v9
    v_mul_f32 v132, v132, v100
    v_mul_f32 v133, v133, v101
    v_mul_f32 v134, v134, v102
    s_waitcnt lgkmcnt(7)
    v_mfma_f32_32x32x16_bf16 v[116:131], v[200:203], v[36:39], v[116:131]
    ds_read_b128 v[36:39], v67 offset:17408
    v_mul_f32 v135, v135, v103
    v_mul_f32 v136, v136, v104
    v_mul_f32 v137, v137, v105
    v_mul_f32 v138, v138, v106
    s_waitcnt lgkmcnt(7)
    v_mfma_f32_32x32x16_bf16 v[116:131], v[204:207], v[40:43], v[116:131]
    ds_read_b128 v[40:43], v67 offset:18432
    v_mul_f32 v139, v139, v107
    v_exp_f32 v132, v132
    v_exp_f32 v133, v133
    s_waitcnt lgkmcnt(7)
    v_mfma_f32_32x32x16_bf16 v[116:131], v[208:211], v[44:47], v[116:131]
    ds_read_b128 v[44:47], v67 offset:19456
    v_exp_f32 v134, v134
    v_exp_f32 v135, v135
    s_waitcnt lgkmcnt(7)
    v_mfma_f32_32x32x16_bf16 v[116:131], v[212:215], v[48:51], v[116:131]
    ds_read_b128 v[48:51], v67 offset:20480
    v_exp_f32 v136, v136
    v_exp_f32 v137, v137
    s_waitcnt lgkmcnt(7)
    v_mfma_f32_32x32x16_bf16 v[116:131], v[216:219], v[20:23], v[116:131]
    ds_read_b128 v[20:23], v67 offset:21504
    v_exp_f32 v138, v138
    v_exp_f32 v139, v139
    s_waitcnt lgkmcnt(7)
    v_mfma_f32_32x32x16_bf16 v[116:131], v[220:223], v[24:27], v[116:131]
    ds_read_b128 v[24:27], v67 offset:22528
    v_mul_f32 v140, v100, v108
    v_mul_f32 v141, v101, v109
    v_mul_f32 v142, v102, v110
    v_mul_f32 v143, v103, v111
    s_waitcnt lgkmcnt(7)
    v_mfma_f32_32x32x16_bf16 v[116:131], v[224:227], v[28:31], v[116:131]
    ds_read_b128 v[28:31], v67 offset:23552
    v_mul_f32 v144, v104, v112
    v_mul_f32 v145, v105, v113
    v_mul_f32 v146, v106, v114
    v_mul_f32 v147, v107, v115
    s_waitcnt lgkmcnt(7)
    v_mfma_f32_32x32x16_bf16 v[116:131], v[228:231], v[32:35], v[116:131]
    ds_read_b128 v[32:35], v67 offset:24576
    v_fma_f32 v132, v132, v8, v8
    v_fma_f32 v133, v133, v8, v8
    v_fma_f32 v134, v134, v8, v8
    v_fma_f32 v135, v135, v8, v8
    s_waitcnt lgkmcnt(7)
    v_mfma_f32_32x32x16_bf16 v[116:131], v[232:235], v[36:39], v[116:131]
    ds_read_b128 v[36:39], v67 offset:25600
    v_fma_f32 v136, v136, v8, v8
    v_fma_f32 v137, v137, v8, v8
    v_fma_f32 v138, v138, v8, v8
    v_fma_f32 v139, v139, v8, v8
    s_waitcnt lgkmcnt(7)
    v_mfma_f32_32x32x16_bf16 v[116:131], v[236:239], v[40:43], v[116:131]
    ds_read_b128 v[40:43], v67 offset:26624
    v_rcp_f32 v132, v132
    v_rcp_f32 v133, v133
    s_waitcnt lgkmcnt(7)
    v_mfma_f32_32x32x16_bf16 v[116:131], v[240:243], v[44:47], v[116:131]
    ds_read_b128 v[44:47], v67 offset:27648
    v_rcp_f32 v134, v134
    v_rcp_f32 v135, v135
    s_waitcnt lgkmcnt(7)
    v_mfma_f32_32x32x16_bf16 v[116:131], v[244:247], v[48:51], v[116:131]
    ds_read_b128 v[48:51], v67 offset:28672
    v_rcp_f32 v136, v136
    v_rcp_f32 v137, v137
    s_waitcnt lgkmcnt(7)
    v_mfma_f32_32x32x16_bf16 v[116:131], v[248:251], v[20:23], v[116:131]
    ds_read_b128 v[20:23], v67 offset:29696
    v_rcp_f32 v138, v138
    v_rcp_f32 v139, v139
    s_waitcnt lgkmcnt(7)
    v_mfma_f32_32x32x16_bf16 v[116:131], v[252:255], v[24:27], v[116:131]
    ds_read_b128 v[24:27], v67 offset:30720
    s_nop 0
    v_mul_f32 v140, v140, v132
    v_mul_f32 v141, v141, v133
    v_mul_f32 v142, v142, v134
    s_waitcnt lgkmcnt(7)
    v_mfma_f32_32x32x16_bf16 v[116:131], v[68:71], v[28:31], v[116:131]
    ds_read_b128 v[28:31], v67 offset:31744
    v_mul_f32 v143, v143, v135
    v_mul_f32 v144, v144, v136
    v_mul_f32 v145, v145, v137
    v_mul_f32 v146, v146, v138
    s_waitcnt lgkmcnt(7)
    v_mfma_f32_32x32x16_bf16 v[116:131], v[72:75], v[32:35], v[116:131]
    ds_read_b128 v[32:35], v67 offset:32768
    v_mul_f32 v147, v147, v139
    v_cvt_pk_bf16_f32 v148, v140, v141
    v_cvt_pk_bf16_f32 v149, v142, v143
    v_cvt_pk_bf16_f32 v150, v144, v145
    s_waitcnt lgkmcnt(7)
    v_mfma_f32_32x32x16_bf16 v[116:131], v[76:79], v[36:39], v[116:131]
    v_cvt_pk_bf16_f32 v151, v146, v147
    buffer_store_dwordx4 v[148:151], v3, s[4:7], s31 offen sc1
    s_add_u32 s31, s31, 114688
    s_waitcnt lgkmcnt(6)
    v_mfma_f32_32x32x16_bf16 v[116:131], v[80:83], v[40:43], v[116:131]
    s_waitcnt lgkmcnt(5)
    v_mfma_f32_32x32x16_bf16 v[116:131], v[84:87], v[44:47], v[116:131]
    s_waitcnt lgkmcnt(4)
    v_mfma_f32_32x32x16_bf16 v[116:131], v[88:91], v[48:51], v[116:131]
    s_waitcnt lgkmcnt(3)
    v_mfma_f32_32x32x16_bf16 v[116:131], v[92:95], v[20:23], v[116:131]
    s_waitcnt lgkmcnt(2)
    v_mfma_f32_32x32x16_bf16 v[116:131], v[96:99], v[24:27], v[116:131]
    s_waitcnt lgkmcnt(1)
    v_mfma_f32_32x32x16_bf16 v[116:131], v[156:159], v[28:31], v[116:131]
    s_waitcnt lgkmcnt(0)
    v_mfma_f32_32x32x16_bf16 v[116:131], v[160:163], v[32:35], v[116:131]
    s_nop 11
    v_cmp_u_f32 vcc, v116, v116
    s_cbranch_vccnz KF_GS3
KF_GS3_R:
    v_mul_f32 v132, v116, v116
    v_mul_f32 v133, v117, v117
    v_mul_f32 v134, v118, v118
    v_mul_f32 v135, v119, v119
    v_mul_f32 v136, v120, v120
    v_mul_f32 v137, v121, v121
    v_mul_f32 v138, v122, v122
    v_mul_f32 v139, v123, v123
    v_fma_f32 v132, v132, v14, v13
    v_fma_f32 v133, v133, v14, v13
    v_fma_f32 v134, v134, v14, v13
    v_fma_f32 v135, v135, v14, v13
    v_fma_f32 v136, v136, v14, v13
    v_fma_f32 v137, v137, v14, v13
    v_fma_f32 v138, v138, v14, v13
    v_fma_f32 v139, v139, v14, v13
    v_mul_f32 v132, v132, v116
    v_mul_f32 v133, v133, v117
    v_mul_f32 v134, v134, v118
    v_mul_f32 v135, v135, v119
    v_mul_f32 v136, v136, v120
    v_mul_f32 v137, v137, v121
    v_mul_f32 v138, v138, v122
    v_mul_f32 v139, v139, v123
    v_exp_f32 v132, v132
    v_exp_f32 v133, v133
    v_exp_f32 v134, v134
    v_exp_f32 v135, v135
    v_exp_f32 v136, v136
    v_exp_f32 v137, v137
    v_exp_f32 v138, v138
    v_exp_f32 v139, v139
    v_mul_f32 v140, v116, v124
    v_mul_f32 v141, v117, v125
    v_mul_f32 v142, v118, v126
    v_mul_f32 v143, v119, v127
    v_mul_f32 v144, v120, v128
    v_mul_f32 v145, v121, v129
    v_mul_f32 v146, v122, v130
    v_mul_f32 v147, v123, v131
    v_fma_f32 v132, v132, v12, v12
    v_fma_f32 v133, v133, v12, v12
    v_fma_f32 v134, v134, v12, v12
    v_fma_f32 v135, v135, v12, v12
    v_fma_f32 v136, v136, v12, v12
    v_fma_f32 v137, v137, v12, v12
    v_fma_f32 v138, v138, v12, v12
    v_fma_f32 v139, v139, v12, v12
    v_rcp_f32 v132, v132
    v_rcp_f32 v133, v133
    v_rcp_f32 v134, v134
    v_rcp_f32 v135, v135
    v_rcp_f32 v136, v136
    v_rcp_f32 v137, v137
    v_rcp_f32 v138, v138
    v_rcp_f32 v139, v139
    s_nop 0
    v_mul_f32 v140, v140, v132
    v_mul_f32 v141, v141, v133
    v_mul_f32 v142, v142, v134
    v_mul_f32 v143, v143, v135
    v_mul_f32 v144, v144, v136
    v_mul_f32 v145, v145, v137
    v_mul_f32 v146, v146, v138
    v_mul_f32 v147, v147, v139
    v_cvt_pk_bf16_f32 v148, v140, v141
    v_cvt_pk_bf16_f32 v149, v142, v143
    v_cvt_pk_bf16_f32 v150, v144, v145
    v_cvt_pk_bf16_f32 v151, v146, v147
    buffer_store_dwordx4 v[148:151], v3, s[4:7], s31 offen sc1
    s_add_u32 s31, s31, 114688
    s_mov_b64 exec, 1
    ds_add_u32 v0, v19 offset:28
    s_mov_b64 exec, -1
    s_add_u32 s39, s38, 229376
    s_cmp_ge_u32 s3, 4
    s_cselect_b64 vcc, -1, 0
    s_cbranch_scc1 KF_DA_Y
    s_add_u32 s25, s37, 114688
    buffer_load_dwordx4 v[68:71], v3, s[4:7], s25 offen offset:0
    buffer_load_dwordx4 v[72:75], v3, s[4:7], s25 offen offset:1024
    buffer_load_dwordx4 v[76:79], v3, s[4:7], s25 offen offset:2048
    buffer_load_dwordx4 v[80:83], v3, s[4:7], s25 offen offset:3072
    s_add_u32 s47, s25, 4096
    buffer_load_dwordx4 v[84:87], v3, s[4:7], s47 offen offset:0
    buffer_load_dwordx4 v[88:91], v3, s[4:7], s47 offen offset:1024
    buffer_load_dwordx4 v[92:95], v3, s[4:7], s47 offen offset:2048
    buffer_load_dwordx4 v[96:99], v3, s[4:7], s47 offen offset:3072
    s_mov_b32 s36, 0
KF_SP178_L:
    ds_read_b32 v18, v0 offset:36
    s_add_u32 s36, s36, 1
    s_waitcnt lgkmcnt(0)
    v_readfirstlane_b32 s35, v18
    s_nop 0
    s_cmp_ge_u32 s35, 2
    s_cbranch_scc1 KF_SP178_D
    s_sleep 4
    s_cmp_lt_u32 s36, 524288
    s_cbranch_scc1 KF_SP178_L
KF_SP178_D:
    s_lshl_b32 s25, s3, 13
    s_add_u32 s25, s25, 33792
    v_add_u32 v16, s25, v3
    s_branch KF_DA_R
KF_DA_Y:
    s_setprio 1
    s_sub_u32 s25, s3, 4
    s_lshl_b32 s25, s25, 14
    s_cmp_eq_u32 s3, 6
    s_cselect_b32 s25, 143360, s25
    v_add_u32 v16, s25, v3
    s_mov_b32 s36, 0
KF_SP179_L:
    ds_read_b32 v18, v0 offset:36
    s_add_u32 s36, s36, 1
    s_waitcnt lgkmcnt(0)
    v_readfirstlane_b32 s35, v18
    s_nop 0
    s_cmp_ge_u32 s35, 2
    s_cbranch_scc1 KF_SP179_D
    s_sleep 4
    s_cmp_lt_u32 s36, 524288
    s_cbranch_scc1 KF_SP179_L
KF_SP179_D:
    ds_read_b128 v[68:71], v16 offset:8192
    ds_read_b128 v[72:75], v16 offset:9216
    ds_read_b128 v[76:79], v16 offset:10240
    ds_read_b128 v[80:83], v16 offset:11264
    ds_read_b128 v[84:87], v16 offset:12288
    ds_read_b128 v[88:91], v16 offset:13312
    ds_read_b128 v[92:95], v16 offset:14336
    ds_read_b128 v[96:99], v16 offset:15360
KF_DA_R:
    ds_read_b128 v[20:23], v16 offset:0
    ds_read_b128 v[24:27], v16 offset:1024
    ds_read_b128 v[28:31], v16 offset:2048
    ds_read_b128 v[32:35], v16 offset:3072
    ds_read_b128 v[36:39], v16 offset:4096
    ds_read_b128 v[40:43], v16 offset:5120
    ds_read_b128 v[44:47], v16 offset:6144
    ds_read_b128 v[48:51], v16 offset:7168
    s_cbranch_vccnz KF_PC180
    s_waitcnt vmcnt(10)
KF_PC180:
    s_add_u32 s25, s38, 0
    buffer_load_dwordx4 v[200:203], v3, s[4:7], s25 offen offset:0 sc1
    s_add_u32 s25, s38, 0
    buffer_load_dwordx4 v[204:207], v3, s[4:7], s25 offen offset:1024 sc1
    s_cbranch_vccnz KF_PC181
    s_waitcnt vmcnt(10)
KF_PC181:
    s_add_u32 s25, s38, 0
    buffer_load_dwordx4 v[208:211], v3, s[4:7], s25 offen offset:2048 sc1
    s_add_u32 s25, s38, 0
    buffer_load_dwordx4 v[212:215], v3, s[4:7], s25 offen offset:3072 sc1
    s_cbranch_vccnz KF_PC182
    s_waitcnt vmcnt(10)
KF_PC182:
    s_add_u32 s25, s38, 4096
    buffer_load_dwordx4 v[216:219], v3, s[4:7], s25 offen offset:0 sc1
    s_add_u32 s25, s38, 4096
    buffer_load_dwordx4 v[220:223], v3, s[4:7], s25 offen offset:1024 sc1
    s_cbranch_vccnz KF_PC183
    s_waitcnt vmcnt(10)
KF_PC183:
    s_add_u32 s25, s38, 4096
    buffer_load_dwordx4 v[224:227], v3, s[4:7], s25 offen offset:2048 sc1
    s_add_u32 s25, s38, 4096
    buffer_load_dwordx4 v[228:231], v3, s[4:7], s25 offen offset:3072 sc1
    s_waitcnt lgkmcnt(0)
    s_mov_b64 exec, 1
    ds_add_u32 v0, v19 offset:8
    s_mov_b64 exec, -1
    s_cbranch_vccnz KF_PC184
    s_waitcnt vmcnt(10)
KF_PC184:
    s_add_u32 s25, s37, 11264
    buffer_load_dwordx4 v[164:167], v3, s[4:7], s25 offen
    s_add_u32 s25, s37, 12288
    buffer_load_dwordx4 v[168:171], v3, s[4:7], s25 offen
    s_add_u32 s25, s37, 13312
    buffer_load_dwordx4 v[172:175], v3, s[4:7], s25 offen
    s_waitcnt vmcnt(10)
    v_mfma_f32_32x32x16_bf16 v[100:115], v[20:23], v[200:203], 0
    v_mfma_f32_32x32x16_bf16 v[116:131], v[68:71], v[200:203], 0
    s_cbranch_vccnz KF_PC185
    s_waitcnt vmcnt(10)
KF_PC185:
    s_add_u32 s25, s37, 122880
    buffer_load_dwordx4 v[176:179], v3, s[4:7], s25 offen
    s_add_u32 s25, s37, 123904
    buffer_load_dwordx4 v[180:183], v3, s[4:7], s25 offen
    s_add_u32 s25, s37, 124928
    buffer_load_dwordx4 v[184:187], v3, s[4:7], s25 offen
    s_waitcnt vmcnt(12)
    v_mfma_f32_32x32x16_bf16 v[100:115], v[24:27], v[204:207], v[100:115]
    v_mfma_f32_32x32x16_bf16 v[116:131], v[72:75], v[204:207], v[116:131]
    s_cbranch_vccnz KF_PC186
    s_waitcnt vmcnt(10)
KF_PC186:
    s_add_u32 s25, s37, 125952
    buffer_load_dwordx4 v[188:191], v3, s[4:7], s25 offen
    s_add_u32 s25, s37, 126976
    buffer_load_dwordx4 v[192:195], v3, s[4:7], s25 offen
    s_add_u32 s25, s37, 128000
    buffer_load_dwordx4 v[196:199], v3, s[4:7], s25 offen
    s_waitcnt vmcnt(14)
    v_mfma_f32_32x32x16_bf16 v[100:115], v[28:31], v[208:211], v[100:115]
    v_mfma_f32_32x32x16_bf16 v[116:131], v[76:79], v[208:211], v[116:131]
    s_cbranch_vccnz KF_PC187
    s_waitcnt vmcnt(10)
KF_PC187:
    s_add_u32 s25, s38, 8192
    buffer_load_dwordx4 v[232:235], v3, s[4:7], s25 offen offset:0 sc1
    s_add_u32 s25, s38, 8192
    buffer_load_dwordx4 v[236:239], v3, s[4:7], s25 offen offset:1024 sc1
    s_add_u32 s25, s38, 8192
    buffer_load_dwordx4 v[240:243], v3, s[4:7], s25 offen offset:2048 sc1
    s_waitcnt vmcnt(16)
    v_mfma_f32_32x32x16_bf16 v[100:115], v[32:35], v[212:215], v[100:115]
    v_mfma_f32_32x32x16_bf16 v[116:131], v[80:83], v[212:215], v[116:131]
    s_cbranch_vccnz KF_PC188
    s_waitcnt vmcnt(10)
KF_PC188:
    s_add_u32 s25, s38, 8192
    buffer_load_dwordx4 v[244:247], v3, s[4:7], s25 offen offset:3072 sc1
    s_add_u32 s25, s38, 12288
    buffer_load_dwordx4 v[248:251], v3, s[4:7], s25 offen offset:0 sc1
    s_add_u32 s25, s38, 12288
    buffer_load_dwordx4 v[252:255], v3, s[4:7], s25 offen offset:1024 sc1
    s_waitcnt vmcnt(18)
    v_mfma_f32_32x32x16_bf16 v[100:115], v[36:39], v[216:219], v[100:115]
    v_mfma_f32_32x32x16_bf16 v[116:131], v[84:87], v[216:219], v[116:131]
    s_cbranch_vccnz KF_PC189
    s_waitcnt vmcnt(10)
KF_PC189:
    s_add_u32 s25, s39, 0
    buffer_load_dwordx4 v[132:135], v3, s[4:7], s25 offen offset:0 sc1
    s_add_u32 s25, s39, 0
    buffer_load_dwordx4 v[136:139], v3, s[4:7], s25 offen offset:1024 sc1
    s_add_u32 s25, s39, 0
    buffer_load_dwordx4 v[140:143], v3, s[4:7], s25 offen offset:2048 sc1
    s_waitcnt vmcnt(20)
    v_mfma_f32_32x32x16_bf16 v[100:115], v[40:43], v[220:223], v[100:115]
    v_mfma_f32_32x32x16_bf16 v[116:131], v[88:91], v[220:223], v[116:131]
    s_cbranch_vccnz KF_PC190
    s_waitcnt vmcnt(10)
KF_PC190:
    s_add_u32 s25, s39, 0
    buffer_load_dwordx4 v[144:147], v3, s[4:7], s25 offen offset:3072 sc1
    s_add_u32 s25, s39, 4096
    buffer_load_dwordx4 v[148:151], v3, s[4:7], s25 offen offset:3072 sc1
    s_add_u32 s25, s39, 8192
    buffer_load_dwordx4 v[152:155], v3, s[4:7], s25 offen offset:0 sc1
    s_waitcnt vmcnt(22)
    v_mfma_f32_32x32x16_bf16 v[100:115], v[44:47], v[224:227], v[100:115]
    v_mfma_f32_32x32x16_bf16 v[116:131], v[92:95], v[224:227], v[116:131]
    s_cbranch_vccnz KF_PC191
    s_waitcnt vmcnt(10)
KF_PC191:
    s_add_u32 s25, s39, 8192
    buffer_load_dwordx4 v[156:159], v3, s[4:7], s25 offen offset:1024 sc1
    s_add_u32 s25, s39, 8192
    buffer_load_dwordx4 v[160:163], v3, s[4:7], s25 offen offset:2048 sc1
    s_waitcnt vmcnt(23)
    v_mfma_f32_32x32x16_bf16 v[100:115], v[48:51], v[228:231], v[100:115]
    v_mfma_f32_32x32x16_bf16 v[116:131], v[96:99], v[228:231], v[116:131]
    s_branch KF_DOWN2
KF_STATS:
    s_add_u32 m0, s32, 33792
    s_add_u32 s25, s46, 32768
    buffer_load_dwordx4 v3, s[4:7], s25 offen offset:0 sc1 lds
    buffer_load_dwordx4 v3, s[4:7], s25 offen offset:1024 sc1 lds
    buffer_load_dwordx4 v3, s[4:7], s25 offen offset:2048 sc1 lds
    buffer_load_dwordx4 v3, s[4:7], s25 offen offset:3072 sc1 lds
    s_waitcnt vmcnt(4)
    s_barrier
    s_add_u32 m0, s32, 67584
    s_add_u32 s25, s46, 65536
    buffer_load_dwordx4 v3, s[4:7], s25 offen offset:0 sc1 lds
    buffer_load_dwordx4 v3, s[4:7], s25 offen offset:1024 sc1 lds
    buffer_load_dwordx4 v3, s[4:7], s25 offen offset:2048 sc1 lds
    buffer_load_dwordx4 v3, s[4:7], s25 offen offset:3072 sc1 lds
    s_add_u32 m0, s32, 101376
    s_add_u32 s25, s46, 98304
    buffer_load_dwordx4 v3, s[4:7], s25 offen offset:0 sc1 lds
    buffer_load_dwordx4 v3, s[4:7], s25 offen offset:1024 sc1 lds
    buffer_load_dwordx4 v3, s[4:7], s25 offen offset:2048 sc1 lds
    buffer_load_dwordx4 v3, s[4:7], s25 offen offset:3072 sc1 lds
    s_waitcnt vmcnt(0)
    s_waitcnt vmcnt(6)
    buffer_load_dwordx4 v[20:23], v3, s[4:7], s37 offen offset:0
    buffer_load_dwordx4 v[24:27], v3, s[4:7], s37 offen offset:1024
    s_waitcnt vmcnt(6)
    buffer_load_dwordx4 v[28:31], v3, s[4:7], s37 offen offset:2048
    buffer_load_dwordx4 v[32:35], v3, s[4:7], s37 offen offset:3072
    s_waitcnt vmcnt(6)
    s_add_u32 s47, s37, 4096
    buffer_load_dwordx4 v[36:39], v3, s[4:7], s47 offen offset:0
    buffer_load_dwordx4 v[40:43], v3, s[4:7], s47 offen offset:1024
    s_waitcnt vmcnt(6)
    buffer_load_dwordx4 v[44:47], v3, s[4:7], s47 offen offset:2048
    buffer_load_dwordx4 v[48:51], v3, s[4:7], s47 offen offset:3072
    s_waitcnt vmcnt(6)
    s_add_u32 s47, s37, 8192
    buffer_load_dwordx4 v[52:55], v3, s[4:7], s47 offen offset:0
    buffer_load_dwordx4 v[56:59], v3, s[4:7], s47 offen offset:1024
    s_waitcnt vmcnt(6)
    buffer_load_dwordx4 v[60:63], v3, s[4:7], s47 offen offset:2048
    buffer_load_dwordx4 v[164:167], v3, s[4:7], s47 offen offset:3072
    s_waitcnt vmcnt(6)
    s_add_u32 s47, s37, 12288
    buffer_load_dwordx4 v[168:171], v3, s[4:7], s47 offen offset:0
    buffer_load_dwordx4 v[172:175], v3, s[4:7], s47 offen offset:1024
    s_barrier
    s_waitcnt vmcnt(16)
    s_mov_b32 m0, 0
    s_add_u32 s25, s37, 4294924288
    buffer_load_dwordx4 v3, s[4:7], s25 offen offset:0 lds
    buffer_load_dwordx4 v3, s[4:7], s25 offen offset:1024 lds
    buffer_load_dwordx4 v3, s[4:7], s25 offen offset:2048 lds
    buffer_load_dwordx4 v3, s[4:7], s25 offen offset:3072 lds
    s_waitcnt vmcnt(16)
    s_mov_b32 m0, 4096
    s_add_u32 s25, s37, 4294928384
    buffer_load_dwordx4 v3, s[4:7], s25 offen offset:0 lds
    buffer_load_dwordx4 v3, s[4:7], s25 offen offset:1024 lds
    buffer_load_dwordx4 v3, s[4:7], s25 offen offset:2048 lds
    buffer_load_dwordx4 v3, s[4:7], s25 offen offset:3072 lds
    s_waitcnt vmcnt(16)
    s_mov_b32 m0, 8192
    s_add_u32 s25, s37, 71680
    buffer_load_dwordx4 v3, s[4:7], s25 offen offset:0 lds
    buffer_load_dwordx4 v3, s[4:7], s25 offen offset:1024 lds
    buffer_load_dwordx4 v3, s[4:7], s25 offen offset:2048 lds
    buffer_load_dwordx4 v3, s[4:7], s25 offen offset:3072 lds
    s_waitcnt vmcnt(16)
    s_mov_b32 m0, 12288
    s_add_u32 s25, s37, 75776
    buffer_load_dwordx4 v3, s[4:7], s25 offen offset:0 lds
    buffer_load_dwordx4 v3, s[4:7], s25 offen offset:1024 lds
    buffer_load_dwordx4 v3, s[4:7], s25 offen offset:2048 lds
    buffer_load_dwordx4 v3, s[4:7], s25 offen offset:3072 lds
    s_waitcnt vmcnt(16)
    s_mov_b32 m0, 16384
    s_add_u32 s25, s37, 4294938624
    buffer_load_dwordx4 v3, s[4:7], s25 offen offset:0 lds
    buffer_load_dwordx4 v3, s[4:7], s25 offen offset:1024 lds
    buffer_load_dwordx4 v3, s[4:7], s25 offen offset:2048 lds
    buffer_load_dwordx4 v3, s[4:7], s25 offen offset:3072 lds
    s_waitcnt vmcnt(16)
    s_mov_b32 m0, 20480
    s_add_u32 s25, s37, 4294942720
    buffer_load_dwordx4 v3, s[4:7], s25 offen offset:0 lds
    buffer_load_dwordx4 v3, s[4:7], s25 offen offset:1024 lds
    buffer_load_dwordx4 v3, s[4:7], s25 offen offset:2048 lds
    buffer_load_dwordx4 v3, s[4:7], s25 offen offset:3072 lds
    s_waitcnt vmcnt(16)
    s_mov_b32 m0, 24576
    s_add_u32 s25, s37, 86016
    buffer_load_dwordx4 v3, s[4:7], s25 offen offset:0 lds
    buffer_load_dwordx4 v3, s[4:7], s25 offen offset:1024 lds
    buffer_load_dwordx4 v3, s[4:7], s25 offen offset:2048 lds
    buffer_load_dwordx4 v3, s[4:7], s25 offen offset:3072 lds
    s_waitcnt vmcnt(16)
    s_mov_b32 m0, 28672
    s_add_u32 s25, s37, 90112
    buffer_load_dwordx4 v3, s[4:7], s25 offen offset:0 lds
    buffer_load_dwordx4 v3, s[4:7], s25 offen offset:1024 lds
    buffer_load_dwordx4 v3, s[4:7], s25 offen offset:2048 lds
    buffer_load_dwordx4 v3, s[4:7], s25 offen offset:3072 lds
    s_waitcnt vmcnt(16)
    s_mov_b32 m0, 143360
    s_add_u32 s25, s37, 4294952960
    buffer_load_dwordx4 v3, s[4:7], s25 offen offset:0 lds
    buffer_load_dwordx4 v3, s[4:7], s25 offen offset:1024 lds
    buffer_load_dwordx4 v3, s[4:7], s25 offen offset:2048 lds
    buffer_load_dwordx4 v3, s[4:7], s25 offen offset:3072 lds
    s_waitcnt vmcnt(16)
    s_mov_b32 m0, 147456
    s_add_u32 s25, s37, 4294957056
    buffer_load_dwordx4 v3, s[4:7], s25 offen offset:0 lds
    buffer_load_dwordx4 v3, s[4:7], s25 offen offset:1024 lds
    buffer_load_dwordx4 v3, s[4:7], s25 offen offset:2048 lds
    buffer_load_dwordx4 v3, s[4:7], s25 offen offset:3072 lds
    s_waitcnt vmcnt(16)
    s_mov_b32 m0, 151552
    s_add_u32 s25, s37, 100352
    buffer_load_dwordx4 v3, s[4:7], s25 offen offset:0 lds
    buffer_load_dwordx4 v3, s[4:7], s25 offen offset:1024 lds
    buffer_load_dwordx4 v3, s[4:7], s25 offen offset:2048 lds
    buffer_load_dwordx4 v3, s[4:7], s25 offen offset:3072 lds
    s_waitcnt vmcnt(16)
    s_mov_b32 m0, 155648
    s_add_u32 s25, s37, 104448
    buffer_load_dwordx4 v3, s[4:7], s25 offen offset:0 lds
    buffer_load_dwordx4 v3, s[4:7], s25 offen offset:1024 lds
    buffer_load_dwordx4 v3, s[4:7], s25 offen offset:2048 lds
    buffer_load_dwordx4 v3, s[4:7], s25 offen offset:3072 lds
    s_add_u32 s25, s37, 114688
    s_waitcnt vmcnt(16)
    buffer_load_dwordx4 v[68:71], v3, s[4:7], s25 offen offset:0
    buffer_load_dwordx4 v[72:75], v3, s[4:7], s25 offen offset:1024
    s_waitcnt vmcnt(16)
    buffer_load_dwordx4 v[76:79], v3, s[4:7], s25 offen offset:2048
    buffer_load_dwordx4 v[80:83], v3, s[4:7], s25 offen offset:3072
    s_waitcnt vmcnt(16)
    s_add_u32 s47, s25, 4096
    buffer_load_dwordx4 v[84:87], v3, s[4:7], s47 offen offset:0
    buffer_load_dwordx4 v[88:91], v3, s[4:7], s47 offen offset:1024
    s_waitcnt vmcnt(16)
    buffer_load_dwordx4 v[92:95], v3, s[4:7], s47 offen offset:2048
    buffer_load_dwordx4 v[96:99], v3, s[4:7], s47 offen offset:3072
    s_waitcnt vmcnt(16)
    s_add_u32 s47, s25, 8192
    buffer_load_dwordx4 v[176:179], v3, s[4:7], s47 offen offset:0
    buffer_load_dwordx4 v[180:183], v3, s[4:7], s47 offen offset:1024
    s_waitcnt vmcnt(16)
    buffer_load_dwordx4 v[184:187], v3, s[4:7], s47 offen offset:2048
    buffer_load_dwordx4 v[188:191], v3, s[4:7], s47 offen offset:3072
    s_waitcnt vmcnt(16)
    s_add_u32 s47, s25, 12288
    buffer_load_dwordx4 v[192:195], v3, s[4:7], s47 offen offset:0
    buffer_load_dwordx4 v[196:199], v3, s[4:7], s47 offen offset:1024
    s_mov_b32 s36, 0
KF_SP192_L:
    ds_read_b32 v18, v0 offset:24
    s_add_u32 s36, s36, 1
    s_waitcnt lgkmcnt(0)
    v_readfirstlane_b32 s35, v18
    s_nop 0
    s_cmp_ge_u32 s35, 7
    s_cbranch_scc1 KF_SP192_D
    s_sleep 4
    s_cmp_lt_u32 s36, 524288
    s_cbranch_scc1 KF_SP192_L
KF_SP192_D:
    s_mov_b64 exec, 1
    s_mov_b32 s36, 0
KF_RDA_L:
    v_mov_b32 v64, 0
    buffer_atomic_add v64, off, s[4:7], s55 offset:256 sc0 sc1
    s_add_u32 s36, s36, 1
    s_waitcnt vmcnt(0)
    v_readfirstlane_b32 s35, v64
    s_cmp_ge_u32 s36, 65536
    s_cbranch_scc1 KF_RDA
    s_cmp_lt_u32 s35, 16
    s_cbranch_scc1 KF_RDA_L
KF_RDA:
    ds_write_b32 v0, v19 offset:40
    s_mov_b64 exec, -1
    s_waitcnt vmcnt(16)
    s_mov_b32 m0, 33792
    s_add_u32 s25, s37, 4294866944
    buffer_load_dwordx4 v3, s[4:7], s25 offen offset:0 lds
    buffer_load_dwordx4 v3, s[4:7], s25 offen offset:1024 lds
    buffer_load_dwordx4 v3, s[4:7], s25 offen offset:2048 lds
    buffer_load_dwordx4 v3, s[4:7], s25 offen offset:3072 lds
    s_waitcnt vmcnt(16)
    s_mov_b32 m0, 37888
    s_add_u32 s25, s37, 4294871040
    buffer_load_dwordx4 v3, s[4:7], s25 offen offset:0 lds
    buffer_load_dwordx4 v3, s[4:7], s25 offen offset:1024 lds
    buffer_load_dwordx4 v3, s[4:7], s25 offen offset:2048 lds
    buffer_load_dwordx4 v3, s[4:7], s25 offen offset:3072 lds
    s_waitcnt vmcnt(16)
    s_mov_b32 m0, 41984
    s_add_u32 s25, s37, 4294881280
    buffer_load_dwordx4 v3, s[4:7], s25 offen offset:0 lds
    buffer_load_dwordx4 v3, s[4:7], s25 offen offset:1024 lds
    buffer_load_dwordx4 v3, s[4:7], s25 offen offset:2048 lds
    buffer_load_dwordx4 v3, s[4:7], s25 offen offset:3072 lds
    s_waitcnt vmcnt(16)
    s_mov_b32 m0, 46080
    s_add_u32 s25, s37, 4294885376
    buffer_load_dwordx4 v3, s[4:7], s25 offen offset:0 lds
    buffer_load_dwordx4 v3, s[4:7], s25 offen offset:1024 lds
    buffer_load_dwordx4 v3, s[4:7], s25 offen offset:2048 lds
    buffer_load_dwordx4 v3, s[4:7], s25 offen offset:3072 lds
    s_waitcnt vmcnt(16)
    s_mov_b32 m0, 50176
    s_add_u32 s25, s37, 4294895616
    buffer_load_dwordx4 v3, s[4:7], s25 offen offset:0 lds
    buffer_load_dwordx4 v3, s[4:7], s25 offen offset:1024 lds
    buffer_load_dwordx4 v3, s[4:7], s25 offen offset:2048 lds
    buffer_load_dwordx4 v3, s[4:7], s25 offen offset:3072 lds
    s_waitcnt vmcnt(16)
    s_mov_b32 m0, 54272
    s_add_u32 s25, s37, 4294899712
    buffer_load_dwordx4 v3, s[4:7], s25 offen offset:0 lds
    buffer_load_dwordx4 v3, s[4:7], s25 offen offset:1024 lds
    buffer_load_dwordx4 v3, s[4:7], s25 offen offset:2048 lds
    buffer_load_dwordx4 v3, s[4:7], s25 offen offset:3072 lds
    s_waitcnt vmcnt(16)
    s_mov_b32 m0, 58368
    s_add_u32 s25, s37, 4294909952
    buffer_load_dwordx4 v3, s[4:7], s25 offen offset:0 lds
    buffer_load_dwordx4 v3, s[4:7], s25 offen offset:1024 lds
    buffer_load_dwordx4 v3, s[4:7], s25 offen offset:2048 lds
    buffer_load_dwordx4 v3, s[4:7], s25 offen offset:3072 lds
    s_waitcnt vmcnt(16)
    s_mov_b32 m0, 62464
    s_add_u32 s25, s37, 4294914048
    buffer_load_dwordx4 v3, s[4:7], s25 offen offset:0 lds
    buffer_load_dwordx4 v3, s[4:7], s25 offen offset:1024 lds
    buffer_load_dwordx4 v3, s[4:7], s25 offen offset:2048 lds
    buffer_load_dwordx4 v3, s[4:7], s25 offen offset:3072 lds
    s_add_u32 s25, s38, 0
    buffer_load_dwordx4 v[200:203], v3, s[4:7], s25 offen offset:0 sc1
    s_add_u32 s25, s38, 0
    buffer_load_dwordx4 v[204:207], v3, s[4:7], s25 offen offset:1024 sc1
    s_add_u32 s25, s38, 0
    buffer_load_dwordx4 v[208:211], v3, s[4:7], s25 offen offset:2048 sc1
    s_add_u32 s25, s38, 0
    buffer_load_dwordx4 v[212:215], v3, s[4:7], s25 offen offset:3072 sc1
    s_add_u32 s25, s38, 4096
    buffer_load_dwordx4 v[216:219], v3, s[4:7], s25 offen offset:0 sc1
    s_add_u32 s25, s38, 4096
    buffer_load_dwordx4 v[220:223], v3, s[4:7], s25 offen offset:1024 sc1
    s_add_u32 s25, s38, 4096
    buffer_load_dwordx4 v[224:227], v3, s[4:7], s25 offen offset:2048 sc1
    s_add_u32 s25, s38, 4096
    buffer_load_dwordx4 v[228:231], v3, s[4:7], s25 offen offset:3072 sc1
    s_add_u32 s25, s38, 8192
    buffer_load_dwordx4 v[232:235], v3, s[4:7], s25 offen offset:0 sc1
    s_add_u32 s25, s38, 8192
    buffer_load_dwordx4 v[236:239], v3, s[4:7], s25 offen offset:1024 sc1
    s_add_u32 s25, s38, 8192
    buffer_load_dwordx4 v[240:243], v3, s[4:7], s25 offen offset:2048 sc1
    s_add_u32 s25, s38, 8192
    buffer_load_dwordx4 v[244:247], v3, s[4:7], s25 offen offset:3072 sc1
    s_add_u32 s25, s38, 12288
    buffer_load_dwordx4 v[248:251], v3, s[4:7], s25 offen offset:0 sc1
    s_add_u32 s25, s38, 12288
    buffer_load_dwordx4 v[252:255], v3, s[4:7], s25 offen offset:1024 sc1
    v_mov_b32 v18, 2
    s_waitcnt vmcnt(14)
    ds_write_b32 v0, v18 offset:36
    s_add_u32 s39, s38, 229376
    s_waitcnt vmcnt(0)
    v_mfma_f32_32x32x16_bf16 v[100:115], v[20:23], v[200:203], 0
    v_mfma_f32_32x32x16_bf16 v[116:131], v[68:71], v[200:203], 0
    v_mfma_f32_32x32x16_bf16 v[100:115], v[24:27], v[204:207], v[100:115]
    v_mfma_f32_32x32x16_bf16 v[116:131], v[72:75], v[204:207], v[116:131]
    v_mfma_f32_32x32x16_bf16 v[100:115], v[28:31], v[208:211], v[100:115]
    v_mfma_f32_32x32x16_bf16 v[116:131], v[76:79], v[208:211], v[116:131]
    v_mfma_f32_32x32x16_bf16 v[100:115], v[32:35], v[212:215], v[100:115]
    v_mfma_f32_32x32x16_bf16 v[116:131], v[80:83], v[212:215], v[116:131]
    v_mfma_f32_32x32x16_bf16 v[100:115], v[36:39], v[216:219], v[100:115]
    v_mfma_f32_32x32x16_bf16 v[116:131], v[84:87], v[216:219], v[116:131]
    v_mfma_f32_32x32x16_bf16 v[100:115], v[40:43], v[220:223], v[100:115]
    v_mfma_f32_32x32x16_bf16 v[116:131], v[88:91], v[220:223], v[116:131]
    v_mfma_f32_32x32x16_bf16 v[100:115], v[44:47], v[224:227], v[100:115]
    v_mfma_f32_32x32x16_bf16 v[116:131], v[92:95], v[224:227], v[116:131]
    v_mfma_f32_32x32x16_bf16 v[100:115], v[48:51], v[228:231], v[100:115]
    v_mfma_f32_32x32x16_bf16 v[116:131], v[96:99], v[228:231], v[116:131]
    s_mov_b32 s36, 0
KF_SP193_L:
    ds_read_b32 v18, v0 offset:28
    s_add_u32 s36, s36, 1
    s_waitcnt lgkmcnt(0)
    v_readfirstlane_b32 s35, v18
    s_nop 0
    s_cmp_ge_u32 s35, 4
    s_cbranch_scc1 KF_SP193_D
    s_sleep 4
    s_cmp_lt_u32 s36, 524288
    s_cbranch_scc1 KF_SP193_L
KF_SP193_D:
    s_add_u32 s25, s39, 0
    buffer_load_dwordx4 v[132:135], v3, s[4:7], s25 offen offset:0 sc1
    s_add_u32 s25, s39, 0
    buffer_load_dwordx4 v[136:139], v3, s[4:7], s25 offen offset:1024 sc1
    s_add_u32 s25, s39, 0
    buffer_load_dwordx4 v[140:143], v3, s[4:7], s25 offen offset:2048 sc1
    s_add_u32 s25, s39, 0
    buffer_load_dwordx4 v[144:147], v3, s[4:7], s25 offen offset:3072 sc1
    s_add_u32 s25, s39, 4096
    buffer_load_dwordx4 v[148:151], v3, s[4:7], s25 offen offset:3072 sc1
    s_add_u32 s25, s39, 8192
    buffer_load_dwordx4 v[152:155], v3, s[4:7], s25 offen offset:0 sc1
    s_add_u32 s25, s39, 8192
    buffer_load_dwordx4 v[156:159], v3, s[4:7], s25 offen offset:1024 sc1
    s_add_u32 s25, s39, 8192
    buffer_load_dwordx4 v[160:163], v3, s[4:7], s25 offen offset:2048 sc1
KF_DOWN2:
    ds_read_b128 v[8:11], v17 offset:64
    ds_read_b128 v[12:15], v17 offset:80
    s_lshl_b32 s32, s3, 12
    v_add_u32 v16, s32, v3
    v_add_u32 v65, 0x10000, v16
    s_lshr_b32 s32, s3, 1
    s_lshl_b32 s32, s32, 15
    s_and_b32 s33, s3, 1
    s_lshl_b32 s33, s33, 11
    s_add_u32 s32, s32, s33
    v_add_u32 v66, s32, v3
    s_waitcnt vmcnt(13)
    v_mfma_f32_32x32x16_bf16 v[100:115], v[52:55], v[232:235], v[100:115]
    v_mfma_f32_32x32x16_bf16 v[116:131], v[176:179], v[232:235], v[116:131]
    s_waitcnt vmcnt(12)
    v_mfma_f32_32x32x16_bf16 v[100:115], v[56:59], v[236:239], v[100:115]
    v_mfma_f32_32x32x16_bf16 v[116:131], v[180:183], v[236:239], v[116:131]
    s_waitcnt vmcnt(11)
    v_mfma_f32_32x32x16_bf16 v[100:115], v[60:63], v[240:243], v[100:115]
    v_mfma_f32_32x32x16_bf16 v[116:131], v[184:187], v[240:243], v[116:131]
    s_waitcnt vmcnt(10)
    v_mfma_f32_32x32x16_bf16 v[100:115], v[164:167], v[244:247], v[100:115]
    v_mfma_f32_32x32x16_bf16 v[116:131], v[188:191], v[244:247], v[116:131]
    s_waitcnt vmcnt(9)
    v_mfma_f32_32x32x16_bf16 v[100:115], v[168:171], v[248:251], v[100:115]
    v_mfma_f32_32x32x16_bf16 v[116:131], v[192:195], v[248:251], v[116:131]
    s_waitcnt vmcnt(8)
    v_mfma_f32_32x32x16_bf16 v[100:115], v[172:175], v[252:255], v[100:115]
    v_mfma_f32_32x32x16_bf16 v[116:131], v[196:199], v[252:255], v[116:131]
    ds_read_b32 v18, v0 offset:8
    s_waitcnt lgkmcnt(0)
    v_readfirstlane_b32 s35, v18
    s_nop 0
    s_cmp_ge_u32 s35, 7
    s_cbranch_scc1 KF_DL
    s_mov_b32 s36, 0
KF_SP194_L:
    ds_read_b32 v18, v0 offset:8
    s_add_u32 s36, s36, 1
    s_waitcnt lgkmcnt(0)
    v_readfirstlane_b32 s35, v18
    s_nop 0
    s_cmp_ge_u32 s35, 7
    s_cbranch_scc1 KF_SP194_D
    s_sleep 4
    s_cmp_lt_u32 s36, 524288
    s_cbranch_scc1 KF_SP194_L
KF_SP194_D:
KF_DL:
    s_nop 7
    v_cmp_u_f32 vcc, v100, v100
    s_cbranch_vccnz KF_DS0
KF_DS0_R:
    s_add_u32 s25, s39, 4096
    buffer_load_dwordx4 v[232:235], v3, s[4:7], s25 offen offset:0 sc1
    s_add_u32 s25, s39, 4096
    buffer_load_dwordx4 v[236:239], v3, s[4:7], s25 offen offset:1024 sc1
    s_add_u32 s25, s39, 4096
    buffer_load_dwordx4 v[240:243], v3, s[4:7], s25 offen offset:2048 sc1
    s_add_u32 s25, s39, 8192
    buffer_load_dwordx4 v[244:247], v3, s[4:7], s25 offen offset:3072 sc1
    s_add_u32 s25, s39, 12288
    buffer_load_dwordx4 v[248:251], v3, s[4:7], s25 offen offset:0 sc1
    s_add_u32 s25, s39, 12288
    buffer_load_dwordx4 v[252:255], v3, s[4:7], s25 offen offset:1024 sc1
    ds_write_b128 v16, v[100:103] offset:0
    ds_write_b128 v16, v[104:107] offset:1024
    ds_write_b128 v16, v[108:111] offset:2048
    ds_write_b128 v16, v[112:115] offset:3072
    ds_write_b128 v16, v[116:119] offset:32768
    ds_write_b128 v16, v[120:123] offset:33792
    ds_write_b128 v16, v[124:127] offset:34816
    ds_write_b128 v16, v[128:131] offset:35840
    s_waitcnt vmcnt(13)
    v_mfma_f32_32x32x16_bf16 v[200:215], v[20:23], v[132:135], 0
    v_mfma_f32_32x32x16_bf16 v[216:231], v[68:71], v[132:135], 0
    s_waitcnt vmcnt(12)
    v_mfma_f32_32x32x16_bf16 v[200:215], v[24:27], v[136:139], v[200:215]
    v_mfma_f32_32x32x16_bf16 v[216:231], v[72:75], v[136:139], v[216:231]
    s_waitcnt vmcnt(11)
    v_mfma_f32_32x32x16_bf16 v[200:215], v[28:31], v[140:143], v[200:215]
    v_mfma_f32_32x32x16_bf16 v[216:231], v[76:79], v[140:143], v[216:231]
    s_waitcnt vmcnt(10)
    v_mfma_f32_32x32x16_bf16 v[200:215], v[32:35], v[144:147], v[200:215]
    v_mfma_f32_32x32x16_bf16 v[216:231], v[80:83], v[144:147], v[216:231]
    s_waitcnt vmcnt(9)
    v_mfma_f32_32x32x16_bf16 v[200:215], v[48:51], v[148:151], v[200:215]
    v_mfma_f32_32x32x16_bf16 v[216:231], v[96:99], v[148:151], v[216:231]
    s_waitcnt vmcnt(8)
    v_mfma_f32_32x32x16_bf16 v[200:215], v[52:55], v[152:155], v[200:215]
    v_mfma_f32_32x32x16_bf16 v[216:231], v[176:179], v[152:155], v[216:231]
    s_waitcnt vmcnt(7)
    v_mfma_f32_32x32x16_bf16 v[200:215], v[56:59], v[156:159], v[200:215]
    v_mfma_f32_32x32x16_bf16 v[216:231], v[180:183], v[156:159], v[216:231]
    s_waitcnt vmcnt(6)
    v_mfma_f32_32x32x16_bf16 v[200:215], v[60:63], v[160:163], v[200:215]
    v_mfma_f32_32x32x16_bf16 v[216:231], v[184:187], v[160:163], v[216:231]
    s_waitcnt vmcnt(5)
    v_mfma_f32_32x32x16_bf16 v[200:215], v[36:39], v[232:235], v[200:215]
    v_mfma_f32_32x32x16_bf16 v[216:231], v[84:87], v[232:235], v[216:231]
    s_waitcnt vmcnt(4)
    v_mfma_f32_32x32x16_bf16 v[200:215], v[40:43], v[236:239], v[200:215]
    v_mfma_f32_32x32x16_bf16 v[216:231], v[88:91], v[236:239], v[216:231]
    s_waitcnt vmcnt(3)
    v_mfma_f32_32x32x16_bf16 v[200:215], v[44:47], v[240:243], v[200:215]
    v_mfma_f32_32x32x16_bf16 v[216:231], v[92:95], v[240:243], v[216:231]
    s_waitcnt vmcnt(2)
    v_mfma_f32_32x32x16_bf16 v[200:215], v[164:167], v[244:247], v[200:215]
    v_mfma_f32_32x32x16_bf16 v[216:231], v[188:191], v[244:247], v[216:231]
    s_waitcnt vmcnt(1)
    v_mfma_f32_32x32x16_bf16 v[200:215], v[168:171], v[248:251], v[200:215]
    v_mfma_f32_32x32x16_bf16 v[216:231], v[192:195], v[248:251], v[216:231]
    s_waitcnt vmcnt(0)
    v_mfma_f32_32x32x16_bf16 v[200:215], v[172:175], v[252:255], v[200:215]
    v_mfma_f32_32x32x16_bf16 v[216:231], v[196:199], v[252:255], v[216:231]
    s_nop 10
    v_cmp_u_f32 vcc, v200, v200
    s_cbranch_vccnz KF_DS1
KF_DS1_R:
    ds_write_b128 v65, v[200:203] offset:0
    ds_write_b128 v65, v[204:207] offset:1024
    ds_write_b128 v65, v[208:211] offset:2048
    ds_write_b128 v65, v[212:215] offset:3072
    ds_write_b128 v65, v[216:219] offset:32768
    ds_write_b128 v65, v[220:223] offset:33792
    ds_write_b128 v65, v[224:227] offset:34816
    ds_write_b128 v65, v[228:231] offset:35840
    v_mov_b32 v18, v66
    s_waitcnt lgkmcnt(0)
    s_barrier
    ds_read_b128 v[20:23], v18 offset:0
    ds_read_b128 v[24:27], v18 offset:1024
    ds_read_b128 v[28:31], v18 offset:4096
    ds_read_b128 v[32:35], v18 offset:5120
    ds_read_b128 v[36:39], v18 offset:8192
    ds_read_b128 v[40:43], v18 offset:9216
    ds_read_b128 v[44:47], v18 offset:12288
    ds_read_b128 v[48:51], v18 offset:13312
    ds_read_b128 v[52:55], v18 offset:16384
    ds_read_b128 v[56:59], v18 offset:17408
    ds_read_b128 v[60:63], v18 offset:20480
    ds_read_b128 v[64:67], v18 offset:21504
    ds_read_b128 v[68:71], v18 offset:24576
    ds_read_b128 v[72:75], v18 offset:25600
    ds_read_b128 v[76:79], v18 offset:28672
    ds_read_b128 v[80:83], v18 offset:29696
    v_lshlrev_b32 v84, 16, v4
    v_and_b32 v85, 0xffff0000, v4
    v_lshlrev_b32 v86, 16, v5
    v_and_b32 v87, 0xffff0000, v5
    v_lshlrev_b32 v88, 16, v6
    v_and_b32 v89, 0xffff0000, v6
    v_lshlrev_b32 v90, 16, v7
    v_and_b32 v91, 0xffff0000, v7
    s_waitcnt lgkmcnt(12)
    v_add_f32 v20, v20, v28
    v_add_f32 v21, v21, v29
    v_add_f32 v22, v22, v30
    v_add_f32 v23, v23, v31
    v_add_f32 v24, v24, v32
    v_add_f32 v25, v25, v33
    v_add_f32 v26, v26, v34
    v_add_f32 v27, v27, v35
    s_waitcnt lgkmcnt(10)
    v_add_f32 v20, v20, v36
    v_add_f32 v21, v21, v37
    v_add_f32 v22, v22, v38
    v_add_f32 v23, v23, v39
    v_add_f32 v24, v24, v40
    v_add_f32 v25, v25, v41
    v_add_f32 v26, v26, v42
    v_add_f32 v27, v27, v43
    s_waitcnt lgkmcnt(8)
    v_add_f32 v20, v20, v44
    v_add_f32 v21, v21, v45
    v_add_f32 v22, v22, v46
    v_add_f32 v23, v23, v47
    v_add_f32 v24, v24, v48
    v_add_f32 v25, v25, v49
    v_add_f32 v26, v26, v50
    v_add_f32 v27, v27, v51
    s_waitcnt lgkmcnt(6)
    v_add_f32 v20, v20, v52
    v_add_f32 v21, v21, v53
    v_add_f32 v22, v22, v54
    v_add_f32 v23, v23, v55
    v_add_f32 v24, v24, v56
    v_add_f32 v25, v25, v57
    v_add_f32 v26, v26, v58
    v_add_f32 v27, v27, v59
    s_waitcnt lgkmcnt(4)
    v_add_f32 v20, v20, v60
    v_add_f32 v21, v21, v61
    v_add_f32 v22, v22, v62
    v_add_f32 v23, v23, v63
    v_add_f32 v24, v24, v64
    v_add_f32 v25, v25, v65
    v_add_f32 v26, v26, v66
    v_add_f32 v27, v27, v67
    s_waitcnt lgkmcnt(2)
    v_add_f32 v20, v20, v68
    v_add_f32 v21, v21, v69
    v_add_f32 v22, v22, v70
    v_add_f32 v23, v23, v71
    v_add_f32 v24, v24, v72
    v_add_f32 v25, v25, v73
    v_add_f32 v26, v26, v74
    v_add_f32 v27, v27, v75
    s_waitcnt lgkmcnt(0)
    v_add_f32 v20, v20, v76
    v_add_f32 v21, v21, v77
    v_add_f32 v22, v22, v78
    v_add_f32 v23, v23, v79
    v_add_f32 v24, v24, v80
    v_add_f32 v25, v25, v81
    v_add_f32 v26, v26, v82
    v_add_f32 v27, v27, v83
    v_fmac_f32 v84, v8, v20
    v_fmac_f32 v85, v9, v21
    v_fmac_f32 v86, v10, v22
    v_fmac_f32 v87, v11, v23
    v_fmac_f32 v88, v12, v24
    v_fmac_f32 v89, v13, v25
    v_fmac_f32 v90, v14, v26
    v_fmac_f32 v91, v15, v27
    v_cvt_pk_bf16_f32 v4, v84, v85
    v_cvt_pk_bf16_f32 v5, v86, v87
    v_cvt_pk_bf16_f32 v6, v88, v89
    v_cvt_pk_bf16_f32 v7, v90, v91
    buffer_store_dwordx4 v[4:7], v1, s[12:15], s30 offen
    s_endpgm
KF_HOT_END:
KF_WO_SLOW:
    s_cmp_lg_u32 s52, 0
    s_cbranch_scc1 KF_WO_OK
    s_mov_b32 s52, 1
    s_nop 4
    s_mov_b32 s36, 0
KF_CK47:
    v_max3_u32 v84, v20, v21, v22
    v_max3_u32 v84, v84, v23, v24
    v_max3_u32 v84, v84, v25, v26
    v_max3_u32 v84, v84, v27, v28
    v_max3_u32 v84, v84, v29, v30
    v_max3_u32 v84, v84, v31, v32
    v_max3_u32 v84, v84, v33, v34
    v_max3_u32 v84, v84, v35, v36
    v_max3_u32 v84, v84, v37, v38
    v_max3_u32 v84, v84, v39, v40
    v_max3_u32 v84, v84, v41, v42
    v_max3_u32 v84, v84, v43, v44
    v_max3_u32 v84, v84, v45, v46
    v_max3_u32 v84, v84, v47, v48
    v_max3_u32 v84, v84, v49, v50
    v_max_u32 v84, v84, v51
    v_cmp_eq_u32 s[34:35], -1, v84
    s_nop 0
    s_cmp_lg_u64 s[34:35], 0
    s_cbranch_scc1 KF_CK47_R
KF_CK47_C:
    s_branch KF_WO
KF_GS0:
    ds_read_b128 v[136:139], v3 offset:32768
    s_add_u32 s25, s48, 0
    buffer_load_dwordx4 v[132:135], v3, s[4:7], s25 offen sc1
    s_add_u32 s25, s27, 0
    buffer_load_dwordx4 v[140:143], v3, s[4:7], s25 offen sc1
    s_waitcnt vmcnt(0)
    s_mov_b32 s36, 0
KF_CK49:
    v_max3_u32 v64, v132, v133, v134
    v_max_u32 v64, v64, v135
    v_cmp_eq_u32 s[34:35], -1, v64
    s_nop 0
    s_cmp_lg_u64 s[34:35], 0
    s_cbranch_scc1 KF_CK49_R
KF_CK49_C:
    v_mfma_f32_32x32x16_bf16 v[100:115], v[140:143], v[132:135], 0
    s_add_u32 s25, s48, 1024
    buffer_load_dwordx4 v[132:135], v3, s[4:7], s25 offen sc1
    s_add_u32 s25, s27, 1024
    buffer_load_dwordx4 v[140:143], v3, s[4:7], s25 offen sc1
    s_waitcnt vmcnt(0)
    s_mov_b32 s36, 0
KF_CK50:
    v_max3_u32 v64, v132, v133, v134
    v_max_u32 v64, v64, v135
    v_cmp_eq_u32 s[34:35], -1, v64
    s_nop 0
    s_cmp_lg_u64 s[34:35], 0
    s_cbranch_scc1 KF_CK50_R
KF_CK50_C:
    v_mfma_f32_32x32x16_bf16 v[100:115], v[140:143], v[132:135], v[100:115]
    s_add_u32 s25, s48, 2048
    buffer_load_dwordx4 v[132:135], v3, s[4:7], s25 offen sc1
    s_add_u32 s25, s27, 2048
    buffer_load_dwordx4 v[140:143], v3, s[4:7], s25 offen sc1
    s_waitcnt vmcnt(0)
    s_mov_b32 s36, 0
KF_CK51:
    v_max3_u32 v64, v132, v133, v134
    v_max_u32 v64, v64, v135
    v_cmp_eq_u32 s[34:35], -1, v64
    s_nop 0
    s_cmp_lg_u64 s[34:35], 0
    s_cbranch_scc1 KF_CK51_R
KF_CK51_C:
    v_mfma_f32_32x32x16_bf16 v[100:115], v[140:143], v[132:135], v[100:115]
    s_add_u32 s25, s48, 3072
    buffer_load_dwordx4 v[132:135], v3, s[4:7], s25 offen sc1
    s_add_u32 s25, s27, 3072
    buffer_load_dwordx4 v[140:143], v3, s[4:7], s25 offen sc1
    s_waitcnt vmcnt(0)
    s_mov_b32 s36, 0
KF_CK52:
    v_max3_u32 v64, v132, v133, v134
    v_max_u32 v64, v64, v135
    v_cmp_eq_u32 s[34:35], -1, v64
    s_nop 0
    s_cmp_lg_u64 s[34:35], 0
    s_cbranch_scc1 KF_CK52_R
KF_CK52_C:
    v_mfma_f32_32x32x16_bf16 v[100:115], v[140:143], v[132:135], v[100:115]
    s_add_u32 s25, s48, 4096
    buffer_load_dwordx4 v[132:135], v3, s[4:7], s25 offen sc1
    s_add_u32 s25, s27, 4096
    buffer_load_dwordx4 v[140:143], v3, s[4:7], s25 offen sc1
    s_waitcnt vmcnt(0)
    s_mov_b32 s36, 0
KF_CK53:
    v_max3_u32 v64, v132, v133, v134
    v_max_u32 v64, v64, v135
    v_cmp_eq_u32 s[34:35], -1, v64
    s_nop 0
    s_cmp_lg_u64 s[34:35], 0
    s_cbranch_scc1 KF_CK53_R
KF_CK53_C:
    v_mfma_f32_32x32x16_bf16 v[100:115], v[140:143], v[132:135], v[100:115]
    s_add_u32 s25, s48, 5120
    buffer_load_dwordx4 v[132:135], v3, s[4:7], s25 offen sc1
    s_add_u32 s25, s27, 5120
    buffer_load_dwordx4 v[140:143], v3, s[4:7], s25 offen sc1
    s_waitcnt vmcnt(0)
    s_mov_b32 s36, 0
KF_CK54:
    v_max3_u32 v64, v132, v133, v134
    v_max_u32 v64, v64, v135
    v_cmp_eq_u32 s[34:35], -1, v64
    s_nop 0
    s_cmp_lg_u64 s[34:35], 0
    s_cbranch_scc1 KF_CK54_R
KF_CK54_C:
    v_mfma_f32_32x32x16_bf16 v[100:115], v[140:143], v[132:135], v[100:115]
    s_add_u32 s25, s48, 6144
    buffer_load_dwordx4 v[132:135], v3, s[4:7], s25 offen sc1
    s_add_u32 s25, s27, 6144
    buffer_load_dwordx4 v[140:143], v3, s[4:7], s25 offen sc1
    s_waitcnt vmcnt(0)
    s_mov_b32 s36, 0
KF_CK55:
    v_max3_u32 v64, v132, v133, v134
    v_max_u32 v64, v64, v135
    v_cmp_eq_u32 s[34:35], -1, v64
    s_nop 0
    s_cmp_lg_u64 s[34:35], 0
    s_cbranch_scc1 KF_CK55_R
KF_CK55_C:
    v_mfma_f32_32x32x16_bf16 v[100:115], v[140:143], v[132:135], v[100:115]
    s_add_u32 s25, s48, 7168
    buffer_load_dwordx4 v[132:135], v3, s[4:7], s25 offen sc1
    s_add_u32 s25, s27, 7168
    buffer_load_dwordx4 v[140:143], v3, s[4:7], s25 offen sc1
    s_waitcnt vmcnt(0)
    s_mov_b32 s36, 0
KF_CK56:
    v_max3_u32 v64, v132, v133, v134
    v_max_u32 v64, v64, v135
    v_cmp_eq_u32 s[34:35], -1, v64
    s_nop 0
    s_cmp_lg_u64 s[34:35], 0
    s_cbranch_scc1 KF_CK56_R
KF_CK56_C:
    v_mfma_f32_32x32x16_bf16 v[100:115], v[140:143], v[132:135], v[100:115]
    s_add_u32 s25, s48, 8192
    buffer_load_dwordx4 v[132:135], v3, s[4:7], s25 offen sc1
    s_add_u32 s25, s27, 8192
    buffer_load_dwordx4 v[140:143], v3, s[4:7], s25 offen sc1
    s_waitcnt vmcnt(0)
    s_mov_b32 s36, 0
KF_CK57:
    v_max3_u32 v64, v132, v133, v134
    v_max_u32 v64, v64, v135
    v_cmp_eq_u32 s[34:35], -1, v64
    s_nop 0
    s_cmp_lg_u64 s[34:35], 0
    s_cbranch_scc1 KF_CK57_R
KF_CK57_C:
    v_mfma_f32_32x32x16_bf16 v[100:115], v[140:143], v[132:135], v[100:115]
    s_add_u32 s25, s48, 9216
    buffer_load_dwordx4 v[132:135], v3, s[4:7], s25 offen sc1
    s_add_u32 s25, s27, 9216
    buffer_load_dwordx4 v[140:143], v3, s[4:7], s25 offen sc1
    s_waitcnt vmcnt(0)
    s_mov_b32 s36, 0
KF_CK58:
    v_max3_u32 v64, v132, v133, v134
    v_max_u32 v64, v64, v135
    v_cmp_eq_u32 s[34:35], -1, v64
    s_nop 0
    s_cmp_lg_u64 s[34:35], 0
    s_cbranch_scc1 KF_CK58_R
KF_CK58_C:
    v_mfma_f32_32x32x16_bf16 v[100:115], v[140:143], v[132:135], v[100:115]
    s_add_u32 s25, s48, 10240
    buffer_load_dwordx4 v[132:135], v3, s[4:7], s25 offen sc1
    s_add_u32 s25, s27, 10240
    buffer_load_dwordx4 v[140:143], v3, s[4:7], s25 offen sc1
    s_waitcnt vmcnt(0)
    s_mov_b32 s36, 0
KF_CK59:
    v_max3_u32 v64, v132, v133, v134
    v_max_u32 v64, v64, v135
    v_cmp_eq_u32 s[34:35], -1, v64
    s_nop 0
    s_cmp_lg_u64 s[34:35], 0
    s_cbranch_scc1 KF_CK59_R
KF_CK59_C:
    v_mfma_f32_32x32x16_bf16 v[100:115], v[140:143], v[132:135], v[100:115]
    s_add_u32 s25, s48, 11264
    buffer_load_dwordx4 v[132:135], v3, s[4:7], s25 offen sc1
    s_add_u32 s25, s27, 11264
    buffer_load_dwordx4 v[140:143], v3, s[4:7], s25 offen sc1
    s_waitcnt vmcnt(0)
    s_mov_b32 s36, 0
KF_CK60:
    v_max3_u32 v64, v132, v133, v134
    v_max_u32 v64, v64, v135
    v_cmp_eq_u32 s[34:35], -1, v64
    s_nop 0
    s_cmp_lg_u64 s[34:35], 0
    s_cbranch_scc1 KF_CK60_R
KF_CK60_C:
    v_mfma_f32_32x32x16_bf16 v[100:115], v[140:143], v[132:135], v[100:115]
    s_add_u32 s25, s48, 12288
    buffer_load_dwordx4 v[132:135], v3, s[4:7], s25 offen sc1
    s_add_u32 s25, s27, 12288
    buffer_load_dwordx4 v[140:143], v3, s[4:7], s25 offen sc1
    s_waitcnt vmcnt(0)
    s_mov_b32 s36, 0
KF_CK61:
    v_max3_u32 v64, v132, v133, v134
    v_max_u32 v64, v64, v135
    v_cmp_eq_u32 s[34:35], -1, v64
    s_nop 0
    s_cmp_lg_u64 s[34:35], 0
    s_cbranch_scc1 KF_CK61_R
KF_CK61_C:
    v_mfma_f32_32x32x16_bf16 v[100:115], v[140:143], v[132:135], v[100:115]
    s_add_u32 s25, s48, 13312
    buffer_load_dwordx4 v[132:135], v3, s[4:7], s25 offen sc1
    s_add_u32 s25, s27, 13312
    buffer_load_dwordx4 v[140:143], v3, s[4:7], s25 offen sc1
    s_waitcnt vmcnt(0)
    s_mov_b32 s36, 0
KF_CK62:
    v_max3_u32 v64, v132, v133, v134
    v_max_u32 v64, v64, v135
    v_cmp_eq_u32 s[34:35], -1, v64
    s_nop 0
    s_cmp_lg_u64 s[34:35], 0
    s_cbranch_scc1 KF_CK62_R
KF_CK62_C:
    v_mfma_f32_32x32x16_bf16 v[100:115], v[140:143], v[132:135], v[100:115]
    s_add_u32 s25, s48, 14336
    buffer_load_dwordx4 v[132:135], v3, s[4:7], s25 offen sc1
    s_add_u32 s25, s27, 14336
    buffer_load_dwordx4 v[140:143], v3, s[4:7], s25 offen sc1
    s_waitcnt vmcnt(0)
    s_mov_b32 s36, 0
KF_CK63:
    v_max3_u32 v64, v132, v133, v134
    v_max_u32 v64, v64, v135
    v_cmp_eq_u32 s[34:35], -1, v64
    s_nop 0
    s_cmp_lg_u64 s[34:35], 0
    s_cbranch_scc1 KF_CK63_R
KF_CK63_C:
    v_mfma_f32_32x32x16_bf16 v[100:115], v[140:143], v[132:135], v[100:115]
    s_add_u32 s25, s48, 15360
    buffer_load_dwordx4 v[132:135], v3, s[4:7], s25 offen sc1
    s_add_u32 s25, s27, 15360
    buffer_load_dwordx4 v[140:143], v3, s[4:7], s25 offen sc1
    s_waitcnt vmcnt(0)
    s_mov_b32 s36, 0
KF_CK64:
    v_max3_u32 v64, v132, v133, v134
    v_max_u32 v64, v64, v135
    v_cmp_eq_u32 s[34:35], -1, v64
    s_nop 0
    s_cmp_lg_u64 s[34:35], 0
    s_cbranch_scc1 KF_CK64_R
KF_CK64_C:
    v_mfma_f32_32x32x16_bf16 v[100:115], v[140:143], v[132:135], v[100:115]
    s_add_u32 s25, s48, 16384
    buffer_load_dwordx4 v[132:135], v3, s[4:7], s25 offen sc1
    s_add_u32 s25, s27, 16384
    buffer_load_dwordx4 v[140:143], v3, s[4:7], s25 offen sc1
    s_waitcnt vmcnt(0)
    s_mov_b32 s36, 0
KF_CK65:
    v_max3_u32 v64, v132, v133, v134
    v_max_u32 v64, v64, v135
    v_cmp_eq_u32 s[34:35], -1, v64
    s_nop 0
    s_cmp_lg_u64 s[34:35], 0
    s_cbranch_scc1 KF_CK65_R
KF_CK65_C:
    v_mfma_f32_32x32x16_bf16 v[100:115], v[140:143], v[132:135], v[100:115]
    s_add_u32 s25, s48, 17408
    buffer_load_dwordx4 v[132:135], v3, s[4:7], s25 offen sc1
    s_add_u32 s25, s27, 17408
    buffer_load_dwordx4 v[140:143], v3, s[4:7], s25 offen sc1
    s_waitcnt vmcnt(0)
    s_mov_b32 s36, 0
KF_CK66:
    v_max3_u32 v64, v132, v133, v134
    v_max_u32 v64, v64, v135
    v_cmp_eq_u32 s[34:35], -1, v64
    s_nop 0
    s_cmp_lg_u64 s[34:35], 0
    s_cbranch_scc1 KF_CK66_R
KF_CK66_C:
    v_mfma_f32_32x32x16_bf16 v[100:115], v[140:143], v[132:135], v[100:115]
    s_add_u32 s25, s48, 18432
    buffer_load_dwordx4 v[132:135], v3, s[4:7], s25 offen sc1
    s_add_u32 s25, s27, 18432
    buffer_load_dwordx4 v[140:143], v3, s[4:7], s25 offen sc1
    s_waitcnt vmcnt(0)
    s_mov_b32 s36, 0
KF_CK67:
    v_max3_u32 v64, v132, v133, v134
    v_max_u32 v64, v64, v135
    v_cmp_eq_u32 s[34:35], -1, v64
    s_nop 0
    s_cmp_lg_u64 s[34:35], 0
    s_cbranch_scc1 KF_CK67_R
KF_CK67_C:
    v_mfma_f32_32x32x16_bf16 v[100:115], v[140:143], v[132:135], v[100:115]
    s_add_u32 s25, s48, 19456
    buffer_load_dwordx4 v[132:135], v3, s[4:7], s25 offen sc1
    s_add_u32 s25, s27, 19456
    buffer_load_dwordx4 v[140:143], v3, s[4:7], s25 offen sc1
    s_waitcnt vmcnt(0)
    s_mov_b32 s36, 0
KF_CK68:
    v_max3_u32 v64, v132, v133, v134
    v_max_u32 v64, v64, v135
    v_cmp_eq_u32 s[34:35], -1, v64
    s_nop 0
    s_cmp_lg_u64 s[34:35], 0
    s_cbranch_scc1 KF_CK68_R
KF_CK68_C:
    v_mfma_f32_32x32x16_bf16 v[100:115], v[140:143], v[132:135], v[100:115]
    s_add_u32 s25, s48, 20480
    buffer_load_dwordx4 v[132:135], v3, s[4:7], s25 offen sc1
    s_add_u32 s25, s27, 20480
    buffer_load_dwordx4 v[140:143], v3, s[4:7], s25 offen sc1
    s_waitcnt vmcnt(0)
    s_mov_b32 s36, 0
KF_CK69:
    v_max3_u32 v64, v132, v133, v134
    v_max_u32 v64, v64, v135
    v_cmp_eq_u32 s[34:35], -1, v64
    s_nop 0
    s_cmp_lg_u64 s[34:35], 0
    s_cbranch_scc1 KF_CK69_R
KF_CK69_C:
    v_mfma_f32_32x32x16_bf16 v[100:115], v[140:143], v[132:135], v[100:115]
    s_add_u32 s25, s48, 21504
    buffer_load_dwordx4 v[132:135], v3, s[4:7], s25 offen sc1
    s_add_u32 s25, s27, 21504
    buffer_load_dwordx4 v[140:143], v3, s[4:7], s25 offen sc1
    s_waitcnt vmcnt(0)
    s_mov_b32 s36, 0
KF_CK70:
    v_max3_u32 v64, v132, v133, v134
    v_max_u32 v64, v64, v135
    v_cmp_eq_u32 s[34:35], -1, v64
    s_nop 0
    s_cmp_lg_u64 s[34:35], 0
    s_cbranch_scc1 KF_CK70_R
KF_CK70_C:
    v_mfma_f32_32x32x16_bf16 v[100:115], v[140:143], v[132:135], v[100:115]
    s_add_u32 s25, s48, 22528
    buffer_load_dwordx4 v[132:135], v3, s[4:7], s25 offen sc1
    s_add_u32 s25, s27, 22528
    buffer_load_dwordx4 v[140:143], v3, s[4:7], s25 offen sc1
    s_waitcnt vmcnt(0)
    s_mov_b32 s36, 0
KF_CK71:
    v_max3_u32 v64, v132, v133, v134
    v_max_u32 v64, v64, v135
    v_cmp_eq_u32 s[34:35], -1, v64
    s_nop 0
    s_cmp_lg_u64 s[34:35], 0
    s_cbranch_scc1 KF_CK71_R
KF_CK71_C:
    v_mfma_f32_32x32x16_bf16 v[100:115], v[140:143], v[132:135], v[100:115]
    s_add_u32 s25, s48, 23552
    buffer_load_dwordx4 v[132:135], v3, s[4:7], s25 offen sc1
    s_add_u32 s25, s27, 23552
    buffer_load_dwordx4 v[140:143], v3, s[4:7], s25 offen sc1
    s_waitcnt vmcnt(0)
    s_mov_b32 s36, 0
KF_CK72:
    v_max3_u32 v64, v132, v133, v134
    v_max_u32 v64, v64, v135
    v_cmp_eq_u32 s[34:35], -1, v64
    s_nop 0
    s_cmp_lg_u64 s[34:35], 0
    s_cbranch_scc1 KF_CK72_R
KF_CK72_C:
    v_mfma_f32_32x32x16_bf16 v[100:115], v[140:143], v[132:135], v[100:115]
    s_add_u32 s25, s48, 24576
    buffer_load_dwordx4 v[132:135], v3, s[4:7], s25 offen sc1
    s_add_u32 s25, s27, 24576
    buffer_load_dwordx4 v[140:143], v3, s[4:7], s25 offen sc1
    s_waitcnt vmcnt(0)
    s_mov_b32 s36, 0
KF_CK73:
    v_max3_u32 v64, v132, v133, v134
    v_max_u32 v64, v64, v135
    v_cmp_eq_u32 s[34:35], -1, v64
    s_nop 0
    s_cmp_lg_u64 s[34:35], 0
    s_cbranch_scc1 KF_CK73_R
KF_CK73_C:
    v_mfma_f32_32x32x16_bf16 v[100:115], v[140:143], v[132:135], v[100:115]
    s_add_u32 s25, s48, 25600
    buffer_load_dwordx4 v[132:135], v3, s[4:7], s25 offen sc1
    s_add_u32 s25, s27, 25600
    buffer_load_dwordx4 v[140:143], v3, s[4:7], s25 offen sc1
    s_waitcnt vmcnt(0)
    s_mov_b32 s36, 0
KF_CK74:
    v_max3_u32 v64, v132, v133, v134
    v_max_u32 v64, v64, v135
    v_cmp_eq_u32 s[34:35], -1, v64
    s_nop 0
    s_cmp_lg_u64 s[34:35], 0
    s_cbranch_scc1 KF_CK74_R
KF_CK74_C:
    v_mfma_f32_32x32x16_bf16 v[100:115], v[140:143], v[132:135], v[100:115]
    s_add_u32 s25, s48, 26624
    buffer_load_dwordx4 v[132:135], v3, s[4:7], s25 offen sc1
    s_add_u32 s25, s27, 26624
    buffer_load_dwordx4 v[140:143], v3, s[4:7], s25 offen sc1
    s_waitcnt vmcnt(0)
    s_mov_b32 s36, 0
KF_CK75:
    v_max3_u32 v64, v132, v133, v134
    v_max_u32 v64, v64, v135
    v_cmp_eq_u32 s[34:35], -1, v64
    s_nop 0
    s_cmp_lg_u64 s[34:35], 0
    s_cbranch_scc1 KF_CK75_R
KF_CK75_C:
    v_mfma_f32_32x32x16_bf16 v[100:115], v[140:143], v[132:135], v[100:115]
    s_add_u32 s25, s48, 27648
    buffer_load_dwordx4 v[132:135], v3, s[4:7], s25 offen sc1
    s_add_u32 s25, s27, 27648
    buffer_load_dwordx4 v[140:143], v3, s[4:7], s25 offen sc1
    s_waitcnt vmcnt(0)
    s_mov_b32 s36, 0
KF_CK76:
    v_max3_u32 v64, v132, v133, v134
    v_max_u32 v64, v64, v135
    v_cmp_eq_u32 s[34:35], -1, v64
    s_nop 0
    s_cmp_lg_u64 s[34:35], 0
    s_cbranch_scc1 KF_CK76_R
KF_CK76_C:
    v_mfma_f32_32x32x16_bf16 v[100:115], v[140:143], v[132:135], v[100:115]
    s_add_u32 s25, s48, 28672
    buffer_load_dwordx4 v[132:135], v3, s[4:7], s25 offen sc1
    s_add_u32 s25, s27, 28672
    buffer_load_dwordx4 v[140:143], v3, s[4:7], s25 offen sc1
    s_waitcnt vmcnt(0)
    s_mov_b32 s36, 0
KF_CK77:
    v_max3_u32 v64, v132, v133, v134
    v_max_u32 v64, v64, v135
    v_cmp_eq_u32 s[34:35], -1, v64
    s_nop 0
    s_cmp_lg_u64 s[34:35], 0
    s_cbranch_scc1 KF_CK77_R
KF_CK77_C:
    v_mfma_f32_32x32x16_bf16 v[100:115], v[140:143], v[132:135], v[100:115]
    s_add_u32 s25, s48, 29696
    buffer_load_dwordx4 v[132:135], v3, s[4:7], s25 offen sc1
    s_add_u32 s25, s27, 29696
    buffer_load_dwordx4 v[140:143], v3, s[4:7], s25 offen sc1
    s_waitcnt vmcnt(0)
    s_mov_b32 s36, 0
KF_CK78:
    v_max3_u32 v64, v132, v133, v134
    v_max_u32 v64, v64, v135
    v_cmp_eq_u32 s[34:35], -1, v64
    s_nop 0
    s_cmp_lg_u64 s[34:35], 0
    s_cbranch_scc1 KF_CK78_R
KF_CK78_C:
    v_mfma_f32_32x32x16_bf16 v[100:115], v[140:143], v[132:135], v[100:115]
    s_add_u32 s25, s48, 30720
    buffer_load_dwordx4 v[132:135], v3, s[4:7], s25 offen sc1
    s_add_u32 s25, s27, 30720
    buffer_load_dwordx4 v[140:143], v3, s[4:7], s25 offen sc1
    s_waitcnt vmcnt(0)
    s_mov_b32 s36, 0
KF_CK79:
    v_max3_u32 v64, v132, v133, v134
    v_max_u32 v64, v64, v135
    v_cmp_eq_u32 s[34:35], -1, v64
    s_nop 0
    s_cmp_lg_u64 s[34:35], 0
    s_cbranch_scc1 KF_CK79_R
KF_CK79_C:
    v_mfma_f32_32x32x16_bf16 v[100:115], v[140:143], v[132:135], v[100:115]
    s_add_u32 s25, s48, 31744
    buffer_load_dwordx4 v[132:135], v3, s[4:7], s25 offen sc1
    s_add_u32 s25, s27, 31744
    buffer_load_dwordx4 v[140:143], v3, s[4:7], s25 offen sc1
    s_waitcnt vmcnt(0)
    s_mov_b32 s36, 0
KF_CK80:
    v_max3_u32 v64, v132, v133, v134
    v_max_u32 v64, v64, v135
    v_cmp_eq_u32 s[34:35], -1, v64
    s_nop 0
    s_cmp_lg_u64 s[34:35], 0
    s_cbranch_scc1 KF_CK80_R
KF_CK80_C:
    v_mfma_f32_32x32x16_bf16 v[100:115], v[140:143], v[132:135], v[100:115]
    s_waitcnt lgkmcnt(0)
    v_mfma_f32_32x32x16_bf16 v[100:115], v[160:163], v[136:139], v[100:115]
    s_nop 15
    s_branch KF_GS0_R
KF_GS1:
    ds_read_b128 v[136:139], v65 offset:32768
    s_add_u32 s25, s48, 32768
    buffer_load_dwordx4 v[132:135], v3, s[4:7], s25 offen sc1
    s_add_u32 s25, s27, 0
    buffer_load_dwordx4 v[140:143], v3, s[4:7], s25 offen sc1
    s_waitcnt vmcnt(0)
    s_mov_b32 s36, 0
KF_CK81:
    v_max3_u32 v64, v132, v133, v134
    v_max_u32 v64, v64, v135
    v_cmp_eq_u32 s[34:35], -1, v64
    s_nop 0
    s_cmp_lg_u64 s[34:35], 0
    s_cbranch_scc1 KF_CK81_R
KF_CK81_C:
    v_mfma_f32_32x32x16_bf16 v[116:131], v[140:143], v[132:135], 0
    s_add_u32 s25, s48, 33792
    buffer_load_dwordx4 v[132:135], v3, s[4:7], s25 offen sc1
    s_add_u32 s25, s27, 1024
    buffer_load_dwordx4 v[140:143], v3, s[4:7], s25 offen sc1
    s_waitcnt vmcnt(0)
    s_mov_b32 s36, 0
KF_CK82:
    v_max3_u32 v64, v132, v133, v134
    v_max_u32 v64, v64, v135
    v_cmp_eq_u32 s[34:35], -1, v64
    s_nop 0
    s_cmp_lg_u64 s[34:35], 0
    s_cbranch_scc1 KF_CK82_R
KF_CK82_C:
    v_mfma_f32_32x32x16_bf16 v[116:131], v[140:143], v[132:135], v[116:131]
    s_add_u32 s25, s48, 34816
    buffer_load_dwordx4 v[132:135], v3, s[4:7], s25 offen sc1
    s_add_u32 s25, s27, 2048
    buffer_load_dwordx4 v[140:143], v3, s[4:7], s25 offen sc1
    s_waitcnt vmcnt(0)
    s_mov_b32 s36, 0
KF_CK83:
    v_max3_u32 v64, v132, v133, v134
    v_max_u32 v64, v64, v135
    v_cmp_eq_u32 s[34:35], -1, v64
    s_nop 0
    s_cmp_lg_u64 s[34:35], 0
    s_cbranch_scc1 KF_CK83_R
KF_CK83_C:
    v_mfma_f32_32x32x16_bf16 v[116:131], v[140:143], v[132:135], v[116:131]
    s_add_u32 s25, s48, 35840
    buffer_load_dwordx4 v[132:135], v3, s[4:7], s25 offen sc1
    s_add_u32 s25, s27, 3072
    buffer_load_dwordx4 v[140:143], v3, s[4:7], s25 offen sc1
    s_waitcnt vmcnt(0)
    s_mov_b32 s36, 0
KF_CK84:
    v_max3_u32 v64, v132, v133, v134
    v_max_u32 v64, v64, v135
    v_cmp_eq_u32 s[34:35], -1, v64
    s_nop 0
    s_cmp_lg_u64 s[34:35], 0
    s_cbranch_scc1 KF_CK84_R
KF_CK84_C:
    v_mfma_f32_32x32x16_bf16 v[116:131], v[140:143], v[132:135], v[116:131]
    s_add_u32 s25, s48, 36864
    buffer_load_dwordx4 v[132:135], v3, s[4:7], s25 offen sc1
    s_add_u32 s25, s27, 4096
    buffer_load_dwordx4 v[140:143], v3, s[4:7], s25 offen sc1
    s_waitcnt vmcnt(0)
    s_mov_b32 s36, 0
KF_CK85:
    v_max3_u32 v64, v132, v133, v134
    v_max_u32 v64, v64, v135
    v_cmp_eq_u32 s[34:35], -1, v64
    s_nop 0
    s_cmp_lg_u64 s[34:35], 0
    s_cbranch_scc1 KF_CK85_R
KF_CK85_C:
    v_mfma_f32_32x32x16_bf16 v[116:131], v[140:143], v[132:135], v[116:131]
    s_add_u32 s25, s48, 37888
    buffer_load_dwordx4 v[132:135], v3, s[4:7], s25 offen sc1
    s_add_u32 s25, s27, 5120
    buffer_load_dwordx4 v[140:143], v3, s[4:7], s25 offen sc1
    s_waitcnt vmcnt(0)
    s_mov_b32 s36, 0
KF_CK86:
    v_max3_u32 v64, v132, v133, v134
    v_max_u32 v64, v64, v135
    v_cmp_eq_u32 s[34:35], -1, v64
    s_nop 0
    s_cmp_lg_u64 s[34:35], 0
    s_cbranch_scc1 KF_CK86_R
KF_CK86_C:
    v_mfma_f32_32x32x16_bf16 v[116:131], v[140:143], v[132:135], v[116:131]
    s_add_u32 s25, s48, 38912
    buffer_load_dwordx4 v[132:135], v3, s[4:7], s25 offen sc1
    s_add_u32 s25, s27, 6144
    buffer_load_dwordx4 v[140:143], v3, s[4:7], s25 offen sc1
    s_waitcnt vmcnt(0)
    s_mov_b32 s36, 0
KF_CK87:
    v_max3_u32 v64, v132, v133, v134
    v_max_u32 v64, v64, v135
    v_cmp_eq_u32 s[34:35], -1, v64
    s_nop 0
    s_cmp_lg_u64 s[34:35], 0
    s_cbranch_scc1 KF_CK87_R
KF_CK87_C:
    v_mfma_f32_32x32x16_bf16 v[116:131], v[140:143], v[132:135], v[116:131]
    s_add_u32 s25, s48, 39936
    buffer_load_dwordx4 v[132:135], v3, s[4:7], s25 offen sc1
    s_add_u32 s25, s27, 7168
    buffer_load_dwordx4 v[140:143], v3, s[4:7], s25 offen sc1
    s_waitcnt vmcnt(0)
    s_mov_b32 s36, 0
KF_CK88:
    v_max3_u32 v64, v132, v133, v134
    v_max_u32 v64, v64, v135
    v_cmp_eq_u32 s[34:35], -1, v64
    s_nop 0
    s_cmp_lg_u64 s[34:35], 0
    s_cbranch_scc1 KF_CK88_R
KF_CK88_C:
    v_mfma_f32_32x32x16_bf16 v[116:131], v[140:143], v[132:135], v[116:131]
    s_add_u32 s25, s48, 40960
    buffer_load_dwordx4 v[132:135], v3, s[4:7], s25 offen sc1
    s_add_u32 s25, s27, 8192
    buffer_load_dwordx4 v[140:143], v3, s[4:7], s25 offen sc1
    s_waitcnt vmcnt(0)
    s_mov_b32 s36, 0
KF_CK89:
    v_max3_u32 v64, v132, v133, v134
    v_max_u32 v64, v64, v135
    v_cmp_eq_u32 s[34:35], -1, v64
    s_nop 0
    s_cmp_lg_u64 s[34:35], 0
    s_cbranch_scc1 KF_CK89_R
KF_CK89_C:
    v_mfma_f32_32x32x16_bf16 v[116:131], v[140:143], v[132:135], v[116:131]
    s_add_u32 s25, s48, 41984
    buffer_load_dwordx4 v[132:135], v3, s[4:7], s25 offen sc1
    s_add_u32 s25, s27, 9216
    buffer_load_dwordx4 v[140:143], v3, s[4:7], s25 offen sc1
    s_waitcnt vmcnt(0)
    s_mov_b32 s36, 0
KF_CK90:
    v_max3_u32 v64, v132, v133, v134
    v_max_u32 v64, v64, v135
    v_cmp_eq_u32 s[34:35], -1, v64
    s_nop 0
    s_cmp_lg_u64 s[34:35], 0
    s_cbranch_scc1 KF_CK90_R
KF_CK90_C:
    v_mfma_f32_32x32x16_bf16 v[116:131], v[140:143], v[132:135], v[116:131]
    s_add_u32 s25, s48, 43008
    buffer_load_dwordx4 v[132:135], v3, s[4:7], s25 offen sc1
    s_add_u32 s25, s27, 10240
    buffer_load_dwordx4 v[140:143], v3, s[4:7], s25 offen sc1
    s_waitcnt vmcnt(0)
    s_mov_b32 s36, 0
KF_CK91:
    v_max3_u32 v64, v132, v133, v134
    v_max_u32 v64, v64, v135
    v_cmp_eq_u32 s[34:35], -1, v64
    s_nop 0
    s_cmp_lg_u64 s[34:35], 0
    s_cbranch_scc1 KF_CK91_R
KF_CK91_C:
    v_mfma_f32_32x32x16_bf16 v[116:131], v[140:143], v[132:135], v[116:131]
    s_add_u32 s25, s48, 44032
    buffer_load_dwordx4 v[132:135], v3, s[4:7], s25 offen sc1
    s_add_u32 s25, s27, 11264
    buffer_load_dwordx4 v[140:143], v3, s[4:7], s25 offen sc1
    s_waitcnt vmcnt(0)
    s_mov_b32 s36, 0
KF_CK92:
    v_max3_u32 v64, v132, v133, v134
    v_max_u32 v64, v64, v135
    v_cmp_eq_u32 s[34:35], -1, v64
    s_nop 0
    s_cmp_lg_u64 s[34:35], 0
    s_cbranch_scc1 KF_CK92_R
KF_CK92_C:
    v_mfma_f32_32x32x16_bf16 v[116:131], v[140:143], v[132:135], v[116:131]
    s_add_u32 s25, s48, 45056
    buffer_load_dwordx4 v[132:135], v3, s[4:7], s25 offen sc1
    s_add_u32 s25, s27, 12288
    buffer_load_dwordx4 v[140:143], v3, s[4:7], s25 offen sc1
    s_waitcnt vmcnt(0)
    s_mov_b32 s36, 0
KF_CK93:
    v_max3_u32 v64, v132, v133, v134
    v_max_u32 v64, v64, v135
    v_cmp_eq_u32 s[34:35], -1, v64
    s_nop 0
    s_cmp_lg_u64 s[34:35], 0
    s_cbranch_scc1 KF_CK93_R
KF_CK93_C:
    v_mfma_f32_32x32x16_bf16 v[116:131], v[140:143], v[132:135], v[116:131]
    s_add_u32 s25, s48, 46080
    buffer_load_dwordx4 v[132:135], v3, s[4:7], s25 offen sc1
    s_add_u32 s25, s27, 13312
    buffer_load_dwordx4 v[140:143], v3, s[4:7], s25 offen sc1
    s_waitcnt vmcnt(0)
    s_mov_b32 s36, 0
KF_CK94:
    v_max3_u32 v64, v132, v133, v134
    v_max_u32 v64, v64, v135
    v_cmp_eq_u32 s[34:35], -1, v64
    s_nop 0
    s_cmp_lg_u64 s[34:35], 0
    s_cbranch_scc1 KF_CK94_R
KF_CK94_C:
    v_mfma_f32_32x32x16_bf16 v[116:131], v[140:143], v[132:135], v[116:131]
    s_add_u32 s25, s48, 47104
    buffer_load_dwordx4 v[132:135], v3, s[4:7], s25 offen sc1
    s_add_u32 s25, s27, 14336
    buffer_load_dwordx4 v[140:143], v3, s[4:7], s25 offen sc1
    s_waitcnt vmcnt(0)
    s_mov_b32 s36, 0
KF_CK95:
    v_max3_u32 v64, v132, v133, v134
    v_max_u32 v64, v64, v135
    v_cmp_eq_u32 s[34:35], -1, v64
    s_nop 0
    s_cmp_lg_u64 s[34:35], 0
    s_cbranch_scc1 KF_CK95_R
KF_CK95_C:
    v_mfma_f32_32x32x16_bf16 v[116:131], v[140:143], v[132:135], v[116:131]
    s_add_u32 s25, s48, 48128
    buffer_load_dwordx4 v[132:135], v3, s[4:7], s25 offen sc1
    s_add_u32 s25, s27, 15360
    buffer_load_dwordx4 v[140:143], v3, s[4:7], s25 offen sc1
    s_waitcnt vmcnt(0)
    s_mov_b32 s36, 0
KF_CK96:
    v_max3_u32 v64, v132, v133, v134
    v_max_u32 v64, v64, v135
    v_cmp_eq_u32 s[34:35], -1, v64
    s_nop 0
    s_cmp_lg_u64 s[34:35], 0
    s_cbranch_scc1 KF_CK96_R
KF_CK96_C:
    v_mfma_f32_32x32x16_bf16 v[116:131], v[140:143], v[132:135], v[116:131]
    s_add_u32 s25, s48, 49152
    buffer_load_dwordx4 v[132:135], v3, s[4:7], s25 offen sc1
    s_add_u32 s25, s27, 16384
    buffer_load_dwordx4 v[140:143], v3, s[4:7], s25 offen sc1
    s_waitcnt vmcnt(0)
    s_mov_b32 s36, 0
KF_CK97:
    v_max3_u32 v64, v132, v133, v134
    v_max_u32 v64, v64, v135
    v_cmp_eq_u32 s[34:35], -1, v64
    s_nop 0
    s_cmp_lg_u64 s[34:35], 0
    s_cbranch_scc1 KF_CK97_R
KF_CK97_C:
    v_mfma_f32_32x32x16_bf16 v[116:131], v[140:143], v[132:135], v[116:131]
    s_add_u32 s25, s48, 50176
    buffer_load_dwordx4 v[132:135], v3, s[4:7], s25 offen sc1
    s_add_u32 s25, s27, 17408
    buffer_load_dwordx4 v[140:143], v3, s[4:7], s25 offen sc1
    s_waitcnt vmcnt(0)
    s_mov_b32 s36, 0
KF_CK98:
    v_max3_u32 v64, v132, v133, v134
    v_max_u32 v64, v64, v135
    v_cmp_eq_u32 s[34:35], -1, v64
    s_nop 0
    s_cmp_lg_u64 s[34:35], 0
    s_cbranch_scc1 KF_CK98_R
KF_CK98_C:
    v_mfma_f32_32x32x16_bf16 v[116:131], v[140:143], v[132:135], v[116:131]
    s_add_u32 s25, s48, 51200
    buffer_load_dwordx4 v[132:135], v3, s[4:7], s25 offen sc1
    s_add_u32 s25, s27, 18432
    buffer_load_dwordx4 v[140:143], v3, s[4:7], s25 offen sc1
    s_waitcnt vmcnt(0)
    s_mov_b32 s36, 0
KF_CK99:
    v_max3_u32 v64, v132, v133, v134
    v_max_u32 v64, v64, v135
    v_cmp_eq_u32 s[34:35], -1, v64
    s_nop 0
    s_cmp_lg_u64 s[34:35], 0
    s_cbranch_scc1 KF_CK99_R
KF_CK99_C:
    v_mfma_f32_32x32x16_bf16 v[116:131], v[140:143], v[132:135], v[116:131]
    s_add_u32 s25, s48, 52224
    buffer_load_dwordx4 v[132:135], v3, s[4:7], s25 offen sc1
    s_add_u32 s25, s27, 19456
    buffer_load_dwordx4 v[140:143], v3, s[4:7], s25 offen sc1
    s_waitcnt vmcnt(0)
    s_mov_b32 s36, 0
KF_CK100:
    v_max3_u32 v64, v132, v133, v134
    v_max_u32 v64, v64, v135
    v_cmp_eq_u32 s[34:35], -1, v64
    s_nop 0
    s_cmp_lg_u64 s[34:35], 0
    s_cbranch_scc1 KF_CK100_R
KF_CK100_C:
    v_mfma_f32_32x32x16_bf16 v[116:131], v[140:143], v[132:135], v[116:131]
    s_add_u32 s25, s48, 53248
    buffer_load_dwordx4 v[132:135], v3, s[4:7], s25 offen sc1
    s_add_u32 s25, s27, 20480
    buffer_load_dwordx4 v[140:143], v3, s[4:7], s25 offen sc1
    s_waitcnt vmcnt(0)
    s_mov_b32 s36, 0
KF_CK101:
    v_max3_u32 v64, v132, v133, v134
    v_max_u32 v64, v64, v135
    v_cmp_eq_u32 s[34:35], -1, v64
    s_nop 0
    s_cmp_lg_u64 s[34:35], 0
    s_cbranch_scc1 KF_CK101_R
KF_CK101_C:
    v_mfma_f32_32x32x16_bf16 v[116:131], v[140:143], v[132:135], v[116:131]
    s_add_u32 s25, s48, 54272
    buffer_load_dwordx4 v[132:135], v3, s[4:7], s25 offen sc1
    s_add_u32 s25, s27, 21504
    buffer_load_dwordx4 v[140:143], v3, s[4:7], s25 offen sc1
    s_waitcnt vmcnt(0)
    s_mov_b32 s36, 0
KF_CK102:
    v_max3_u32 v64, v132, v133, v134
    v_max_u32 v64, v64, v135
    v_cmp_eq_u32 s[34:35], -1, v64
    s_nop 0
    s_cmp_lg_u64 s[34:35], 0
    s_cbranch_scc1 KF_CK102_R
KF_CK102_C:
    v_mfma_f32_32x32x16_bf16 v[116:131], v[140:143], v[132:135], v[116:131]
    s_add_u32 s25, s48, 55296
    buffer_load_dwordx4 v[132:135], v3, s[4:7], s25 offen sc1
    s_add_u32 s25, s27, 22528
    buffer_load_dwordx4 v[140:143], v3, s[4:7], s25 offen sc1
    s_waitcnt vmcnt(0)
    s_mov_b32 s36, 0
KF_CK103:
    v_max3_u32 v64, v132, v133, v134
    v_max_u32 v64, v64, v135
    v_cmp_eq_u32 s[34:35], -1, v64
    s_nop 0
    s_cmp_lg_u64 s[34:35], 0
    s_cbranch_scc1 KF_CK103_R
KF_CK103_C:
    v_mfma_f32_32x32x16_bf16 v[116:131], v[140:143], v[132:135], v[116:131]
    s_add_u32 s25, s48, 56320
    buffer_load_dwordx4 v[132:135], v3, s[4:7], s25 offen sc1
    s_add_u32 s25, s27, 23552
    buffer_load_dwordx4 v[140:143], v3, s[4:7], s25 offen sc1
    s_waitcnt vmcnt(0)
    s_mov_b32 s36, 0
KF_CK104:
    v_max3_u32 v64, v132, v133, v134
    v_max_u32 v64, v64, v135
    v_cmp_eq_u32 s[34:35], -1, v64
    s_nop 0
    s_cmp_lg_u64 s[34:35], 0
    s_cbranch_scc1 KF_CK104_R
KF_CK104_C:
    v_mfma_f32_32x32x16_bf16 v[116:131], v[140:143], v[132:135], v[116:131]
    s_add_u32 s25, s48, 57344
    buffer_load_dwordx4 v[132:135], v3, s[4:7], s25 offen sc1
    s_add_u32 s25, s27, 24576
    buffer_load_dwordx4 v[140:143], v3, s[4:7], s25 offen sc1
    s_waitcnt vmcnt(0)
    s_mov_b32 s36, 0
KF_CK105:
    v_max3_u32 v64, v132, v133, v134
    v_max_u32 v64, v64, v135
    v_cmp_eq_u32 s[34:35], -1, v64
    s_nop 0
    s_cmp_lg_u64 s[34:35], 0
    s_cbranch_scc1 KF_CK105_R
KF_CK105_C:
    v_mfma_f32_32x32x16_bf16 v[116:131], v[140:143], v[132:135], v[116:131]
    s_add_u32 s25, s48, 58368
    buffer_load_dwordx4 v[132:135], v3, s[4:7], s25 offen sc1
    s_add_u32 s25, s27, 25600
    buffer_load_dwordx4 v[140:143], v3, s[4:7], s25 offen sc1
    s_waitcnt vmcnt(0)
    s_mov_b32 s36, 0
KF_CK106:
    v_max3_u32 v64, v132, v133, v134
    v_max_u32 v64, v64, v135
    v_cmp_eq_u32 s[34:35], -1, v64
    s_nop 0
    s_cmp_lg_u64 s[34:35], 0
    s_cbranch_scc1 KF_CK106_R
KF_CK106_C:
    v_mfma_f32_32x32x16_bf16 v[116:131], v[140:143], v[132:135], v[116:131]
    s_add_u32 s25, s48, 59392
    buffer_load_dwordx4 v[132:135], v3, s[4:7], s25 offen sc1
    s_add_u32 s25, s27, 26624
    buffer_load_dwordx4 v[140:143], v3, s[4:7], s25 offen sc1
    s_waitcnt vmcnt(0)
    s_mov_b32 s36, 0
KF_CK107:
    v_max3_u32 v64, v132, v133, v134
    v_max_u32 v64, v64, v135
    v_cmp_eq_u32 s[34:35], -1, v64
    s_nop 0
    s_cmp_lg_u64 s[34:35], 0
    s_cbranch_scc1 KF_CK107_R
KF_CK107_C:
    v_mfma_f32_32x32x16_bf16 v[116:131], v[140:143], v[132:135], v[116:131]
    s_add_u32 s25, s48, 60416
    buffer_load_dwordx4 v[132:135], v3, s[4:7], s25 offen sc1
    s_add_u32 s25, s27, 27648
    buffer_load_dwordx4 v[140:143], v3, s[4:7], s25 offen sc1
    s_waitcnt vmcnt(0)
    s_mov_b32 s36, 0
KF_CK108:
    v_max3_u32 v64, v132, v133, v134
    v_max_u32 v64, v64, v135
    v_cmp_eq_u32 s[34:35], -1, v64
    s_nop 0
    s_cmp_lg_u64 s[34:35], 0
    s_cbranch_scc1 KF_CK108_R
KF_CK108_C:
    v_mfma_f32_32x32x16_bf16 v[116:131], v[140:143], v[132:135], v[116:131]
    s_add_u32 s25, s48, 61440
    buffer_load_dwordx4 v[132:135], v3, s[4:7], s25 offen sc1
    s_add_u32 s25, s27, 28672
    buffer_load_dwordx4 v[140:143], v3, s[4:7], s25 offen sc1
    s_waitcnt vmcnt(0)
    s_mov_b32 s36, 0
KF_CK109:
    v_max3_u32 v64, v132, v133, v134
    v_max_u32 v64, v64, v135
    v_cmp_eq_u32 s[34:35], -1, v64
    s_nop 0
    s_cmp_lg_u64 s[34:35], 0
    s_cbranch_scc1 KF_CK109_R
KF_CK109_C:
    v_mfma_f32_32x32x16_bf16 v[116:131], v[140:143], v[132:135], v[116:131]
    s_add_u32 s25, s48, 62464
    buffer_load_dwordx4 v[132:135], v3, s[4:7], s25 offen sc1
    s_add_u32 s25, s27, 29696
    buffer_load_dwordx4 v[140:143], v3, s[4:7], s25 offen sc1
    s_waitcnt vmcnt(0)
    s_mov_b32 s36, 0
KF_CK110:
    v_max3_u32 v64, v132, v133, v134
    v_max_u32 v64, v64, v135
    v_cmp_eq_u32 s[34:35], -1, v64
    s_nop 0
    s_cmp_lg_u64 s[34:35], 0
    s_cbranch_scc1 KF_CK110_R
KF_CK110_C:
    v_mfma_f32_32x32x16_bf16 v[116:131], v[140:143], v[132:135], v[116:131]
    s_add_u32 s25, s48, 63488
    buffer_load_dwordx4 v[132:135], v3, s[4:7], s25 offen sc1
    s_add_u32 s25, s27, 30720
    buffer_load_dwordx4 v[140:143], v3, s[4:7], s25 offen sc1
    s_waitcnt vmcnt(0)
    s_mov_b32 s36, 0
KF_CK111:
    v_max3_u32 v64, v132, v133, v134
    v_max_u32 v64, v64, v135
    v_cmp_eq_u32 s[34:35], -1, v64
    s_nop 0
    s_cmp_lg_u64 s[34:35], 0
    s_cbranch_scc1 KF_CK111_R
KF_CK111_C:
    v_mfma_f32_32x32x16_bf16 v[116:131], v[140:143], v[132:135], v[116:131]
    s_add_u32 s25, s48, 64512
    buffer_load_dwordx4 v[132:135], v3, s[4:7], s25 offen sc1
    s_add_u32 s25, s27, 31744
    buffer_load_dwordx4 v[140:143], v3, s[4:7], s25 offen sc1
    s_waitcnt vmcnt(0)
    s_mov_b32 s36, 0
KF_CK112:
    v_max3_u32 v64, v132, v133, v134
    v_max_u32 v64, v64, v135
    v_cmp_eq_u32 s[34:35], -1, v64
    s_nop 0
    s_cmp_lg_u64 s[34:35], 0
    s_cbranch_scc1 KF_CK112_R
KF_CK112_C:
    v_mfma_f32_32x32x16_bf16 v[116:131], v[140:143], v[132:135], v[116:131]
    s_waitcnt lgkmcnt(0)
    v_mfma_f32_32x32x16_bf16 v[116:131], v[160:163], v[136:139], v[116:131]
    s_nop 15
    s_branch KF_GS1_R
KF_GS2:
    ds_read_b128 v[136:139], v66 offset:32768
    s_add_u32 s25, s48, 65536
    buffer_load_dwordx4 v[132:135], v3, s[4:7], s25 offen sc1
    s_add_u32 s25, s27, 0
    buffer_load_dwordx4 v[140:143], v3, s[4:7], s25 offen sc1
    s_waitcnt vmcnt(0)
    s_mov_b32 s36, 0
KF_CK113:
    v_max3_u32 v64, v132, v133, v134
    v_max_u32 v64, v64, v135
    v_cmp_eq_u32 s[34:35], -1, v64
    s_nop 0
    s_cmp_lg_u64 s[34:35], 0
    s_cbranch_scc1 KF_CK113_R
KF_CK113_C:
    v_mfma_f32_32x32x16_bf16 v[100:115], v[140:143], v[132:135], 0
    s_add_u32 s25, s48, 66560
    buffer_load_dwordx4 v[132:135], v3, s[4:7], s25 offen sc1
    s_add_u32 s25, s27, 1024
    buffer_load_dwordx4 v[140:143], v3, s[4:7], s25 offen sc1
    s_waitcnt vmcnt(0)
    s_mov_b32 s36, 0
KF_CK114:
    v_max3_u32 v64, v132, v133, v134
    v_max_u32 v64, v64, v135
    v_cmp_eq_u32 s[34:35], -1, v64
    s_nop 0
    s_cmp_lg_u64 s[34:35], 0
    s_cbranch_scc1 KF_CK114_R
KF_CK114_C:
    v_mfma_f32_32x32x16_bf16 v[100:115], v[140:143], v[132:135], v[100:115]
    s_add_u32 s25, s48, 67584
    buffer_load_dwordx4 v[132:135], v3, s[4:7], s25 offen sc1
    s_add_u32 s25, s27, 2048
    buffer_load_dwordx4 v[140:143], v3, s[4:7], s25 offen sc1
    s_waitcnt vmcnt(0)
    s_mov_b32 s36, 0
KF_CK115:
    v_max3_u32 v64, v132, v133, v134
    v_max_u32 v64, v64, v135
    v_cmp_eq_u32 s[34:35], -1, v64
    s_nop 0
    s_cmp_lg_u64 s[34:35], 0
    s_cbranch_scc1 KF_CK115_R
KF_CK115_C:
    v_mfma_f32_32x32x16_bf16 v[100:115], v[140:143], v[132:135], v[100:115]
    s_add_u32 s25, s48, 68608
    buffer_load_dwordx4 v[132:135], v3, s[4:7], s25 offen sc1
    s_add_u32 s25, s27, 3072
    buffer_load_dwordx4 v[140:143], v3, s[4:7], s25 offen sc1
    s_waitcnt vmcnt(0)
    s_mov_b32 s36, 0
KF_CK116:
    v_max3_u32 v64, v132, v133, v134
    v_max_u32 v64, v64, v135
    v_cmp_eq_u32 s[34:35], -1, v64
    s_nop 0
    s_cmp_lg_u64 s[34:35], 0
    s_cbranch_scc1 KF_CK116_R
KF_CK116_C:
    v_mfma_f32_32x32x16_bf16 v[100:115], v[140:143], v[132:135], v[100:115]
    s_add_u32 s25, s48, 69632
    buffer_load_dwordx4 v[132:135], v3, s[4:7], s25 offen sc1
    s_add_u32 s25, s27, 4096
    buffer_load_dwordx4 v[140:143], v3, s[4:7], s25 offen sc1
    s_waitcnt vmcnt(0)
    s_mov_b32 s36, 0
KF_CK117:
    v_max3_u32 v64, v132, v133, v134
    v_max_u32 v64, v64, v135
    v_cmp_eq_u32 s[34:35], -1, v64
    s_nop 0
    s_cmp_lg_u64 s[34:35], 0
    s_cbranch_scc1 KF_CK117_R
KF_CK117_C:
    v_mfma_f32_32x32x16_bf16 v[100:115], v[140:143], v[132:135], v[100:115]
    s_add_u32 s25, s48, 70656
    buffer_load_dwordx4 v[132:135], v3, s[4:7], s25 offen sc1
    s_add_u32 s25, s27, 5120
    buffer_load_dwordx4 v[140:143], v3, s[4:7], s25 offen sc1
    s_waitcnt vmcnt(0)
    s_mov_b32 s36, 0
KF_CK118:
    v_max3_u32 v64, v132, v133, v134
    v_max_u32 v64, v64, v135
    v_cmp_eq_u32 s[34:35], -1, v64
    s_nop 0
    s_cmp_lg_u64 s[34:35], 0
    s_cbranch_scc1 KF_CK118_R
KF_CK118_C:
    v_mfma_f32_32x32x16_bf16 v[100:115], v[140:143], v[132:135], v[100:115]
    s_add_u32 s25, s48, 71680
    buffer_load_dwordx4 v[132:135], v3, s[4:7], s25 offen sc1
    s_add_u32 s25, s27, 6144
    buffer_load_dwordx4 v[140:143], v3, s[4:7], s25 offen sc1
    s_waitcnt vmcnt(0)
    s_mov_b32 s36, 0
KF_CK119:
    v_max3_u32 v64, v132, v133, v134
    v_max_u32 v64, v64, v135
    v_cmp_eq_u32 s[34:35], -1, v64
    s_nop 0
    s_cmp_lg_u64 s[34:35], 0
    s_cbranch_scc1 KF_CK119_R
KF_CK119_C:
    v_mfma_f32_32x32x16_bf16 v[100:115], v[140:143], v[132:135], v[100:115]
    s_add_u32 s25, s48, 72704
    buffer_load_dwordx4 v[132:135], v3, s[4:7], s25 offen sc1
    s_add_u32 s25, s27, 7168
    buffer_load_dwordx4 v[140:143], v3, s[4:7], s25 offen sc1
    s_waitcnt vmcnt(0)
    s_mov_b32 s36, 0
KF_CK120:
    v_max3_u32 v64, v132, v133, v134
    v_max_u32 v64, v64, v135
    v_cmp_eq_u32 s[34:35], -1, v64
    s_nop 0
    s_cmp_lg_u64 s[34:35], 0
    s_cbranch_scc1 KF_CK120_R
KF_CK120_C:
    v_mfma_f32_32x32x16_bf16 v[100:115], v[140:143], v[132:135], v[100:115]
    s_add_u32 s25, s48, 73728
    buffer_load_dwordx4 v[132:135], v3, s[4:7], s25 offen sc1
    s_add_u32 s25, s27, 8192
    buffer_load_dwordx4 v[140:143], v3, s[4:7], s25 offen sc1
    s_waitcnt vmcnt(0)
    s_mov_b32 s36, 0
KF_CK121:
    v_max3_u32 v64, v132, v133, v134
    v_max_u32 v64, v64, v135
    v_cmp_eq_u32 s[34:35], -1, v64
    s_nop 0
    s_cmp_lg_u64 s[34:35], 0
    s_cbranch_scc1 KF_CK121_R
KF_CK121_C:
    v_mfma_f32_32x32x16_bf16 v[100:115], v[140:143], v[132:135], v[100:115]
    s_add_u32 s25, s48, 74752
    buffer_load_dwordx4 v[132:135], v3, s[4:7], s25 offen sc1
    s_add_u32 s25, s27, 9216
    buffer_load_dwordx4 v[140:143], v3, s[4:7], s25 offen sc1
    s_waitcnt vmcnt(0)
    s_mov_b32 s36, 0
KF_CK122:
    v_max3_u32 v64, v132, v133, v134
    v_max_u32 v64, v64, v135
    v_cmp_eq_u32 s[34:35], -1, v64
    s_nop 0
    s_cmp_lg_u64 s[34:35], 0
    s_cbranch_scc1 KF_CK122_R
KF_CK122_C:
    v_mfma_f32_32x32x16_bf16 v[100:115], v[140:143], v[132:135], v[100:115]
    s_add_u32 s25, s48, 75776
    buffer_load_dwordx4 v[132:135], v3, s[4:7], s25 offen sc1
    s_add_u32 s25, s27, 10240
    buffer_load_dwordx4 v[140:143], v3, s[4:7], s25 offen sc1
    s_waitcnt vmcnt(0)
    s_mov_b32 s36, 0
KF_CK123:
    v_max3_u32 v64, v132, v133, v134
    v_max_u32 v64, v64, v135
    v_cmp_eq_u32 s[34:35], -1, v64
    s_nop 0
    s_cmp_lg_u64 s[34:35], 0
    s_cbranch_scc1 KF_CK123_R
KF_CK123_C:
    v_mfma_f32_32x32x16_bf16 v[100:115], v[140:143], v[132:135], v[100:115]
    s_add_u32 s25, s48, 76800
    buffer_load_dwordx4 v[132:135], v3, s[4:7], s25 offen sc1
    s_add_u32 s25, s27, 11264
    buffer_load_dwordx4 v[140:143], v3, s[4:7], s25 offen sc1
    s_waitcnt vmcnt(0)
    s_mov_b32 s36, 0
KF_CK124:
    v_max3_u32 v64, v132, v133, v134
    v_max_u32 v64, v64, v135
    v_cmp_eq_u32 s[34:35], -1, v64
    s_nop 0
    s_cmp_lg_u64 s[34:35], 0
    s_cbranch_scc1 KF_CK124_R
KF_CK124_C:
    v_mfma_f32_32x32x16_bf16 v[100:115], v[140:143], v[132:135], v[100:115]
    s_add_u32 s25, s48, 77824
    buffer_load_dwordx4 v[132:135], v3, s[4:7], s25 offen sc1
    s_add_u32 s25, s27, 12288
    buffer_load_dwordx4 v[140:143], v3, s[4:7], s25 offen sc1
    s_waitcnt vmcnt(0)
    s_mov_b32 s36, 0
KF_CK125:
    v_max3_u32 v64, v132, v133, v134
    v_max_u32 v64, v64, v135
    v_cmp_eq_u32 s[34:35], -1, v64
    s_nop 0
    s_cmp_lg_u64 s[34:35], 0
    s_cbranch_scc1 KF_CK125_R
KF_CK125_C:
    v_mfma_f32_32x32x16_bf16 v[100:115], v[140:143], v[132:135], v[100:115]
    s_add_u32 s25, s48, 78848
    buffer_load_dwordx4 v[132:135], v3, s[4:7], s25 offen sc1
    s_add_u32 s25, s27, 13312
    buffer_load_dwordx4 v[140:143], v3, s[4:7], s25 offen sc1
    s_waitcnt vmcnt(0)
    s_mov_b32 s36, 0
KF_CK126:
    v_max3_u32 v64, v132, v133, v134
    v_max_u32 v64, v64, v135
    v_cmp_eq_u32 s[34:35], -1, v64
    s_nop 0
    s_cmp_lg_u64 s[34:35], 0
    s_cbranch_scc1 KF_CK126_R
KF_CK126_C:
    v_mfma_f32_32x32x16_bf16 v[100:115], v[140:143], v[132:135], v[100:115]
    s_add_u32 s25, s48, 79872
    buffer_load_dwordx4 v[132:135], v3, s[4:7], s25 offen sc1
    s_add_u32 s25, s27, 14336
    buffer_load_dwordx4 v[140:143], v3, s[4:7], s25 offen sc1
    s_waitcnt vmcnt(0)
    s_mov_b32 s36, 0
KF_CK127:
    v_max3_u32 v64, v132, v133, v134
    v_max_u32 v64, v64, v135
    v_cmp_eq_u32 s[34:35], -1, v64
    s_nop 0
    s_cmp_lg_u64 s[34:35], 0
    s_cbranch_scc1 KF_CK127_R
KF_CK127_C:
    v_mfma_f32_32x32x16_bf16 v[100:115], v[140:143], v[132:135], v[100:115]
    s_add_u32 s25, s48, 80896
    buffer_load_dwordx4 v[132:135], v3, s[4:7], s25 offen sc1
    s_add_u32 s25, s27, 15360
    buffer_load_dwordx4 v[140:143], v3, s[4:7], s25 offen sc1
    s_waitcnt vmcnt(0)
    s_mov_b32 s36, 0
KF_CK128:
    v_max3_u32 v64, v132, v133, v134
    v_max_u32 v64, v64, v135
    v_cmp_eq_u32 s[34:35], -1, v64
    s_nop 0
    s_cmp_lg_u64 s[34:35], 0
    s_cbranch_scc1 KF_CK128_R
KF_CK128_C:
    v_mfma_f32_32x32x16_bf16 v[100:115], v[140:143], v[132:135], v[100:115]
    s_add_u32 s25, s48, 81920
    buffer_load_dwordx4 v[132:135], v3, s[4:7], s25 offen sc1
    s_add_u32 s25, s27, 16384
    buffer_load_dwordx4 v[140:143], v3, s[4:7], s25 offen sc1
    s_waitcnt vmcnt(0)
    s_mov_b32 s36, 0
KF_CK129:
    v_max3_u32 v64, v132, v133, v134
    v_max_u32 v64, v64, v135
    v_cmp_eq_u32 s[34:35], -1, v64
    s_nop 0
    s_cmp_lg_u64 s[34:35], 0
    s_cbranch_scc1 KF_CK129_R
KF_CK129_C:
    v_mfma_f32_32x32x16_bf16 v[100:115], v[140:143], v[132:135], v[100:115]
    s_add_u32 s25, s48, 82944
    buffer_load_dwordx4 v[132:135], v3, s[4:7], s25 offen sc1
    s_add_u32 s25, s27, 17408
    buffer_load_dwordx4 v[140:143], v3, s[4:7], s25 offen sc1
    s_waitcnt vmcnt(0)
    s_mov_b32 s36, 0
KF_CK130:
    v_max3_u32 v64, v132, v133, v134
    v_max_u32 v64, v64, v135
    v_cmp_eq_u32 s[34:35], -1, v64
    s_nop 0
    s_cmp_lg_u64 s[34:35], 0
    s_cbranch_scc1 KF_CK130_R
KF_CK130_C:
    v_mfma_f32_32x32x16_bf16 v[100:115], v[140:143], v[132:135], v[100:115]
    s_add_u32 s25, s48, 83968
    buffer_load_dwordx4 v[132:135], v3, s[4:7], s25 offen sc1
    s_add_u32 s25, s27, 18432
    buffer_load_dwordx4 v[140:143], v3, s[4:7], s25 offen sc1
    s_waitcnt vmcnt(0)
    s_mov_b32 s36, 0
KF_CK131:
    v_max3_u32 v64, v132, v133, v134
    v_max_u32 v64, v64, v135
    v_cmp_eq_u32 s[34:35], -1, v64
    s_nop 0
    s_cmp_lg_u64 s[34:35], 0
    s_cbranch_scc1 KF_CK131_R
KF_CK131_C:
    v_mfma_f32_32x32x16_bf16 v[100:115], v[140:143], v[132:135], v[100:115]
    s_add_u32 s25, s48, 84992
    buffer_load_dwordx4 v[132:135], v3, s[4:7], s25 offen sc1
    s_add_u32 s25, s27, 19456
    buffer_load_dwordx4 v[140:143], v3, s[4:7], s25 offen sc1
    s_waitcnt vmcnt(0)
    s_mov_b32 s36, 0
KF_CK132:
    v_max3_u32 v64, v132, v133, v134
    v_max_u32 v64, v64, v135
    v_cmp_eq_u32 s[34:35], -1, v64
    s_nop 0
    s_cmp_lg_u64 s[34:35], 0
    s_cbranch_scc1 KF_CK132_R
KF_CK132_C:
    v_mfma_f32_32x32x16_bf16 v[100:115], v[140:143], v[132:135], v[100:115]
    s_add_u32 s25, s48, 86016
    buffer_load_dwordx4 v[132:135], v3, s[4:7], s25 offen sc1
    s_add_u32 s25, s27, 20480
    buffer_load_dwordx4 v[140:143], v3, s[4:7], s25 offen sc1
    s_waitcnt vmcnt(0)
    s_mov_b32 s36, 0
KF_CK133:
    v_max3_u32 v64, v132, v133, v134
    v_max_u32 v64, v64, v135
    v_cmp_eq_u32 s[34:35], -1, v64
    s_nop 0
    s_cmp_lg_u64 s[34:35], 0
    s_cbranch_scc1 KF_CK133_R
KF_CK133_C:
    v_mfma_f32_32x32x16_bf16 v[100:115], v[140:143], v[132:135], v[100:115]
    s_add_u32 s25, s48, 87040
    buffer_load_dwordx4 v[132:135], v3, s[4:7], s25 offen sc1
    s_add_u32 s25, s27, 21504
    buffer_load_dwordx4 v[140:143], v3, s[4:7], s25 offen sc1
    s_waitcnt vmcnt(0)
    s_mov_b32 s36, 0
KF_CK134:
    v_max3_u32 v64, v132, v133, v134
    v_max_u32 v64, v64, v135
    v_cmp_eq_u32 s[34:35], -1, v64
    s_nop 0
    s_cmp_lg_u64 s[34:35], 0
    s_cbranch_scc1 KF_CK134_R
KF_CK134_C:
    v_mfma_f32_32x32x16_bf16 v[100:115], v[140:143], v[132:135], v[100:115]
    s_add_u32 s25, s48, 88064
    buffer_load_dwordx4 v[132:135], v3, s[4:7], s25 offen sc1
    s_add_u32 s25, s27, 22528
    buffer_load_dwordx4 v[140:143], v3, s[4:7], s25 offen sc1
    s_waitcnt vmcnt(0)
    s_mov_b32 s36, 0
KF_CK135:
    v_max3_u32 v64, v132, v133, v134
    v_max_u32 v64, v64, v135
    v_cmp_eq_u32 s[34:35], -1, v64
    s_nop 0
    s_cmp_lg_u64 s[34:35], 0
    s_cbranch_scc1 KF_CK135_R
KF_CK135_C:
    v_mfma_f32_32x32x16_bf16 v[100:115], v[140:143], v[132:135], v[100:115]
    s_add_u32 s25, s48, 89088
    buffer_load_dwordx4 v[132:135], v3, s[4:7], s25 offen sc1
    s_add_u32 s25, s27, 23552
    buffer_load_dwordx4 v[140:143], v3, s[4:7], s25 offen sc1
    s_waitcnt vmcnt(0)
    s_mov_b32 s36, 0
KF_CK136:
    v_max3_u32 v64, v132, v133, v134
    v_max_u32 v64, v64, v135
    v_cmp_eq_u32 s[34:35], -1, v64
    s_nop 0
    s_cmp_lg_u64 s[34:35], 0
    s_cbranch_scc1 KF_CK136_R
KF_CK136_C:
    v_mfma_f32_32x32x16_bf16 v[100:115], v[140:143], v[132:135], v[100:115]
    s_add_u32 s25, s48, 90112
    buffer_load_dwordx4 v[132:135], v3, s[4:7], s25 offen sc1
    s_add_u32 s25, s27, 24576
    buffer_load_dwordx4 v[140:143], v3, s[4:7], s25 offen sc1
    s_waitcnt vmcnt(0)
    s_mov_b32 s36, 0
KF_CK137:
    v_max3_u32 v64, v132, v133, v134
    v_max_u32 v64, v64, v135
    v_cmp_eq_u32 s[34:35], -1, v64
    s_nop 0
    s_cmp_lg_u64 s[34:35], 0
    s_cbranch_scc1 KF_CK137_R
KF_CK137_C:
    v_mfma_f32_32x32x16_bf16 v[100:115], v[140:143], v[132:135], v[100:115]
    s_add_u32 s25, s48, 91136
    buffer_load_dwordx4 v[132:135], v3, s[4:7], s25 offen sc1
    s_add_u32 s25, s27, 25600
    buffer_load_dwordx4 v[140:143], v3, s[4:7], s25 offen sc1
    s_waitcnt vmcnt(0)
    s_mov_b32 s36, 0
KF_CK138:
    v_max3_u32 v64, v132, v133, v134
    v_max_u32 v64, v64, v135
    v_cmp_eq_u32 s[34:35], -1, v64
    s_nop 0
    s_cmp_lg_u64 s[34:35], 0
    s_cbranch_scc1 KF_CK138_R
KF_CK138_C:
    v_mfma_f32_32x32x16_bf16 v[100:115], v[140:143], v[132:135], v[100:115]
    s_add_u32 s25, s48, 92160
    buffer_load_dwordx4 v[132:135], v3, s[4:7], s25 offen sc1
    s_add_u32 s25, s27, 26624
    buffer_load_dwordx4 v[140:143], v3, s[4:7], s25 offen sc1
    s_waitcnt vmcnt(0)
    s_mov_b32 s36, 0
KF_CK139:
    v_max3_u32 v64, v132, v133, v134
    v_max_u32 v64, v64, v135
    v_cmp_eq_u32 s[34:35], -1, v64
    s_nop 0
    s_cmp_lg_u64 s[34:35], 0
    s_cbranch_scc1 KF_CK139_R
KF_CK139_C:
    v_mfma_f32_32x32x16_bf16 v[100:115], v[140:143], v[132:135], v[100:115]
    s_add_u32 s25, s48, 93184
    buffer_load_dwordx4 v[132:135], v3, s[4:7], s25 offen sc1
    s_add_u32 s25, s27, 27648
    buffer_load_dwordx4 v[140:143], v3, s[4:7], s25 offen sc1
    s_waitcnt vmcnt(0)
    s_mov_b32 s36, 0
KF_CK140:
    v_max3_u32 v64, v132, v133, v134
    v_max_u32 v64, v64, v135
    v_cmp_eq_u32 s[34:35], -1, v64
    s_nop 0
    s_cmp_lg_u64 s[34:35], 0
    s_cbranch_scc1 KF_CK140_R
KF_CK140_C:
    v_mfma_f32_32x32x16_bf16 v[100:115], v[140:143], v[132:135], v[100:115]
    s_add_u32 s25, s48, 94208
    buffer_load_dwordx4 v[132:135], v3, s[4:7], s25 offen sc1
    s_add_u32 s25, s27, 28672
    buffer_load_dwordx4 v[140:143], v3, s[4:7], s25 offen sc1
    s_waitcnt vmcnt(0)
    s_mov_b32 s36, 0
KF_CK141:
    v_max3_u32 v64, v132, v133, v134
    v_max_u32 v64, v64, v135
    v_cmp_eq_u32 s[34:35], -1, v64
    s_nop 0
    s_cmp_lg_u64 s[34:35], 0
    s_cbranch_scc1 KF_CK141_R
KF_CK141_C:
    v_mfma_f32_32x32x16_bf16 v[100:115], v[140:143], v[132:135], v[100:115]
    s_add_u32 s25, s48, 95232
    buffer_load_dwordx4 v[132:135], v3, s[4:7], s25 offen sc1
    s_add_u32 s25, s27, 29696
    buffer_load_dwordx4 v[140:143], v3, s[4:7], s25 offen sc1
    s_waitcnt vmcnt(0)
    s_mov_b32 s36, 0
KF_CK142:
    v_max3_u32 v64, v132, v133, v134
    v_max_u32 v64, v64, v135
    v_cmp_eq_u32 s[34:35], -1, v64
    s_nop 0
    s_cmp_lg_u64 s[34:35], 0
    s_cbranch_scc1 KF_CK142_R
KF_CK142_C:
    v_mfma_f32_32x32x16_bf16 v[100:115], v[140:143], v[132:135], v[100:115]
    s_add_u32 s25, s48, 96256
    buffer_load_dwordx4 v[132:135], v3, s[4:7], s25 offen sc1
    s_add_u32 s25, s27, 30720
    buffer_load_dwordx4 v[140:143], v3, s[4:7], s25 offen sc1
    s_waitcnt vmcnt(0)
    s_mov_b32 s36, 0
KF_CK143:
    v_max3_u32 v64, v132, v133, v134
    v_max_u32 v64, v64, v135
    v_cmp_eq_u32 s[34:35], -1, v64
    s_nop 0
    s_cmp_lg_u64 s[34:35], 0
    s_cbranch_scc1 KF_CK143_R
KF_CK143_C:
    v_mfma_f32_32x32x16_bf16 v[100:115], v[140:143], v[132:135], v[100:115]
    s_add_u32 s25, s48, 97280
    buffer_load_dwordx4 v[132:135], v3, s[4:7], s25 offen sc1
    s_add_u32 s25, s27, 31744
    buffer_load_dwordx4 v[140:143], v3, s[4:7], s25 offen sc1
    s_waitcnt vmcnt(0)
    s_mov_b32 s36, 0
KF_CK144:
    v_max3_u32 v64, v132, v133, v134
    v_max_u32 v64, v64, v135
    v_cmp_eq_u32 s[34:35], -1, v64
    s_nop 0
    s_cmp_lg_u64 s[34:35], 0
    s_cbranch_scc1 KF_CK144_R
KF_CK144_C:
    v_mfma_f32_32x32x16_bf16 v[100:115], v[140:143], v[132:135], v[100:115]
    s_waitcnt lgkmcnt(0)
    v_mfma_f32_32x32x16_bf16 v[100:115], v[160:163], v[136:139], v[100:115]
    s_nop 15
    s_branch KF_GS2_R
KF_GS3:
    ds_read_b128 v[136:139], v67 offset:32768
    s_add_u32 s25, s48, 98304
    buffer_load_dwordx4 v[132:135], v3, s[4:7], s25 offen sc1
    s_add_u32 s25, s27, 0
    buffer_load_dwordx4 v[140:143], v3, s[4:7], s25 offen sc1
    s_waitcnt vmcnt(0)
    s_mov_b32 s36, 0
KF_CK145:
    v_max3_u32 v64, v132, v133, v134
    v_max_u32 v64, v64, v135
    v_cmp_eq_u32 s[34:35], -1, v64
    s_nop 0
    s_cmp_lg_u64 s[34:35], 0
    s_cbranch_scc1 KF_CK145_R
KF_CK145_C:
    v_mfma_f32_32x32x16_bf16 v[116:131], v[140:143], v[132:135], 0
    s_add_u32 s25, s48, 99328
    buffer_load_dwordx4 v[132:135], v3, s[4:7], s25 offen sc1
    s_add_u32 s25, s27, 1024
    buffer_load_dwordx4 v[140:143], v3, s[4:7], s25 offen sc1
    s_waitcnt vmcnt(0)
    s_mov_b32 s36, 0
KF_CK146:
    v_max3_u32 v64, v132, v133, v134
    v_max_u32 v64, v64, v135
    v_cmp_eq_u32 s[34:35], -1, v64
    s_nop 0
    s_cmp_lg_u64 s[34:35], 0
    s_cbranch_scc1 KF_CK146_R
KF_CK146_C:
    v_mfma_f32_32x32x16_bf16 v[116:131], v[140:143], v[132:135], v[116:131]
    s_add_u32 s25, s48, 100352
    buffer_load_dwordx4 v[132:135], v3, s[4:7], s25 offen sc1
    s_add_u32 s25, s27, 2048
    buffer_load_dwordx4 v[140:143], v3, s[4:7], s25 offen sc1
    s_waitcnt vmcnt(0)
    s_mov_b32 s36, 0
KF_CK147:
    v_max3_u32 v64, v132, v133, v134
    v_max_u32 v64, v64, v135
    v_cmp_eq_u32 s[34:35], -1, v64
    s_nop 0
    s_cmp_lg_u64 s[34:35], 0
    s_cbranch_scc1 KF_CK147_R
KF_CK147_C:
    v_mfma_f32_32x32x16_bf16 v[116:131], v[140:143], v[132:135], v[116:131]
    s_add_u32 s25, s48, 101376
    buffer_load_dwordx4 v[132:135], v3, s[4:7], s25 offen sc1
    s_add_u32 s25, s27, 3072
    buffer_load_dwordx4 v[140:143], v3, s[4:7], s25 offen sc1
    s_waitcnt vmcnt(0)
    s_mov_b32 s36, 0
KF_CK148:
    v_max3_u32 v64, v132, v133, v134
    v_max_u32 v64, v64, v135
    v_cmp_eq_u32 s[34:35], -1, v64
    s_nop 0
    s_cmp_lg_u64 s[34:35], 0
    s_cbranch_scc1 KF_CK148_R
KF_CK148_C:
    v_mfma_f32_32x32x16_bf16 v[116:131], v[140:143], v[132:135], v[116:131]
    s_add_u32 s25, s48, 102400
    buffer_load_dwordx4 v[132:135], v3, s[4:7], s25 offen sc1
    s_add_u32 s25, s27, 4096
    buffer_load_dwordx4 v[140:143], v3, s[4:7], s25 offen sc1
    s_waitcnt vmcnt(0)
    s_mov_b32 s36, 0
KF_CK149:
    v_max3_u32 v64, v132, v133, v134
    v_max_u32 v64, v64, v135
    v_cmp_eq_u32 s[34:35], -1, v64
    s_nop 0
    s_cmp_lg_u64 s[34:35], 0
    s_cbranch_scc1 KF_CK149_R
KF_CK149_C:
    v_mfma_f32_32x32x16_bf16 v[116:131], v[140:143], v[132:135], v[116:131]
    s_add_u32 s25, s48, 103424
    buffer_load_dwordx4 v[132:135], v3, s[4:7], s25 offen sc1
    s_add_u32 s25, s27, 5120
    buffer_load_dwordx4 v[140:143], v3, s[4:7], s25 offen sc1
    s_waitcnt vmcnt(0)
    s_mov_b32 s36, 0
KF_CK150:
    v_max3_u32 v64, v132, v133, v134
    v_max_u32 v64, v64, v135
    v_cmp_eq_u32 s[34:35], -1, v64
    s_nop 0
    s_cmp_lg_u64 s[34:35], 0
    s_cbranch_scc1 KF_CK150_R
KF_CK150_C:
    v_mfma_f32_32x32x16_bf16 v[116:131], v[140:143], v[132:135], v[116:131]
    s_add_u32 s25, s48, 104448
    buffer_load_dwordx4 v[132:135], v3, s[4:7], s25 offen sc1
    s_add_u32 s25, s27, 6144
    buffer_load_dwordx4 v[140:143], v3, s[4:7], s25 offen sc1
    s_waitcnt vmcnt(0)
    s_mov_b32 s36, 0
KF_CK151:
    v_max3_u32 v64, v132, v133, v134
    v_max_u32 v64, v64, v135
    v_cmp_eq_u32 s[34:35], -1, v64
    s_nop 0
    s_cmp_lg_u64 s[34:35], 0
    s_cbranch_scc1 KF_CK151_R
KF_CK151_C:
    v_mfma_f32_32x32x16_bf16 v[116:131], v[140:143], v[132:135], v[116:131]
    s_add_u32 s25, s48, 105472
    buffer_load_dwordx4 v[132:135], v3, s[4:7], s25 offen sc1
    s_add_u32 s25, s27, 7168
    buffer_load_dwordx4 v[140:143], v3, s[4:7], s25 offen sc1
    s_waitcnt vmcnt(0)
    s_mov_b32 s36, 0
KF_CK152:
    v_max3_u32 v64, v132, v133, v134
    v_max_u32 v64, v64, v135
    v_cmp_eq_u32 s[34:35], -1, v64
    s_nop 0
    s_cmp_lg_u64 s[34:35], 0
    s_cbranch_scc1 KF_CK152_R
KF_CK152_C:
    v_mfma_f32_32x32x16_bf16 v[116:131], v[140:143], v[132:135], v[116:131]
    s_add_u32 s25, s48, 106496
    buffer_load_dwordx4 v[132:135], v3, s[4:7], s25 offen sc1
    s_add_u32 s25, s27, 8192
    buffer_load_dwordx4 v[140:143], v3, s[4:7], s25 offen sc1
    s_waitcnt vmcnt(0)
    s_mov_b32 s36, 0
KF_CK153:
    v_max3_u32 v64, v132, v133, v134
    v_max_u32 v64, v64, v135
    v_cmp_eq_u32 s[34:35], -1, v64
    s_nop 0
    s_cmp_lg_u64 s[34:35], 0
    s_cbranch_scc1 KF_CK153_R
KF_CK153_C:
    v_mfma_f32_32x32x16_bf16 v[116:131], v[140:143], v[132:135], v[116:131]
    s_add_u32 s25, s48, 107520
    buffer_load_dwordx4 v[132:135], v3, s[4:7], s25 offen sc1
    s_add_u32 s25, s27, 9216
    buffer_load_dwordx4 v[140:143], v3, s[4:7], s25 offen sc1
    s_waitcnt vmcnt(0)
    s_mov_b32 s36, 0
KF_CK154:
    v_max3_u32 v64, v132, v133, v134
    v_max_u32 v64, v64, v135
    v_cmp_eq_u32 s[34:35], -1, v64
    s_nop 0
    s_cmp_lg_u64 s[34:35], 0
    s_cbranch_scc1 KF_CK154_R
KF_CK154_C:
    v_mfma_f32_32x32x16_bf16 v[116:131], v[140:143], v[132:135], v[116:131]
    s_add_u32 s25, s48, 108544
    buffer_load_dwordx4 v[132:135], v3, s[4:7], s25 offen sc1
    s_add_u32 s25, s27, 10240
    buffer_load_dwordx4 v[140:143], v3, s[4:7], s25 offen sc1
    s_waitcnt vmcnt(0)
    s_mov_b32 s36, 0
KF_CK155:
    v_max3_u32 v64, v132, v133, v134
    v_max_u32 v64, v64, v135
    v_cmp_eq_u32 s[34:35], -1, v64
    s_nop 0
    s_cmp_lg_u64 s[34:35], 0
    s_cbranch_scc1 KF_CK155_R
KF_CK155_C:
    v_mfma_f32_32x32x16_bf16 v[116:131], v[140:143], v[132:135], v[116:131]
    s_add_u32 s25, s48, 109568
    buffer_load_dwordx4 v[132:135], v3, s[4:7], s25 offen sc1
    s_add_u32 s25, s27, 11264
    buffer_load_dwordx4 v[140:143], v3, s[4:7], s25 offen sc1
    s_waitcnt vmcnt(0)
    s_mov_b32 s36, 0
KF_CK156:
    v_max3_u32 v64, v132, v133, v134
    v_max_u32 v64, v64, v135
    v_cmp_eq_u32 s[34:35], -1, v64
    s_nop 0
    s_cmp_lg_u64 s[34:35], 0
    s_cbranch_scc1 KF_CK156_R
KF_CK156_C:
    v_mfma_f32_32x32x16_bf16 v[116:131], v[140:143], v[132:135], v[116:131]
    s_add_u32 s25, s48, 110592
    buffer_load_dwordx4 v[132:135], v3, s[4:7], s25 offen sc1
    s_add_u32 s25, s27, 12288
    buffer_load_dwordx4 v[140:143], v3, s[4:7], s25 offen sc1
    s_waitcnt vmcnt(0)
    s_mov_b32 s36, 0
KF_CK157:
    v_max3_u32 v64, v132, v133, v134
    v_max_u32 v64, v64, v135
    v_cmp_eq_u32 s[34:35], -1, v64
    s_nop 0
    s_cmp_lg_u64 s[34:35], 0
    s_cbranch_scc1 KF_CK157_R
KF_CK157_C:
    v_mfma_f32_32x32x16_bf16 v[116:131], v[140:143], v[132:135], v[116:131]
    s_add_u32 s25, s48, 111616
    buffer_load_dwordx4 v[132:135], v3, s[4:7], s25 offen sc1
    s_add_u32 s25, s27, 13312
    buffer_load_dwordx4 v[140:143], v3, s[4:7], s25 offen sc1
    s_waitcnt vmcnt(0)
    s_mov_b32 s36, 0
KF_CK158:
    v_max3_u32 v64, v132, v133, v134
    v_max_u32 v64, v64, v135
    v_cmp_eq_u32 s[34:35], -1, v64
    s_nop 0
    s_cmp_lg_u64 s[34:35], 0
    s_cbranch_scc1 KF_CK158_R
KF_CK158_C:
    v_mfma_f32_32x32x16_bf16 v[116:131], v[140:143], v[132:135], v[116:131]
    s_add_u32 s25, s48, 112640
    buffer_load_dwordx4 v[132:135], v3, s[4:7], s25 offen sc1
    s_add_u32 s25, s27, 14336
    buffer_load_dwordx4 v[140:143], v3, s[4:7], s25 offen sc1
    s_waitcnt vmcnt(0)
    s_mov_b32 s36, 0
KF_CK159:
    v_max3_u32 v64, v132, v133, v134
    v_max_u32 v64, v64, v135
    v_cmp_eq_u32 s[34:35], -1, v64
    s_nop 0
    s_cmp_lg_u64 s[34:35], 0
    s_cbranch_scc1 KF_CK159_R
KF_CK159_C:
    v_mfma_f32_32x32x16_bf16 v[116:131], v[140:143], v[132:135], v[116:131]
    s_add_u32 s25, s48, 113664
    buffer_load_dwordx4 v[132:135], v3, s[4:7], s25 offen sc1
    s_add_u32 s25, s27, 15360
    buffer_load_dwordx4 v[140:143], v3, s[4:7], s25 offen sc1
    s_waitcnt vmcnt(0)
    s_mov_b32 s36, 0
KF_CK160:
    v_max3_u32 v64, v132, v133, v134
    v_max_u32 v64, v64, v135
    v_cmp_eq_u32 s[34:35], -1, v64
    s_nop 0
    s_cmp_lg_u64 s[34:35], 0
    s_cbranch_scc1 KF_CK160_R
KF_CK160_C:
    v_mfma_f32_32x32x16_bf16 v[116:131], v[140:143], v[132:135], v[116:131]
    s_add_u32 s25, s48, 114688
    buffer_load_dwordx4 v[132:135], v3, s[4:7], s25 offen sc1
    s_add_u32 s25, s27, 16384
    buffer_load_dwordx4 v[140:143], v3, s[4:7], s25 offen sc1
    s_waitcnt vmcnt(0)
    s_mov_b32 s36, 0
KF_CK161:
    v_max3_u32 v64, v132, v133, v134
    v_max_u32 v64, v64, v135
    v_cmp_eq_u32 s[34:35], -1, v64
    s_nop 0
    s_cmp_lg_u64 s[34:35], 0
    s_cbranch_scc1 KF_CK161_R
KF_CK161_C:
    v_mfma_f32_32x32x16_bf16 v[116:131], v[140:143], v[132:135], v[116:131]
    s_add_u32 s25, s48, 115712
    buffer_load_dwordx4 v[132:135], v3, s[4:7], s25 offen sc1
    s_add_u32 s25, s27, 17408
    buffer_load_dwordx4 v[140:143], v3, s[4:7], s25 offen sc1
    s_waitcnt vmcnt(0)
    s_mov_b32 s36, 0
KF_CK162:
    v_max3_u32 v64, v132, v133, v134
    v_max_u32 v64, v64, v135
    v_cmp_eq_u32 s[34:35], -1, v64
    s_nop 0
    s_cmp_lg_u64 s[34:35], 0
    s_cbranch_scc1 KF_CK162_R
KF_CK162_C:
    v_mfma_f32_32x32x16_bf16 v[116:131], v[140:143], v[132:135], v[116:131]
    s_add_u32 s25, s48, 116736
    buffer_load_dwordx4 v[132:135], v3, s[4:7], s25 offen sc1
    s_add_u32 s25, s27, 18432
    buffer_load_dwordx4 v[140:143], v3, s[4:7], s25 offen sc1
    s_waitcnt vmcnt(0)
    s_mov_b32 s36, 0
KF_CK163:
    v_max3_u32 v64, v132, v133, v134
    v_max_u32 v64, v64, v135
    v_cmp_eq_u32 s[34:35], -1, v64
    s_nop 0
    s_cmp_lg_u64 s[34:35], 0
    s_cbranch_scc1 KF_CK163_R
KF_CK163_C:
    v_mfma_f32_32x32x16_bf16 v[116:131], v[140:143], v[132:135], v[116:131]
    s_add_u32 s25, s48, 117760
    buffer_load_dwordx4 v[132:135], v3, s[4:7], s25 offen sc1
    s_add_u32 s25, s27, 19456
    buffer_load_dwordx4 v[140:143], v3, s[4:7], s25 offen sc1
    s_waitcnt vmcnt(0)
    s_mov_b32 s36, 0
KF_CK164:
    v_max3_u32 v64, v132, v133, v134
    v_max_u32 v64, v64, v135
    v_cmp_eq_u32 s[34:35], -1, v64
    s_nop 0
    s_cmp_lg_u64 s[34:35], 0
    s_cbranch_scc1 KF_CK164_R
KF_CK164_C:
    v_mfma_f32_32x32x16_bf16 v[116:131], v[140:143], v[132:135], v[116:131]
    s_add_u32 s25, s48, 118784
    buffer_load_dwordx4 v[132:135], v3, s[4:7], s25 offen sc1
    s_add_u32 s25, s27, 20480
    buffer_load_dwordx4 v[140:143], v3, s[4:7], s25 offen sc1
    s_waitcnt vmcnt(0)
    s_mov_b32 s36, 0
KF_CK165:
    v_max3_u32 v64, v132, v133, v134
    v_max_u32 v64, v64, v135
    v_cmp_eq_u32 s[34:35], -1, v64
    s_nop 0
    s_cmp_lg_u64 s[34:35], 0
    s_cbranch_scc1 KF_CK165_R
KF_CK165_C:
    v_mfma_f32_32x32x16_bf16 v[116:131], v[140:143], v[132:135], v[116:131]
    s_add_u32 s25, s48, 119808
    buffer_load_dwordx4 v[132:135], v3, s[4:7], s25 offen sc1
    s_add_u32 s25, s27, 21504
    buffer_load_dwordx4 v[140:143], v3, s[4:7], s25 offen sc1
    s_waitcnt vmcnt(0)
    s_mov_b32 s36, 0
KF_CK166:
    v_max3_u32 v64, v132, v133, v134
    v_max_u32 v64, v64, v135
    v_cmp_eq_u32 s[34:35], -1, v64
    s_nop 0
    s_cmp_lg_u64 s[34:35], 0
    s_cbranch_scc1 KF_CK166_R
KF_CK166_C:
    v_mfma_f32_32x32x16_bf16 v[116:131], v[140:143], v[132:135], v[116:131]
    s_add_u32 s25, s48, 120832
    buffer_load_dwordx4 v[132:135], v3, s[4:7], s25 offen sc1
    s_add_u32 s25, s27, 22528
    buffer_load_dwordx4 v[140:143], v3, s[4:7], s25 offen sc1
    s_waitcnt vmcnt(0)
    s_mov_b32 s36, 0
KF_CK167:
    v_max3_u32 v64, v132, v133, v134
    v_max_u32 v64, v64, v135
    v_cmp_eq_u32 s[34:35], -1, v64
    s_nop 0
    s_cmp_lg_u64 s[34:35], 0
    s_cbranch_scc1 KF_CK167_R
KF_CK167_C:
    v_mfma_f32_32x32x16_bf16 v[116:131], v[140:143], v[132:135], v[116:131]
    s_add_u32 s25, s48, 121856
    buffer_load_dwordx4 v[132:135], v3, s[4:7], s25 offen sc1
    s_add_u32 s25, s27, 23552
    buffer_load_dwordx4 v[140:143], v3, s[4:7], s25 offen sc1
    s_waitcnt vmcnt(0)
    s_mov_b32 s36, 0
KF_CK168:
    v_max3_u32 v64, v132, v133, v134
    v_max_u32 v64, v64, v135
    v_cmp_eq_u32 s[34:35], -1, v64
    s_nop 0
    s_cmp_lg_u64 s[34:35], 0
    s_cbranch_scc1 KF_CK168_R
KF_CK168_C:
    v_mfma_f32_32x32x16_bf16 v[116:131], v[140:143], v[132:135], v[116:131]
    s_add_u32 s25, s48, 122880
    buffer_load_dwordx4 v[132:135], v3, s[4:7], s25 offen sc1
    s_add_u32 s25, s27, 24576
    buffer_load_dwordx4 v[140:143], v3, s[4:7], s25 offen sc1
    s_waitcnt vmcnt(0)
    s_mov_b32 s36, 0
KF_CK169:
    v_max3_u32 v64, v132, v133, v134
    v_max_u32 v64, v64, v135
    v_cmp_eq_u32 s[34:35], -1, v64
    s_nop 0
    s_cmp_lg_u64 s[34:35], 0
    s_cbranch_scc1 KF_CK169_R
KF_CK169_C:
    v_mfma_f32_32x32x16_bf16 v[116:131], v[140:143], v[132:135], v[116:131]
    s_add_u32 s25, s48, 123904
    buffer_load_dwordx4 v[132:135], v3, s[4:7], s25 offen sc1
    s_add_u32 s25, s27, 25600
    buffer_load_dwordx4 v[140:143], v3, s[4:7], s25 offen sc1
    s_waitcnt vmcnt(0)
    s_mov_b32 s36, 0
KF_CK170:
    v_max3_u32 v64, v132, v133, v134
    v_max_u32 v64, v64, v135
    v_cmp_eq_u32 s[34:35], -1, v64
    s_nop 0
    s_cmp_lg_u64 s[34:35], 0
    s_cbranch_scc1 KF_CK170_R
KF_CK170_C:
    v_mfma_f32_32x32x16_bf16 v[116:131], v[140:143], v[132:135], v[116:131]
    s_add_u32 s25, s48, 124928
    buffer_load_dwordx4 v[132:135], v3, s[4:7], s25 offen sc1
    s_add_u32 s25, s27, 26624
    buffer_load_dwordx4 v[140:143], v3, s[4:7], s25 offen sc1
    s_waitcnt vmcnt(0)
    s_mov_b32 s36, 0
KF_CK171:
    v_max3_u32 v64, v132, v133, v134
    v_max_u32 v64, v64, v135
    v_cmp_eq_u32 s[34:35], -1, v64
    s_nop 0
    s_cmp_lg_u64 s[34:35], 0
    s_cbranch_scc1 KF_CK171_R
KF_CK171_C:
    v_mfma_f32_32x32x16_bf16 v[116:131], v[140:143], v[132:135], v[116:131]
    s_add_u32 s25, s48, 125952
    buffer_load_dwordx4 v[132:135], v3, s[4:7], s25 offen sc1
    s_add_u32 s25, s27, 27648
    buffer_load_dwordx4 v[140:143], v3, s[4:7], s25 offen sc1
    s_waitcnt vmcnt(0)
    s_mov_b32 s36, 0
KF_CK172:
    v_max3_u32 v64, v132, v133, v134
    v_max_u32 v64, v64, v135
    v_cmp_eq_u32 s[34:35], -1, v64
    s_nop 0
    s_cmp_lg_u64 s[34:35], 0
    s_cbranch_scc1 KF_CK172_R
KF_CK172_C:
    v_mfma_f32_32x32x16_bf16 v[116:131], v[140:143], v[132:135], v[116:131]
    s_add_u32 s25, s48, 126976
    buffer_load_dwordx4 v[132:135], v3, s[4:7], s25 offen sc1
    s_add_u32 s25, s27, 28672
    buffer_load_dwordx4 v[140:143], v3, s[4:7], s25 offen sc1
    s_waitcnt vmcnt(0)
    s_mov_b32 s36, 0
KF_CK173:
    v_max3_u32 v64, v132, v133, v134
    v_max_u32 v64, v64, v135
    v_cmp_eq_u32 s[34:35], -1, v64
    s_nop 0
    s_cmp_lg_u64 s[34:35], 0
    s_cbranch_scc1 KF_CK173_R
KF_CK173_C:
    v_mfma_f32_32x32x16_bf16 v[116:131], v[140:143], v[132:135], v[116:131]
    s_add_u32 s25, s48, 128000
    buffer_load_dwordx4 v[132:135], v3, s[4:7], s25 offen sc1
    s_add_u32 s25, s27, 29696
    buffer_load_dwordx4 v[140:143], v3, s[4:7], s25 offen sc1
    s_waitcnt vmcnt(0)
    s_mov_b32 s36, 0
KF_CK174:
    v_max3_u32 v64, v132, v133, v134
    v_max_u32 v64, v64, v135
    v_cmp_eq_u32 s[34:35], -1, v64
    s_nop 0
    s_cmp_lg_u64 s[34:35], 0
    s_cbranch_scc1 KF_CK174_R
KF_CK174_C:
    v_mfma_f32_32x32x16_bf16 v[116:131], v[140:143], v[132:135], v[116:131]
    s_add_u32 s25, s48, 129024
    buffer_load_dwordx4 v[132:135], v3, s[4:7], s25 offen sc1
    s_add_u32 s25, s27, 30720
    buffer_load_dwordx4 v[140:143], v3, s[4:7], s25 offen sc1
    s_waitcnt vmcnt(0)
    s_mov_b32 s36, 0
KF_CK175:
    v_max3_u32 v64, v132, v133, v134
    v_max_u32 v64, v64, v135
    v_cmp_eq_u32 s[34:35], -1, v64
    s_nop 0
    s_cmp_lg_u64 s[34:35], 0
    s_cbranch_scc1 KF_CK175_R
KF_CK175_C:
    v_mfma_f32_32x32x16_bf16 v[116:131], v[140:143], v[132:135], v[116:131]
    s_add_u32 s25, s48, 130048
    buffer_load_dwordx4 v[132:135], v3, s[4:7], s25 offen sc1
    s_add_u32 s25, s27, 31744
    buffer_load_dwordx4 v[140:143], v3, s[4:7], s25 offen sc1
    s_waitcnt vmcnt(0)
    s_mov_b32 s36, 0
KF_CK176:
    v_max3_u32 v64, v132, v133, v134
    v_max_u32 v64, v64, v135
    v_cmp_eq_u32 s[34:35], -1, v64
    s_nop 0
    s_cmp_lg_u64 s[34:35], 0
    s_cbranch_scc1 KF_CK176_R
KF_CK176_C:
    v_mfma_f32_32x32x16_bf16 v[116:131], v[140:143], v[132:135], v[116:131]
    s_waitcnt lgkmcnt(0)
    v_mfma_f32_32x32x16_bf16 v[116:131], v[160:163], v[136:139], v[116:131]
    s_nop 15
    s_branch KF_GS3_R
KF_DS0:
    s_nop 4
    s_waitcnt vmcnt(0)
    s_mov_b32 s36, 0
KF_CK195:
    v_max3_u32 v64, v200, v201, v202
    v_max_u32 v64, v64, v203
    v_cmp_eq_u32 s[34:35], -1, v64
    s_nop 0
    s_cmp_lg_u64 s[34:35], 0
    s_cbranch_scc1 KF_CK195_R
KF_CK195_C:
    v_mfma_f32_32x32x16_bf16 v[100:115], v[20:23], v[200:203], 0
    v_mfma_f32_32x32x16_bf16 v[116:131], v[68:71], v[200:203], 0
    s_waitcnt vmcnt(0)
    s_mov_b32 s36, 0
KF_CK196:
    v_max3_u32 v64, v204, v205, v206
    v_max_u32 v64, v64, v207
    v_cmp_eq_u32 s[34:35], -1, v64
    s_nop 0
    s_cmp_lg_u64 s[34:35], 0
    s_cbranch_scc1 KF_CK196_R
KF_CK196_C:
    v_mfma_f32_32x32x16_bf16 v[100:115], v[24:27], v[204:207], v[100:115]
    v_mfma_f32_32x32x16_bf16 v[116:131], v[72:75], v[204:207], v[116:131]
    s_waitcnt vmcnt(0)
    s_mov_b32 s36, 0
KF_CK197:
    v_max3_u32 v64, v208, v209, v210
    v_max_u32 v64, v64, v211
    v_cmp_eq_u32 s[34:35], -1, v64
    s_nop 0
    s_cmp_lg_u64 s[34:35], 0
    s_cbranch_scc1 KF_CK197_R
KF_CK197_C:
    v_mfma_f32_32x32x16_bf16 v[100:115], v[28:31], v[208:211], v[100:115]
    v_mfma_f32_32x32x16_bf16 v[116:131], v[76:79], v[208:211], v[116:131]
    s_waitcnt vmcnt(0)
    s_mov_b32 s36, 0
KF_CK198:
    v_max3_u32 v64, v212, v213, v214
    v_max_u32 v64, v64, v215
    v_cmp_eq_u32 s[34:35], -1, v64
    s_nop 0
    s_cmp_lg_u64 s[34:35], 0
    s_cbranch_scc1 KF_CK198_R
KF_CK198_C:
    v_mfma_f32_32x32x16_bf16 v[100:115], v[32:35], v[212:215], v[100:115]
    v_mfma_f32_32x32x16_bf16 v[116:131], v[80:83], v[212:215], v[116:131]
    s_waitcnt vmcnt(0)
    s_mov_b32 s36, 0
KF_CK199:
    v_max3_u32 v64, v216, v217, v218
    v_max_u32 v64, v64, v219
    v_cmp_eq_u32 s[34:35], -1, v64
    s_nop 0
    s_cmp_lg_u64 s[34:35], 0
    s_cbranch_scc1 KF_CK199_R
KF_CK199_C:
    v_mfma_f32_32x32x16_bf16 v[100:115], v[36:39], v[216:219], v[100:115]
    v_mfma_f32_32x32x16_bf16 v[116:131], v[84:87], v[216:219], v[116:131]
    s_waitcnt vmcnt(0)
    s_mov_b32 s36, 0
KF_CK200:
    v_max3_u32 v64, v220, v221, v222
    v_max_u32 v64, v64, v223
    v_cmp_eq_u32 s[34:35], -1, v64
    s_nop 0
    s_cmp_lg_u64 s[34:35], 0
    s_cbranch_scc1 KF_CK200_R
KF_CK200_C:
    v_mfma_f32_32x32x16_bf16 v[100:115], v[40:43], v[220:223], v[100:115]
    v_mfma_f32_32x32x16_bf16 v[116:131], v[88:91], v[220:223], v[116:131]
    s_waitcnt vmcnt(0)
    s_mov_b32 s36, 0
KF_CK201:
    v_max3_u32 v64, v224, v225, v226
    v_max_u32 v64, v64, v227
    v_cmp_eq_u32 s[34:35], -1, v64
    s_nop 0
    s_cmp_lg_u64 s[34:35], 0
    s_cbranch_scc1 KF_CK201_R
KF_CK201_C:
    v_mfma_f32_32x32x16_bf16 v[100:115], v[44:47], v[224:227], v[100:115]
    v_mfma_f32_32x32x16_bf16 v[116:131], v[92:95], v[224:227], v[116:131]
    s_waitcnt vmcnt(0)
    s_mov_b32 s36, 0
KF_CK202:
    v_max3_u32 v64, v228, v229, v230
    v_max_u32 v64, v64, v231
    v_cmp_eq_u32 s[34:35], -1, v64
    s_nop 0
    s_cmp_lg_u64 s[34:35], 0
    s_cbranch_scc1 KF_CK202_R
KF_CK202_C:
    v_mfma_f32_32x32x16_bf16 v[100:115], v[48:51], v[228:231], v[100:115]
    v_mfma_f32_32x32x16_bf16 v[116:131], v[96:99], v[228:231], v[116:131]
    s_waitcnt vmcnt(0)
    s_mov_b32 s36, 0
KF_CK203:
    v_max3_u32 v64, v232, v233, v234
    v_max_u32 v64, v64, v235
    v_cmp_eq_u32 s[34:35], -1, v64
    s_nop 0
    s_cmp_lg_u64 s[34:35], 0
    s_cbranch_scc1 KF_CK203_R
KF_CK203_C:
    v_mfma_f32_32x32x16_bf16 v[100:115], v[52:55], v[232:235], v[100:115]
    v_mfma_f32_32x32x16_bf16 v[116:131], v[176:179], v[232:235], v[116:131]
    s_waitcnt vmcnt(0)
    s_mov_b32 s36, 0
KF_CK204:
    v_max3_u32 v64, v236, v237, v238
    v_max_u32 v64, v64, v239
    v_cmp_eq_u32 s[34:35], -1, v64
    s_nop 0
    s_cmp_lg_u64 s[34:35], 0
    s_cbranch_scc1 KF_CK204_R
KF_CK204_C:
    v_mfma_f32_32x32x16_bf16 v[100:115], v[56:59], v[236:239], v[100:115]
    v_mfma_f32_32x32x16_bf16 v[116:131], v[180:183], v[236:239], v[116:131]
    s_waitcnt vmcnt(0)
    s_mov_b32 s36, 0
KF_CK205:
    v_max3_u32 v64, v240, v241, v242
    v_max_u32 v64, v64, v243
    v_cmp_eq_u32 s[34:35], -1, v64
    s_nop 0
    s_cmp_lg_u64 s[34:35], 0
    s_cbranch_scc1 KF_CK205_R
KF_CK205_C:
    v_mfma_f32_32x32x16_bf16 v[100:115], v[60:63], v[240:243], v[100:115]
    v_mfma_f32_32x32x16_bf16 v[116:131], v[184:187], v[240:243], v[116:131]
    s_waitcnt vmcnt(0)
    s_mov_b32 s36, 0
KF_CK206:
    v_max3_u32 v64, v244, v245, v246
    v_max_u32 v64, v64, v247
    v_cmp_eq_u32 s[34:35], -1, v64
    s_nop 0
    s_cmp_lg_u64 s[34:35], 0
    s_cbranch_scc1 KF_CK206_R
KF_CK206_C:
    v_mfma_f32_32x32x16_bf16 v[100:115], v[164:167], v[244:247], v[100:115]
    v_mfma_f32_32x32x16_bf16 v[116:131], v[188:191], v[244:247], v[116:131]
    s_waitcnt vmcnt(0)
    s_mov_b32 s36, 0
KF_CK207:
    v_max3_u32 v64, v248, v249, v250
    v_max_u32 v64, v64, v251
    v_cmp_eq_u32 s[34:35], -1, v64
    s_nop 0
    s_cmp_lg_u64 s[34:35], 0
    s_cbranch_scc1 KF_CK207_R
KF_CK207_C:
    v_mfma_f32_32x32x16_bf16 v[100:115], v[168:171], v[248:251], v[100:115]
    v_mfma_f32_32x32x16_bf16 v[116:131], v[192:195], v[248:251], v[116:131]
    s_waitcnt vmcnt(0)
    s_mov_b32 s36, 0
KF_CK208:
    v_max3_u32 v64, v252, v253, v254
    v_max_u32 v64, v64, v255
    v_cmp_eq_u32 s[34:35], -1, v64
    s_nop 0
    s_cmp_lg_u64 s[34:35], 0
    s_cbranch_scc1 KF_CK208_R
KF_CK208_C:
    v_mfma_f32_32x32x16_bf16 v[100:115], v[172:175], v[252:255], v[100:115]
    v_mfma_f32_32x32x16_bf16 v[116:131], v[196:199], v[252:255], v[116:131]
    s_nop 15
    s_branch KF_DS0_R
KF_DS1:
    s_nop 4
    s_waitcnt vmcnt(0)
    s_mov_b32 s36, 0
KF_CK209:
    v_max3_u32 v64, v132, v133, v134
    v_max_u32 v64, v64, v135
    v_cmp_eq_u32 s[34:35], -1, v64
    s_nop 0
    s_cmp_lg_u64 s[34:35], 0
    s_cbranch_scc1 KF_CK209_R
KF_CK209_C:
    v_mfma_f32_32x32x16_bf16 v[200:215], v[20:23], v[132:135], 0
    v_mfma_f32_32x32x16_bf16 v[216:231], v[68:71], v[132:135], 0
    s_waitcnt vmcnt(0)
    s_mov_b32 s36, 0
KF_CK210:
    v_max3_u32 v64, v136, v137, v138
    v_max_u32 v64, v64, v139
    v_cmp_eq_u32 s[34:35], -1, v64
    s_nop 0
    s_cmp_lg_u64 s[34:35], 0
    s_cbranch_scc1 KF_CK210_R
KF_CK210_C:
    v_mfma_f32_32x32x16_bf16 v[200:215], v[24:27], v[136:139], v[200:215]
    v_mfma_f32_32x32x16_bf16 v[216:231], v[72:75], v[136:139], v[216:231]
    s_waitcnt vmcnt(0)
    s_mov_b32 s36, 0
KF_CK211:
    v_max3_u32 v64, v140, v141, v142
    v_max_u32 v64, v64, v143
    v_cmp_eq_u32 s[34:35], -1, v64
    s_nop 0
    s_cmp_lg_u64 s[34:35], 0
    s_cbranch_scc1 KF_CK211_R
KF_CK211_C:
    v_mfma_f32_32x32x16_bf16 v[200:215], v[28:31], v[140:143], v[200:215]
    v_mfma_f32_32x32x16_bf16 v[216:231], v[76:79], v[140:143], v[216:231]
    s_waitcnt vmcnt(0)
    s_mov_b32 s36, 0
KF_CK212:
    v_max3_u32 v64, v144, v145, v146
    v_max_u32 v64, v64, v147
    v_cmp_eq_u32 s[34:35], -1, v64
    s_nop 0
    s_cmp_lg_u64 s[34:35], 0
    s_cbranch_scc1 KF_CK212_R
KF_CK212_C:
    v_mfma_f32_32x32x16_bf16 v[200:215], v[32:35], v[144:147], v[200:215]
    v_mfma_f32_32x32x16_bf16 v[216:231], v[80:83], v[144:147], v[216:231]
    s_waitcnt vmcnt(0)
    s_mov_b32 s36, 0
KF_CK213:
    v_max3_u32 v64, v148, v149, v150
    v_max_u32 v64, v64, v151
    v_cmp_eq_u32 s[34:35], -1, v64
    s_nop 0
    s_cmp_lg_u64 s[34:35], 0
    s_cbranch_scc1 KF_CK213_R
KF_CK213_C:
    v_mfma_f32_32x32x16_bf16 v[200:215], v[48:51], v[148:151], v[200:215]
    v_mfma_f32_32x32x16_bf16 v[216:231], v[96:99], v[148:151], v[216:231]
    s_waitcnt vmcnt(0)
    s_mov_b32 s36, 0
KF_CK214:
    v_max3_u32 v64, v152, v153, v154
    v_max_u32 v64, v64, v155
    v_cmp_eq_u32 s[34:35], -1, v64
    s_nop 0
    s_cmp_lg_u64 s[34:35], 0
    s_cbranch_scc1 KF_CK214_R
KF_CK214_C:
    v_mfma_f32_32x32x16_bf16 v[200:215], v[52:55], v[152:155], v[200:215]
    v_mfma_f32_32x32x16_bf16 v[216:231], v[176:179], v[152:155], v[216:231]
    s_waitcnt vmcnt(0)
    s_mov_b32 s36, 0
KF_CK215:
    v_max3_u32 v64, v156, v157, v158
    v_max_u32 v64, v64, v159
    v_cmp_eq_u32 s[34:35], -1, v64
    s_nop 0
    s_cmp_lg_u64 s[34:35], 0
    s_cbranch_scc1 KF_CK215_R
KF_CK215_C:
    v_mfma_f32_32x32x16_bf16 v[200:215], v[56:59], v[156:159], v[200:215]
    v_mfma_f32_32x32x16_bf16 v[216:231], v[180:183], v[156:159], v[216:231]
    s_waitcnt vmcnt(0)
    s_mov_b32 s36, 0
KF_CK216:
    v_max3_u32 v64, v160, v161, v162
    v_max_u32 v64, v64, v163
    v_cmp_eq_u32 s[34:35], -1, v64
    s_nop 0
    s_cmp_lg_u64 s[34:35], 0
    s_cbranch_scc1 KF_CK216_R
KF_CK216_C:
    v_mfma_f32_32x32x16_bf16 v[200:215], v[60:63], v[160:163], v[200:215]
    v_mfma_f32_32x32x16_bf16 v[216:231], v[184:187], v[160:163], v[216:231]
    s_waitcnt vmcnt(0)
    s_mov_b32 s36, 0
KF_CK217:
    v_max3_u32 v64, v232, v233, v234
    v_max_u32 v64, v64, v235
    v_cmp_eq_u32 s[34:35], -1, v64
    s_nop 0
    s_cmp_lg_u64 s[34:35], 0
    s_cbranch_scc1 KF_CK217_R
KF_CK217_C:
    v_mfma_f32_32x32x16_bf16 v[200:215], v[36:39], v[232:235], v[200:215]
    v_mfma_f32_32x32x16_bf16 v[216:231], v[84:87], v[232:235], v[216:231]
    s_waitcnt vmcnt(0)
    s_mov_b32 s36, 0
KF_CK218:
    v_max3_u32 v64, v236, v237, v238
    v_max_u32 v64, v64, v239
    v_cmp_eq_u32 s[34:35], -1, v64
    s_nop 0
    s_cmp_lg_u64 s[34:35], 0
    s_cbranch_scc1 KF_CK218_R
KF_CK218_C:
    v_mfma_f32_32x32x16_bf16 v[200:215], v[40:43], v[236:239], v[200:215]
    v_mfma_f32_32x32x16_bf16 v[216:231], v[88:91], v[236:239], v[216:231]
    s_waitcnt vmcnt(0)
    s_mov_b32 s36, 0
KF_CK219:
    v_max3_u32 v64, v240, v241, v242
    v_max_u32 v64, v64, v243
    v_cmp_eq_u32 s[34:35], -1, v64
    s_nop 0
    s_cmp_lg_u64 s[34:35], 0
    s_cbranch_scc1 KF_CK219_R
KF_CK219_C:
    v_mfma_f32_32x32x16_bf16 v[200:215], v[44:47], v[240:243], v[200:215]
    v_mfma_f32_32x32x16_bf16 v[216:231], v[92:95], v[240:243], v[216:231]
    s_waitcnt vmcnt(0)
    s_mov_b32 s36, 0
KF_CK220:
    v_max3_u32 v64, v244, v245, v246
    v_max_u32 v64, v64, v247
    v_cmp_eq_u32 s[34:35], -1, v64
    s_nop 0
    s_cmp_lg_u64 s[34:35], 0
    s_cbranch_scc1 KF_CK220_R
KF_CK220_C:
    v_mfma_f32_32x32x16_bf16 v[200:215], v[164:167], v[244:247], v[200:215]
    v_mfma_f32_32x32x16_bf16 v[216:231], v[188:191], v[244:247], v[216:231]
    s_waitcnt vmcnt(0)
    s_mov_b32 s36, 0
KF_CK221:
    v_max3_u32 v64, v248, v249, v250
    v_max_u32 v64, v64, v251
    v_cmp_eq_u32 s[34:35], -1, v64
    s_nop 0
    s_cmp_lg_u64 s[34:35], 0
    s_cbranch_scc1 KF_CK221_R
KF_CK221_C:
    v_mfma_f32_32x32x16_bf16 v[200:215], v[168:171], v[248:251], v[200:215]
    v_mfma_f32_32x32x16_bf16 v[216:231], v[192:195], v[248:251], v[216:231]
    s_waitcnt vmcnt(0)
    s_mov_b32 s36, 0
KF_CK222:
    v_max3_u32 v64, v252, v253, v254
    v_max_u32 v64, v64, v255
    v_cmp_eq_u32 s[34:35], -1, v64
    s_nop 0
    s_cmp_lg_u64 s[34:35], 0
    s_cbranch_scc1 KF_CK222_R
KF_CK222_C:
    v_mfma_f32_32x32x16_bf16 v[200:215], v[172:175], v[252:255], v[200:215]
    v_mfma_f32_32x32x16_bf16 v[216:231], v[196:199], v[252:255], v[216:231]
    s_nop 15
    s_branch KF_DS1_R
KF_FALLBACK:
    v_mov_b32 v16, 0xff800000
    s_mov_b32 s56, 0xe80000
KF_FB_LOOP:
    buffer_load_dwordx4 v[12:15], v3, s[4:7], s56 offen sc1
    s_waitcnt vmcnt(0)
    v_mfma_f32_32x32x16_bf16 v[68:83], v[12:15], v[4:7], 0
    s_nop 11
    v_max3_f32 v16, v16, v68, v69
    v_max3_f32 v16, v16, v70, v71
    v_max3_f32 v16, v16, v72, v73
    v_max3_f32 v16, v16, v74, v75
    v_max3_f32 v16, v16, v76, v77
    v_max3_f32 v16, v16, v78, v79
    v_max3_f32 v16, v16, v80, v81
    v_max3_f32 v16, v16, v82, v83
    s_add_u32 s56, s56, 0x400
    s_cmp_lt_u32 s56, 0xe90000
    s_cbranch_scc1 KF_FB_LOOP
    s_mov_b32 s56, 0xe80000
    v_mov_b32 v11, v16
    s_nop 1
    v_permlane32_swap_b32 v11, v16
    v_max_f32 v16, v11, v16
    v_sub_f32 v36, 0, v16
    v_sub_f32 v37, 0, v16
    v_sub_f32 v38, 0, v16
    v_sub_f32 v39, 0, v16
    v_sub_f32 v40, 0, v16
    v_sub_f32 v41, 0, v16
    v_sub_f32 v42, 0, v16
    v_sub_f32 v43, 0, v16
    v_sub_f32 v44, 0, v16
    v_sub_f32 v45, 0, v16
    v_sub_f32 v46, 0, v16
    v_sub_f32 v47, 0, v16
    v_sub_f32 v48, 0, v16
    v_sub_f32 v49, 0, v16
    v_sub_f32 v50, 0, v16
    v_sub_f32 v51, 0, v16
    v_mov_b32 v52, 0
    v_mov_b32 v53, 0
    v_mov_b32 v54, 0
    v_mov_b32 v55, 0
    v_mov_b32 v56, 0
    v_mov_b32 v57, 0
    v_mov_b32 v58, 0
    v_mov_b32 v59, 0
    v_mov_b32 v60, 0
    v_mov_b32 v61, 0
    v_mov_b32 v62, 0
    v_mov_b32 v63, 0
    v_mov_b32 v64, 0
    v_mov_b32 v65, 0
    v_mov_b32 v66, 0
    v_mov_b32 v67, 0
KF_FB_LOOP2:
    buffer_load_dwordx4 v[12:15], v3, s[4:7], s56 offen sc1
    s_mov_b64 exec, s[50:51]
    buffer_load_dwordx4 v[20:23], v10, s[4:7], s56 offen sc1
    buffer_load_dwordx4 v[24:27], v10, s[4:7], s56 offen offset:512 sc1
    s_mov_b64 exec, -1
    s_waitcnt vmcnt(0)
    v_mfma_f32_32x32x16_bf16 v[68:83], v[12:15], v[4:7], v[36:51]
    s_nop 11
    v_exp_f32 v68, v68
    v_exp_f32 v69, v69
    v_exp_f32 v70, v70
    v_exp_f32 v71, v71
    v_exp_f32 v72, v72
    v_exp_f32 v73, v73
    v_exp_f32 v74, v74
    v_exp_f32 v75, v75
    v_exp_f32 v76, v76
    v_exp_f32 v77, v77
    v_exp_f32 v78, v78
    v_exp_f32 v79, v79
    v_exp_f32 v80, v80
    v_exp_f32 v81, v81
    v_exp_f32 v82, v82
    v_exp_f32 v83, v83
    v_smfmac_f32_32x32x32_bf16 v[52:67], v[20:23], v[68:75], v8
    s_nop 0
    v_smfmac_f32_32x32x32_bf16 v[52:67], v[24:27], v[76:83], v8
    s_add_u32 s56, s56, 0x400
    s_cmp_lt_u32 s56, 0xe90000
    s_cbranch_scc1 KF_FB_LOOP2
    s_nop 15
    s_branch KF_FIN
KF_CK1_R:
    s_add_u32 s36, s36, 1
    s_cmp_ge_u32 s36, s41
    s_cselect_b32 s41, 0, s41
    s_cbranch_scc1 KF_CK1_C
    s_sleep 12
    s_add_u32 s25, s37, 0
    s_add_u32 s32, s38, 0
    buffer_load_dwordx4 v[172:175], v3, s[4:7], s25 offen sc1
    buffer_load_dwordx4 v[176:179], v3, s[4:7], s32 offen sc1
    s_waitcnt vmcnt(0)
    s_branch KF_CK1
KF_CK2_R:
    s_add_u32 s36, s36, 1
    s_cmp_ge_u32 s36, s41
    s_cselect_b32 s41, 0, s41
    s_cbranch_scc1 KF_CK2_C
    s_sleep 12
    s_add_u32 s25, s37, 8192
    s_add_u32 s32, s38, 8192
    buffer_load_dwordx4 v[180:183], v3, s[4:7], s25 offen sc1
    buffer_load_dwordx4 v[184:187], v3, s[4:7], s32 offen sc1
    s_waitcnt vmcnt(0)
    s_branch KF_CK2
KF_CK5_R:
    s_add_u32 s36, s36, 1
    s_cmp_ge_u32 s36, s41
    s_cselect_b32 s41, 0, s41
    s_cbranch_scc1 KF_CK5_C
    s_sleep 12
    s_add_u32 s25, s37, 16384
    s_add_u32 s32, s38, 16384
    buffer_load_dwordx4 v[116:119], v3, s[4:7], s25 offen sc1
    buffer_load_dwordx4 v[120:123], v3, s[4:7], s32 offen sc1
    s_waitcnt vmcnt(0)
    s_branch KF_CK5
KF_CK7_R:
    s_add_u32 s36, s36, 1
    s_cmp_ge_u32 s36, s41
    s_cselect_b32 s41, 0, s41
    s_cbranch_scc1 KF_CK7_C
    s_sleep 12
    s_add_u32 s25, s37, 24576
    s_add_u32 s32, s38, 24576
    buffer_load_dwordx4 v[124:127], v3, s[4:7], s25 offen sc1
    buffer_load_dwordx4 v[128:131], v3, s[4:7], s32 offen sc1
    s_waitcnt vmcnt(0)
    s_branch KF_CK7
KF_CK16_R:
    s_add_u32 s36, s36, 1
    s_cmp_ge_u32 s36, s41
    s_cselect_b32 s41, 0, s41
    s_cbranch_scc1 KF_CK16_C
    s_sleep 12
    s_add_u32 s25, s37, 32768
    s_add_u32 s32, s38, 32768
    buffer_load_dwordx4 v[164:167], v3, s[4:7], s25 offen sc1
    buffer_load_dwordx4 v[168:171], v3, s[4:7], s32 offen sc1
    s_waitcnt vmcnt(0)
    s_branch KF_CK16
KF_CK19_R:
    s_add_u32 s36, s36, 1
    s_cmp_ge_u32 s36, s41
    s_cselect_b32 s41, 0, s41
    s_cbranch_scc1 KF_CK19_C
    s_sleep 12
    s_add_u32 s25, s37, 40960
    s_add_u32 s32, s38, 40960
    buffer_load_dwordx4 v[172:175], v3, s[4:7], s25 offen sc1
    buffer_load_dwordx4 v[176:179], v3, s[4:7], s32 offen sc1
    s_waitcnt vmcnt(0)
    s_branch KF_CK19
KF_CK21_R:
    s_add_u32 s36, s36, 1
    s_cmp_ge_u32 s36, s41
    s_cselect_b32 s41, 0, s41
    s_cbranch_scc1 KF_CK21_C
    s_sleep 12
    s_add_u32 s25, s37, 49152
    s_add_u32 s32, s38, 49152
    buffer_load_dwordx4 v[180:183], v3, s[4:7], s25 offen sc1
    buffer_load_dwordx4 v[184:187], v3, s[4:7], s32 offen sc1
    s_waitcnt vmcnt(0)
    s_branch KF_CK21
KF_CK23_R:
    s_add_u32 s36, s36, 1
    s_cmp_ge_u32 s36, s41
    s_cselect_b32 s41, 0, s41
    s_cbranch_scc1 KF_CK23_C
    s_sleep 12
    s_add_u32 s25, s37, 57344
    s_add_u32 s32, s38, 57344
    buffer_load_dwordx4 v[188:191], v3, s[4:7], s25 offen sc1
    buffer_load_dwordx4 v[192:195], v3, s[4:7], s32 offen sc1
    s_waitcnt vmcnt(0)
    s_branch KF_CK23
KF_CK47_R:
    s_add_u32 s36, s36, 1
    s_cmp_ge_u32 s36, s41
    s_cselect_b32 s41, 0, s41
    s_cbranch_scc1 KF_CK47_C
    s_sleep 4
    buffer_load_dwordx4 v[20:23], v3, s[4:7], s48 offen offset:0 sc1
    buffer_load_dwordx4 v[24:27], v3, s[4:7], s48 offen offset:1024 sc1
    buffer_load_dwordx4 v[28:31], v3, s[4:7], s48 offen offset:2048 sc1
    buffer_load_dwordx4 v[32:35], v3, s[4:7], s48 offen offset:3072 sc1
    s_add_u32 s47, s48, 4096
    buffer_load_dwordx4 v[36:39], v3, s[4:7], s47 offen offset:0 sc1
    buffer_load_dwordx4 v[40:43], v3, s[4:7], s47 offen offset:1024 sc1
    buffer_load_dwordx4 v[44:47], v3, s[4:7], s47 offen offset:2048 sc1
    buffer_load_dwordx4 v[48:51], v3, s[4:7], s47 offen offset:3072 sc1
    s_waitcnt vmcnt(0)
    s_branch KF_CK47
KF_CK49_R:
    s_add_u32 s36, s36, 1
    s_cmp_ge_u32 s36, s41
    s_cselect_b32 s41, 0, s41
    s_cbranch_scc1 KF_CK49_C
    s_sleep 4
    s_add_u32 s25, s48, 0
    buffer_load_dwordx4 v[132:135], v3, s[4:7], s25 offen sc1
    s_waitcnt vmcnt(0)
    s_branch KF_CK49
KF_CK50_R:
    s_add_u32 s36, s36, 1
    s_cmp_ge_u32 s36, s41
    s_cselect_b32 s41, 0, s41
    s_cbranch_scc1 KF_CK50_C
    s_sleep 4
    s_add_u32 s25, s48, 1024
    buffer_load_dwordx4 v[132:135], v3, s[4:7], s25 offen sc1
    s_waitcnt vmcnt(0)
    s_branch KF_CK50
KF_CK51_R:
    s_add_u32 s36, s36, 1
    s_cmp_ge_u32 s36, s41
    s_cselect_b32 s41, 0, s41
    s_cbranch_scc1 KF_CK51_C
    s_sleep 4
    s_add_u32 s25, s48, 2048
    buffer_load_dwordx4 v[132:135], v3, s[4:7], s25 offen sc1
    s_waitcnt vmcnt(0)
    s_branch KF_CK51
KF_CK52_R:
    s_add_u32 s36, s36, 1
    s_cmp_ge_u32 s36, s41
    s_cselect_b32 s41, 0, s41
    s_cbranch_scc1 KF_CK52_C
    s_sleep 4
    s_add_u32 s25, s48, 3072
    buffer_load_dwordx4 v[132:135], v3, s[4:7], s25 offen sc1
    s_waitcnt vmcnt(0)
    s_branch KF_CK52
KF_CK53_R:
    s_add_u32 s36, s36, 1
    s_cmp_ge_u32 s36, s41
    s_cselect_b32 s41, 0, s41
    s_cbranch_scc1 KF_CK53_C
    s_sleep 4
    s_add_u32 s25, s48, 4096
    buffer_load_dwordx4 v[132:135], v3, s[4:7], s25 offen sc1
    s_waitcnt vmcnt(0)
    s_branch KF_CK53
KF_CK54_R:
    s_add_u32 s36, s36, 1
    s_cmp_ge_u32 s36, s41
    s_cselect_b32 s41, 0, s41
    s_cbranch_scc1 KF_CK54_C
    s_sleep 4
    s_add_u32 s25, s48, 5120
    buffer_load_dwordx4 v[132:135], v3, s[4:7], s25 offen sc1
    s_waitcnt vmcnt(0)
    s_branch KF_CK54
KF_CK55_R:
    s_add_u32 s36, s36, 1
    s_cmp_ge_u32 s36, s41
    s_cselect_b32 s41, 0, s41
    s_cbranch_scc1 KF_CK55_C
    s_sleep 4
    s_add_u32 s25, s48, 6144
    buffer_load_dwordx4 v[132:135], v3, s[4:7], s25 offen sc1
    s_waitcnt vmcnt(0)
    s_branch KF_CK55
KF_CK56_R:
    s_add_u32 s36, s36, 1
    s_cmp_ge_u32 s36, s41
    s_cselect_b32 s41, 0, s41
    s_cbranch_scc1 KF_CK56_C
    s_sleep 4
    s_add_u32 s25, s48, 7168
    buffer_load_dwordx4 v[132:135], v3, s[4:7], s25 offen sc1
    s_waitcnt vmcnt(0)
    s_branch KF_CK56
KF_CK57_R:
    s_add_u32 s36, s36, 1
    s_cmp_ge_u32 s36, s41
    s_cselect_b32 s41, 0, s41
    s_cbranch_scc1 KF_CK57_C
    s_sleep 4
    s_add_u32 s25, s48, 8192
    buffer_load_dwordx4 v[132:135], v3, s[4:7], s25 offen sc1
    s_waitcnt vmcnt(0)
    s_branch KF_CK57
KF_CK58_R:
    s_add_u32 s36, s36, 1
    s_cmp_ge_u32 s36, s41
    s_cselect_b32 s41, 0, s41
    s_cbranch_scc1 KF_CK58_C
    s_sleep 4
    s_add_u32 s25, s48, 9216
    buffer_load_dwordx4 v[132:135], v3, s[4:7], s25 offen sc1
    s_waitcnt vmcnt(0)
    s_branch KF_CK58
KF_CK59_R:
    s_add_u32 s36, s36, 1
    s_cmp_ge_u32 s36, s41
    s_cselect_b32 s41, 0, s41
    s_cbranch_scc1 KF_CK59_C
    s_sleep 4
    s_add_u32 s25, s48, 10240
    buffer_load_dwordx4 v[132:135], v3, s[4:7], s25 offen sc1
    s_waitcnt vmcnt(0)
    s_branch KF_CK59
KF_CK60_R:
    s_add_u32 s36, s36, 1
    s_cmp_ge_u32 s36, s41
    s_cselect_b32 s41, 0, s41
    s_cbranch_scc1 KF_CK60_C
    s_sleep 4
    s_add_u32 s25, s48, 11264
    buffer_load_dwordx4 v[132:135], v3, s[4:7], s25 offen sc1
    s_waitcnt vmcnt(0)
    s_branch KF_CK60
KF_CK61_R:
    s_add_u32 s36, s36, 1
    s_cmp_ge_u32 s36, s41
    s_cselect_b32 s41, 0, s41
    s_cbranch_scc1 KF_CK61_C
    s_sleep 4
    s_add_u32 s25, s48, 12288
    buffer_load_dwordx4 v[132:135], v3, s[4:7], s25 offen sc1
    s_waitcnt vmcnt(0)
    s_branch KF_CK61
KF_CK62_R:
    s_add_u32 s36, s36, 1
    s_cmp_ge_u32 s36, s41
    s_cselect_b32 s41, 0, s41
    s_cbranch_scc1 KF_CK62_C
    s_sleep 4
    s_add_u32 s25, s48, 13312
    buffer_load_dwordx4 v[132:135], v3, s[4:7], s25 offen sc1
    s_waitcnt vmcnt(0)
    s_branch KF_CK62
KF_CK63_R:
    s_add_u32 s36, s36, 1
    s_cmp_ge_u32 s36, s41
    s_cselect_b32 s41, 0, s41
    s_cbranch_scc1 KF_CK63_C
    s_sleep 4
    s_add_u32 s25, s48, 14336
    buffer_load_dwordx4 v[132:135], v3, s[4:7], s25 offen sc1
    s_waitcnt vmcnt(0)
    s_branch KF_CK63
KF_CK64_R:
    s_add_u32 s36, s36, 1
    s_cmp_ge_u32 s36, s41
    s_cselect_b32 s41, 0, s41
    s_cbranch_scc1 KF_CK64_C
    s_sleep 4
    s_add_u32 s25, s48, 15360
    buffer_load_dwordx4 v[132:135], v3, s[4:7], s25 offen sc1
    s_waitcnt vmcnt(0)
    s_branch KF_CK64
KF_CK65_R:
    s_add_u32 s36, s36, 1
    s_cmp_ge_u32 s36, s41
    s_cselect_b32 s41, 0, s41
    s_cbranch_scc1 KF_CK65_C
    s_sleep 4
    s_add_u32 s25, s48, 16384
    buffer_load_dwordx4 v[132:135], v3, s[4:7], s25 offen sc1
    s_waitcnt vmcnt(0)
    s_branch KF_CK65
KF_CK66_R:
    s_add_u32 s36, s36, 1
    s_cmp_ge_u32 s36, s41
    s_cselect_b32 s41, 0, s41
    s_cbranch_scc1 KF_CK66_C
    s_sleep 4
    s_add_u32 s25, s48, 17408
    buffer_load_dwordx4 v[132:135], v3, s[4:7], s25 offen sc1
    s_waitcnt vmcnt(0)
    s_branch KF_CK66
KF_CK67_R:
    s_add_u32 s36, s36, 1
    s_cmp_ge_u32 s36, s41
    s_cselect_b32 s41, 0, s41
    s_cbranch_scc1 KF_CK67_C
    s_sleep 4
    s_add_u32 s25, s48, 18432
    buffer_load_dwordx4 v[132:135], v3, s[4:7], s25 offen sc1
    s_waitcnt vmcnt(0)
    s_branch KF_CK67
KF_CK68_R:
    s_add_u32 s36, s36, 1
    s_cmp_ge_u32 s36, s41
    s_cselect_b32 s41, 0, s41
    s_cbranch_scc1 KF_CK68_C
    s_sleep 4
    s_add_u32 s25, s48, 19456
    buffer_load_dwordx4 v[132:135], v3, s[4:7], s25 offen sc1
    s_waitcnt vmcnt(0)
    s_branch KF_CK68
KF_CK69_R:
    s_add_u32 s36, s36, 1
    s_cmp_ge_u32 s36, s41
    s_cselect_b32 s41, 0, s41
    s_cbranch_scc1 KF_CK69_C
    s_sleep 4
    s_add_u32 s25, s48, 20480
    buffer_load_dwordx4 v[132:135], v3, s[4:7], s25 offen sc1
    s_waitcnt vmcnt(0)
    s_branch KF_CK69
KF_CK70_R:
    s_add_u32 s36, s36, 1
    s_cmp_ge_u32 s36, s41
    s_cselect_b32 s41, 0, s41
    s_cbranch_scc1 KF_CK70_C
    s_sleep 4
    s_add_u32 s25, s48, 21504
    buffer_load_dwordx4 v[132:135], v3, s[4:7], s25 offen sc1
    s_waitcnt vmcnt(0)
    s_branch KF_CK70
KF_CK71_R:
    s_add_u32 s36, s36, 1
    s_cmp_ge_u32 s36, s41
    s_cselect_b32 s41, 0, s41
    s_cbranch_scc1 KF_CK71_C
    s_sleep 4
    s_add_u32 s25, s48, 22528
    buffer_load_dwordx4 v[132:135], v3, s[4:7], s25 offen sc1
    s_waitcnt vmcnt(0)
    s_branch KF_CK71
KF_CK72_R:
    s_add_u32 s36, s36, 1
    s_cmp_ge_u32 s36, s41
    s_cselect_b32 s41, 0, s41
    s_cbranch_scc1 KF_CK72_C
    s_sleep 4
    s_add_u32 s25, s48, 23552
    buffer_load_dwordx4 v[132:135], v3, s[4:7], s25 offen sc1
    s_waitcnt vmcnt(0)
    s_branch KF_CK72
KF_CK73_R:
    s_add_u32 s36, s36, 1
    s_cmp_ge_u32 s36, s41
    s_cselect_b32 s41, 0, s41
    s_cbranch_scc1 KF_CK73_C
    s_sleep 4
    s_add_u32 s25, s48, 24576
    buffer_load_dwordx4 v[132:135], v3, s[4:7], s25 offen sc1
    s_waitcnt vmcnt(0)
    s_branch KF_CK73
KF_CK74_R:
    s_add_u32 s36, s36, 1
    s_cmp_ge_u32 s36, s41
    s_cselect_b32 s41, 0, s41
    s_cbranch_scc1 KF_CK74_C
    s_sleep 4
    s_add_u32 s25, s48, 25600
    buffer_load_dwordx4 v[132:135], v3, s[4:7], s25 offen sc1
    s_waitcnt vmcnt(0)
    s_branch KF_CK74
KF_CK75_R:
    s_add_u32 s36, s36, 1
    s_cmp_ge_u32 s36, s41
    s_cselect_b32 s41, 0, s41
    s_cbranch_scc1 KF_CK75_C
    s_sleep 4
    s_add_u32 s25, s48, 26624
    buffer_load_dwordx4 v[132:135], v3, s[4:7], s25 offen sc1
    s_waitcnt vmcnt(0)
    s_branch KF_CK75
KF_CK76_R:
    s_add_u32 s36, s36, 1
    s_cmp_ge_u32 s36, s41
    s_cselect_b32 s41, 0, s41
    s_cbranch_scc1 KF_CK76_C
    s_sleep 4
    s_add_u32 s25, s48, 27648
    buffer_load_dwordx4 v[132:135], v3, s[4:7], s25 offen sc1
    s_waitcnt vmcnt(0)
    s_branch KF_CK76
KF_CK77_R:
    s_add_u32 s36, s36, 1
    s_cmp_ge_u32 s36, s41
    s_cselect_b32 s41, 0, s41
    s_cbranch_scc1 KF_CK77_C
    s_sleep 4
    s_add_u32 s25, s48, 28672
    buffer_load_dwordx4 v[132:135], v3, s[4:7], s25 offen sc1
    s_waitcnt vmcnt(0)
    s_branch KF_CK77
KF_CK78_R:
    s_add_u32 s36, s36, 1
    s_cmp_ge_u32 s36, s41
    s_cselect_b32 s41, 0, s41
    s_cbranch_scc1 KF_CK78_C
    s_sleep 4
    s_add_u32 s25, s48, 29696
    buffer_load_dwordx4 v[132:135], v3, s[4:7], s25 offen sc1
    s_waitcnt vmcnt(0)
    s_branch KF_CK78
KF_CK79_R:
    s_add_u32 s36, s36, 1
    s_cmp_ge_u32 s36, s41
    s_cselect_b32 s41, 0, s41
    s_cbranch_scc1 KF_CK79_C
    s_sleep 4
    s_add_u32 s25, s48, 30720
    buffer_load_dwordx4 v[132:135], v3, s[4:7], s25 offen sc1
    s_waitcnt vmcnt(0)
    s_branch KF_CK79
KF_CK80_R:
    s_add_u32 s36, s36, 1
    s_cmp_ge_u32 s36, s41
    s_cselect_b32 s41, 0, s41
    s_cbranch_scc1 KF_CK80_C
    s_sleep 4
    s_add_u32 s25, s48, 31744
    buffer_load_dwordx4 v[132:135], v3, s[4:7], s25 offen sc1
    s_waitcnt vmcnt(0)
    s_branch KF_CK80
KF_CK81_R:
    s_add_u32 s36, s36, 1
    s_cmp_ge_u32 s36, s41
    s_cselect_b32 s41, 0, s41
    s_cbranch_scc1 KF_CK81_C
    s_sleep 4
    s_add_u32 s25, s48, 32768
    buffer_load_dwordx4 v[132:135], v3, s[4:7], s25 offen sc1
    s_waitcnt vmcnt(0)
    s_branch KF_CK81
KF_CK82_R:
    s_add_u32 s36, s36, 1
    s_cmp_ge_u32 s36, s41
    s_cselect_b32 s41, 0, s41
    s_cbranch_scc1 KF_CK82_C
    s_sleep 4
    s_add_u32 s25, s48, 33792
    buffer_load_dwordx4 v[132:135], v3, s[4:7], s25 offen sc1
    s_waitcnt vmcnt(0)
    s_branch KF_CK82
KF_CK83_R:
    s_add_u32 s36, s36, 1
    s_cmp_ge_u32 s36, s41
    s_cselect_b32 s41, 0, s41
    s_cbranch_scc1 KF_CK83_C
    s_sleep 4
    s_add_u32 s25, s48, 34816
    buffer_load_dwordx4 v[132:135], v3, s[4:7], s25 offen sc1
    s_waitcnt vmcnt(0)
    s_branch KF_CK83
KF_CK84_R:
    s_add_u32 s36, s36, 1
    s_cmp_ge_u32 s36, s41
    s_cselect_b32 s41, 0, s41
    s_cbranch_scc1 KF_CK84_C
    s_sleep 4
    s_add_u32 s25, s48, 35840
    buffer_load_dwordx4 v[132:135], v3, s[4:7], s25 offen sc1
    s_waitcnt vmcnt(0)
    s_branch KF_CK84
KF_CK85_R:
    s_add_u32 s36, s36, 1
    s_cmp_ge_u32 s36, s41
    s_cselect_b32 s41, 0, s41
    s_cbranch_scc1 KF_CK85_C
    s_sleep 4
    s_add_u32 s25, s48, 36864
    buffer_load_dwordx4 v[132:135], v3, s[4:7], s25 offen sc1
    s_waitcnt vmcnt(0)
    s_branch KF_CK85
KF_CK86_R:
    s_add_u32 s36, s36, 1
    s_cmp_ge_u32 s36, s41
    s_cselect_b32 s41, 0, s41
    s_cbranch_scc1 KF_CK86_C
    s_sleep 4
    s_add_u32 s25, s48, 37888
    buffer_load_dwordx4 v[132:135], v3, s[4:7], s25 offen sc1
    s_waitcnt vmcnt(0)
    s_branch KF_CK86
KF_CK87_R:
    s_add_u32 s36, s36, 1
    s_cmp_ge_u32 s36, s41
    s_cselect_b32 s41, 0, s41
    s_cbranch_scc1 KF_CK87_C
    s_sleep 4
    s_add_u32 s25, s48, 38912
    buffer_load_dwordx4 v[132:135], v3, s[4:7], s25 offen sc1
    s_waitcnt vmcnt(0)
    s_branch KF_CK87
KF_CK88_R:
    s_add_u32 s36, s36, 1
    s_cmp_ge_u32 s36, s41
    s_cselect_b32 s41, 0, s41
    s_cbranch_scc1 KF_CK88_C
    s_sleep 4
    s_add_u32 s25, s48, 39936
    buffer_load_dwordx4 v[132:135], v3, s[4:7], s25 offen sc1
    s_waitcnt vmcnt(0)
    s_branch KF_CK88
KF_CK89_R:
    s_add_u32 s36, s36, 1
    s_cmp_ge_u32 s36, s41
    s_cselect_b32 s41, 0, s41
    s_cbranch_scc1 KF_CK89_C
    s_sleep 4
    s_add_u32 s25, s48, 40960
    buffer_load_dwordx4 v[132:135], v3, s[4:7], s25 offen sc1
    s_waitcnt vmcnt(0)
    s_branch KF_CK89
KF_CK90_R:
    s_add_u32 s36, s36, 1
    s_cmp_ge_u32 s36, s41
    s_cselect_b32 s41, 0, s41
    s_cbranch_scc1 KF_CK90_C
    s_sleep 4
    s_add_u32 s25, s48, 41984
    buffer_load_dwordx4 v[132:135], v3, s[4:7], s25 offen sc1
    s_waitcnt vmcnt(0)
    s_branch KF_CK90
KF_CK91_R:
    s_add_u32 s36, s36, 1
    s_cmp_ge_u32 s36, s41
    s_cselect_b32 s41, 0, s41
    s_cbranch_scc1 KF_CK91_C
    s_sleep 4
    s_add_u32 s25, s48, 43008
    buffer_load_dwordx4 v[132:135], v3, s[4:7], s25 offen sc1
    s_waitcnt vmcnt(0)
    s_branch KF_CK91
KF_CK92_R:
    s_add_u32 s36, s36, 1
    s_cmp_ge_u32 s36, s41
    s_cselect_b32 s41, 0, s41
    s_cbranch_scc1 KF_CK92_C
    s_sleep 4
    s_add_u32 s25, s48, 44032
    buffer_load_dwordx4 v[132:135], v3, s[4:7], s25 offen sc1
    s_waitcnt vmcnt(0)
    s_branch KF_CK92
KF_CK93_R:
    s_add_u32 s36, s36, 1
    s_cmp_ge_u32 s36, s41
    s_cselect_b32 s41, 0, s41
    s_cbranch_scc1 KF_CK93_C
    s_sleep 4
    s_add_u32 s25, s48, 45056
    buffer_load_dwordx4 v[132:135], v3, s[4:7], s25 offen sc1
    s_waitcnt vmcnt(0)
    s_branch KF_CK93
KF_CK94_R:
    s_add_u32 s36, s36, 1
    s_cmp_ge_u32 s36, s41
    s_cselect_b32 s41, 0, s41
    s_cbranch_scc1 KF_CK94_C
    s_sleep 4
    s_add_u32 s25, s48, 46080
    buffer_load_dwordx4 v[132:135], v3, s[4:7], s25 offen sc1
    s_waitcnt vmcnt(0)
    s_branch KF_CK94
KF_CK95_R:
    s_add_u32 s36, s36, 1
    s_cmp_ge_u32 s36, s41
    s_cselect_b32 s41, 0, s41
    s_cbranch_scc1 KF_CK95_C
    s_sleep 4
    s_add_u32 s25, s48, 47104
    buffer_load_dwordx4 v[132:135], v3, s[4:7], s25 offen sc1
    s_waitcnt vmcnt(0)
    s_branch KF_CK95
KF_CK96_R:
    s_add_u32 s36, s36, 1
    s_cmp_ge_u32 s36, s41
    s_cselect_b32 s41, 0, s41
    s_cbranch_scc1 KF_CK96_C
    s_sleep 4
    s_add_u32 s25, s48, 48128
    buffer_load_dwordx4 v[132:135], v3, s[4:7], s25 offen sc1
    s_waitcnt vmcnt(0)
    s_branch KF_CK96
KF_CK97_R:
    s_add_u32 s36, s36, 1
    s_cmp_ge_u32 s36, s41
    s_cselect_b32 s41, 0, s41
    s_cbranch_scc1 KF_CK97_C
    s_sleep 4
    s_add_u32 s25, s48, 49152
    buffer_load_dwordx4 v[132:135], v3, s[4:7], s25 offen sc1
    s_waitcnt vmcnt(0)
    s_branch KF_CK97
KF_CK98_R:
    s_add_u32 s36, s36, 1
    s_cmp_ge_u32 s36, s41
    s_cselect_b32 s41, 0, s41
    s_cbranch_scc1 KF_CK98_C
    s_sleep 4
    s_add_u32 s25, s48, 50176
    buffer_load_dwordx4 v[132:135], v3, s[4:7], s25 offen sc1
    s_waitcnt vmcnt(0)
    s_branch KF_CK98
KF_CK99_R:
    s_add_u32 s36, s36, 1
    s_cmp_ge_u32 s36, s41
    s_cselect_b32 s41, 0, s41
    s_cbranch_scc1 KF_CK99_C
    s_sleep 4
    s_add_u32 s25, s48, 51200
    buffer_load_dwordx4 v[132:135], v3, s[4:7], s25 offen sc1
    s_waitcnt vmcnt(0)
    s_branch KF_CK99
KF_CK100_R:
    s_add_u32 s36, s36, 1
    s_cmp_ge_u32 s36, s41
    s_cselect_b32 s41, 0, s41
    s_cbranch_scc1 KF_CK100_C
    s_sleep 4
    s_add_u32 s25, s48, 52224
    buffer_load_dwordx4 v[132:135], v3, s[4:7], s25 offen sc1
    s_waitcnt vmcnt(0)
    s_branch KF_CK100
KF_CK101_R:
    s_add_u32 s36, s36, 1
    s_cmp_ge_u32 s36, s41
    s_cselect_b32 s41, 0, s41
    s_cbranch_scc1 KF_CK101_C
    s_sleep 4
    s_add_u32 s25, s48, 53248
    buffer_load_dwordx4 v[132:135], v3, s[4:7], s25 offen sc1
    s_waitcnt vmcnt(0)
    s_branch KF_CK101
KF_CK102_R:
    s_add_u32 s36, s36, 1
    s_cmp_ge_u32 s36, s41
    s_cselect_b32 s41, 0, s41
    s_cbranch_scc1 KF_CK102_C
    s_sleep 4
    s_add_u32 s25, s48, 54272
    buffer_load_dwordx4 v[132:135], v3, s[4:7], s25 offen sc1
    s_waitcnt vmcnt(0)
    s_branch KF_CK102
KF_CK103_R:
    s_add_u32 s36, s36, 1
    s_cmp_ge_u32 s36, s41
    s_cselect_b32 s41, 0, s41
    s_cbranch_scc1 KF_CK103_C
    s_sleep 4
    s_add_u32 s25, s48, 55296
    buffer_load_dwordx4 v[132:135], v3, s[4:7], s25 offen sc1
    s_waitcnt vmcnt(0)
    s_branch KF_CK103
KF_CK104_R:
    s_add_u32 s36, s36, 1
    s_cmp_ge_u32 s36, s41
    s_cselect_b32 s41, 0, s41
    s_cbranch_scc1 KF_CK104_C
    s_sleep 4
    s_add_u32 s25, s48, 56320
    buffer_load_dwordx4 v[132:135], v3, s[4:7], s25 offen sc1
    s_waitcnt vmcnt(0)
    s_branch KF_CK104
KF_CK105_R:
    s_add_u32 s36, s36, 1
    s_cmp_ge_u32 s36, s41
    s_cselect_b32 s41, 0, s41
    s_cbranch_scc1 KF_CK105_C
    s_sleep 4
    s_add_u32 s25, s48, 57344
    buffer_load_dwordx4 v[132:135], v3, s[4:7], s25 offen sc1
    s_waitcnt vmcnt(0)
    s_branch KF_CK105
KF_CK106_R:
    s_add_u32 s36, s36, 1
    s_cmp_ge_u32 s36, s41
    s_cselect_b32 s41, 0, s41
    s_cbranch_scc1 KF_CK106_C
    s_sleep 4
    s_add_u32 s25, s48, 58368
    buffer_load_dwordx4 v[132:135], v3, s[4:7], s25 offen sc1
    s_waitcnt vmcnt(0)
    s_branch KF_CK106
KF_CK107_R:
    s_add_u32 s36, s36, 1
    s_cmp_ge_u32 s36, s41
    s_cselect_b32 s41, 0, s41
    s_cbranch_scc1 KF_CK107_C
    s_sleep 4
    s_add_u32 s25, s48, 59392
    buffer_load_dwordx4 v[132:135], v3, s[4:7], s25 offen sc1
    s_waitcnt vmcnt(0)
    s_branch KF_CK107
KF_CK108_R:
    s_add_u32 s36, s36, 1
    s_cmp_ge_u32 s36, s41
    s_cselect_b32 s41, 0, s41
    s_cbranch_scc1 KF_CK108_C
    s_sleep 4
    s_add_u32 s25, s48, 60416
    buffer_load_dwordx4 v[132:135], v3, s[4:7], s25 offen sc1
    s_waitcnt vmcnt(0)
    s_branch KF_CK108
KF_CK109_R:
    s_add_u32 s36, s36, 1
    s_cmp_ge_u32 s36, s41
    s_cselect_b32 s41, 0, s41
    s_cbranch_scc1 KF_CK109_C
    s_sleep 4
    s_add_u32 s25, s48, 61440
    buffer_load_dwordx4 v[132:135], v3, s[4:7], s25 offen sc1
    s_waitcnt vmcnt(0)
    s_branch KF_CK109
KF_CK110_R:
    s_add_u32 s36, s36, 1
    s_cmp_ge_u32 s36, s41
    s_cselect_b32 s41, 0, s41
    s_cbranch_scc1 KF_CK110_C
    s_sleep 4
    s_add_u32 s25, s48, 62464
    buffer_load_dwordx4 v[132:135], v3, s[4:7], s25 offen sc1
    s_waitcnt vmcnt(0)
    s_branch KF_CK110
KF_CK111_R:
    s_add_u32 s36, s36, 1
    s_cmp_ge_u32 s36, s41
    s_cselect_b32 s41, 0, s41
    s_cbranch_scc1 KF_CK111_C
    s_sleep 4
    s_add_u32 s25, s48, 63488
    buffer_load_dwordx4 v[132:135], v3, s[4:7], s25 offen sc1
    s_waitcnt vmcnt(0)
    s_branch KF_CK111
KF_CK112_R:
    s_add_u32 s36, s36, 1
    s_cmp_ge_u32 s36, s41
    s_cselect_b32 s41, 0, s41
    s_cbranch_scc1 KF_CK112_C
    s_sleep 4
    s_add_u32 s25, s48, 64512
    buffer_load_dwordx4 v[132:135], v3, s[4:7], s25 offen sc1
    s_waitcnt vmcnt(0)
    s_branch KF_CK112
KF_CK113_R:
    s_add_u32 s36, s36, 1
    s_cmp_ge_u32 s36, s41
    s_cselect_b32 s41, 0, s41
    s_cbranch_scc1 KF_CK113_C
    s_sleep 4
    s_add_u32 s25, s48, 65536
    buffer_load_dwordx4 v[132:135], v3, s[4:7], s25 offen sc1
    s_waitcnt vmcnt(0)
    s_branch KF_CK113
KF_CK114_R:
    s_add_u32 s36, s36, 1
    s_cmp_ge_u32 s36, s41
    s_cselect_b32 s41, 0, s41
    s_cbranch_scc1 KF_CK114_C
    s_sleep 4
    s_add_u32 s25, s48, 66560
    buffer_load_dwordx4 v[132:135], v3, s[4:7], s25 offen sc1
    s_waitcnt vmcnt(0)
    s_branch KF_CK114
KF_CK115_R:
    s_add_u32 s36, s36, 1
    s_cmp_ge_u32 s36, s41
    s_cselect_b32 s41, 0, s41
    s_cbranch_scc1 KF_CK115_C
    s_sleep 4
    s_add_u32 s25, s48, 67584
    buffer_load_dwordx4 v[132:135], v3, s[4:7], s25 offen sc1
    s_waitcnt vmcnt(0)
    s_branch KF_CK115
KF_CK116_R:
    s_add_u32 s36, s36, 1
    s_cmp_ge_u32 s36, s41
    s_cselect_b32 s41, 0, s41
    s_cbranch_scc1 KF_CK116_C
    s_sleep 4
    s_add_u32 s25, s48, 68608
    buffer_load_dwordx4 v[132:135], v3, s[4:7], s25 offen sc1
    s_waitcnt vmcnt(0)
    s_branch KF_CK116
KF_CK117_R:
    s_add_u32 s36, s36, 1
    s_cmp_ge_u32 s36, s41
    s_cselect_b32 s41, 0, s41
    s_cbranch_scc1 KF_CK117_C
    s_sleep 4
    s_add_u32 s25, s48, 69632
    buffer_load_dwordx4 v[132:135], v3, s[4:7], s25 offen sc1
    s_waitcnt vmcnt(0)
    s_branch KF_CK117
KF_CK118_R:
    s_add_u32 s36, s36, 1
    s_cmp_ge_u32 s36, s41
    s_cselect_b32 s41, 0, s41
    s_cbranch_scc1 KF_CK118_C
    s_sleep 4
    s_add_u32 s25, s48, 70656
    buffer_load_dwordx4 v[132:135], v3, s[4:7], s25 offen sc1
    s_waitcnt vmcnt(0)
    s_branch KF_CK118
KF_CK119_R:
    s_add_u32 s36, s36, 1
    s_cmp_ge_u32 s36, s41
    s_cselect_b32 s41, 0, s41
    s_cbranch_scc1 KF_CK119_C
    s_sleep 4
    s_add_u32 s25, s48, 71680
    buffer_load_dwordx4 v[132:135], v3, s[4:7], s25 offen sc1
    s_waitcnt vmcnt(0)
    s_branch KF_CK119
KF_CK120_R:
    s_add_u32 s36, s36, 1
    s_cmp_ge_u32 s36, s41
    s_cselect_b32 s41, 0, s41
    s_cbranch_scc1 KF_CK120_C
    s_sleep 4
    s_add_u32 s25, s48, 72704
    buffer_load_dwordx4 v[132:135], v3, s[4:7], s25 offen sc1
    s_waitcnt vmcnt(0)
    s_branch KF_CK120
KF_CK121_R:
    s_add_u32 s36, s36, 1
    s_cmp_ge_u32 s36, s41
    s_cselect_b32 s41, 0, s41
    s_cbranch_scc1 KF_CK121_C
    s_sleep 4
    s_add_u32 s25, s48, 73728
    buffer_load_dwordx4 v[132:135], v3, s[4:7], s25 offen sc1
    s_waitcnt vmcnt(0)
    s_branch KF_CK121
KF_CK122_R:
    s_add_u32 s36, s36, 1
    s_cmp_ge_u32 s36, s41
    s_cselect_b32 s41, 0, s41
    s_cbranch_scc1 KF_CK122_C
    s_sleep 4
    s_add_u32 s25, s48, 74752
    buffer_load_dwordx4 v[132:135], v3, s[4:7], s25 offen sc1
    s_waitcnt vmcnt(0)
    s_branch KF_CK122
KF_CK123_R:
    s_add_u32 s36, s36, 1
    s_cmp_ge_u32 s36, s41
    s_cselect_b32 s41, 0, s41
    s_cbranch_scc1 KF_CK123_C
    s_sleep 4
    s_add_u32 s25, s48, 75776
    buffer_load_dwordx4 v[132:135], v3, s[4:7], s25 offen sc1
    s_waitcnt vmcnt(0)
    s_branch KF_CK123
KF_CK124_R:
    s_add_u32 s36, s36, 1
    s_cmp_ge_u32 s36, s41
    s_cselect_b32 s41, 0, s41
    s_cbranch_scc1 KF_CK124_C
    s_sleep 4
    s_add_u32 s25, s48, 76800
    buffer_load_dwordx4 v[132:135], v3, s[4:7], s25 offen sc1
    s_waitcnt vmcnt(0)
    s_branch KF_CK124
KF_CK125_R:
    s_add_u32 s36, s36, 1
    s_cmp_ge_u32 s36, s41
    s_cselect_b32 s41, 0, s41
    s_cbranch_scc1 KF_CK125_C
    s_sleep 4
    s_add_u32 s25, s48, 77824
    buffer_load_dwordx4 v[132:135], v3, s[4:7], s25 offen sc1
    s_waitcnt vmcnt(0)
    s_branch KF_CK125
KF_CK126_R:
    s_add_u32 s36, s36, 1
    s_cmp_ge_u32 s36, s41
    s_cselect_b32 s41, 0, s41
    s_cbranch_scc1 KF_CK126_C
    s_sleep 4
    s_add_u32 s25, s48, 78848
    buffer_load_dwordx4 v[132:135], v3, s[4:7], s25 offen sc1
    s_waitcnt vmcnt(0)
    s_branch KF_CK126
KF_CK127_R:
    s_add_u32 s36, s36, 1
    s_cmp_ge_u32 s36, s41
    s_cselect_b32 s41, 0, s41
    s_cbranch_scc1 KF_CK127_C
    s_sleep 4
    s_add_u32 s25, s48, 79872
    buffer_load_dwordx4 v[132:135], v3, s[4:7], s25 offen sc1
    s_waitcnt vmcnt(0)
    s_branch KF_CK127
KF_CK128_R:
    s_add_u32 s36, s36, 1
    s_cmp_ge_u32 s36, s41
    s_cselect_b32 s41, 0, s41
    s_cbranch_scc1 KF_CK128_C
    s_sleep 4
    s_add_u32 s25, s48, 80896
    buffer_load_dwordx4 v[132:135], v3, s[4:7], s25 offen sc1
    s_waitcnt vmcnt(0)
    s_branch KF_CK128
KF_CK129_R:
    s_add_u32 s36, s36, 1
    s_cmp_ge_u32 s36, s41
    s_cselect_b32 s41, 0, s41
    s_cbranch_scc1 KF_CK129_C
    s_sleep 4
    s_add_u32 s25, s48, 81920
    buffer_load_dwordx4 v[132:135], v3, s[4:7], s25 offen sc1
    s_waitcnt vmcnt(0)
    s_branch KF_CK129
KF_CK130_R:
    s_add_u32 s36, s36, 1
    s_cmp_ge_u32 s36, s41
    s_cselect_b32 s41, 0, s41
    s_cbranch_scc1 KF_CK130_C
    s_sleep 4
    s_add_u32 s25, s48, 82944
    buffer_load_dwordx4 v[132:135], v3, s[4:7], s25 offen sc1
    s_waitcnt vmcnt(0)
    s_branch KF_CK130
KF_CK131_R:
    s_add_u32 s36, s36, 1
    s_cmp_ge_u32 s36, s41
    s_cselect_b32 s41, 0, s41
    s_cbranch_scc1 KF_CK131_C
    s_sleep 4
    s_add_u32 s25, s48, 83968
    buffer_load_dwordx4 v[132:135], v3, s[4:7], s25 offen sc1
    s_waitcnt vmcnt(0)
    s_branch KF_CK131
KF_CK132_R:
    s_add_u32 s36, s36, 1
    s_cmp_ge_u32 s36, s41
    s_cselect_b32 s41, 0, s41
    s_cbranch_scc1 KF_CK132_C
    s_sleep 4
    s_add_u32 s25, s48, 84992
    buffer_load_dwordx4 v[132:135], v3, s[4:7], s25 offen sc1
    s_waitcnt vmcnt(0)
    s_branch KF_CK132
KF_CK133_R:
    s_add_u32 s36, s36, 1
    s_cmp_ge_u32 s36, s41
    s_cselect_b32 s41, 0, s41
    s_cbranch_scc1 KF_CK133_C
    s_sleep 4
    s_add_u32 s25, s48, 86016
    buffer_load_dwordx4 v[132:135], v3, s[4:7], s25 offen sc1
    s_waitcnt vmcnt(0)
    s_branch KF_CK133
KF_CK134_R:
    s_add_u32 s36, s36, 1
    s_cmp_ge_u32 s36, s41
    s_cselect_b32 s41, 0, s41
    s_cbranch_scc1 KF_CK134_C
    s_sleep 4
    s_add_u32 s25, s48, 87040
    buffer_load_dwordx4 v[132:135], v3, s[4:7], s25 offen sc1
    s_waitcnt vmcnt(0)
    s_branch KF_CK134
KF_CK135_R:
    s_add_u32 s36, s36, 1
    s_cmp_ge_u32 s36, s41
    s_cselect_b32 s41, 0, s41
    s_cbranch_scc1 KF_CK135_C
    s_sleep 4
    s_add_u32 s25, s48, 88064
    buffer_load_dwordx4 v[132:135], v3, s[4:7], s25 offen sc1
    s_waitcnt vmcnt(0)
    s_branch KF_CK135
KF_CK136_R:
    s_add_u32 s36, s36, 1
    s_cmp_ge_u32 s36, s41
    s_cselect_b32 s41, 0, s41
    s_cbranch_scc1 KF_CK136_C
    s_sleep 4
    s_add_u32 s25, s48, 89088
    buffer_load_dwordx4 v[132:135], v3, s[4:7], s25 offen sc1
    s_waitcnt vmcnt(0)
    s_branch KF_CK136
KF_CK137_R:
    s_add_u32 s36, s36, 1
    s_cmp_ge_u32 s36, s41
    s_cselect_b32 s41, 0, s41
    s_cbranch_scc1 KF_CK137_C
    s_sleep 4
    s_add_u32 s25, s48, 90112
    buffer_load_dwordx4 v[132:135], v3, s[4:7], s25 offen sc1
    s_waitcnt vmcnt(0)
    s_branch KF_CK137
KF_CK138_R:
    s_add_u32 s36, s36, 1
    s_cmp_ge_u32 s36, s41
    s_cselect_b32 s41, 0, s41
    s_cbranch_scc1 KF_CK138_C
    s_sleep 4
    s_add_u32 s25, s48, 91136
    buffer_load_dwordx4 v[132:135], v3, s[4:7], s25 offen sc1
    s_waitcnt vmcnt(0)
    s_branch KF_CK138
KF_CK139_R:
    s_add_u32 s36, s36, 1
    s_cmp_ge_u32 s36, s41
    s_cselect_b32 s41, 0, s41
    s_cbranch_scc1 KF_CK139_C
    s_sleep 4
    s_add_u32 s25, s48, 92160
    buffer_load_dwordx4 v[132:135], v3, s[4:7], s25 offen sc1
    s_waitcnt vmcnt(0)
    s_branch KF_CK139
KF_CK140_R:
    s_add_u32 s36, s36, 1
    s_cmp_ge_u32 s36, s41
    s_cselect_b32 s41, 0, s41
    s_cbranch_scc1 KF_CK140_C
    s_sleep 4
    s_add_u32 s25, s48, 93184
    buffer_load_dwordx4 v[132:135], v3, s[4:7], s25 offen sc1
    s_waitcnt vmcnt(0)
    s_branch KF_CK140
KF_CK141_R:
    s_add_u32 s36, s36, 1
    s_cmp_ge_u32 s36, s41
    s_cselect_b32 s41, 0, s41
    s_cbranch_scc1 KF_CK141_C
    s_sleep 4
    s_add_u32 s25, s48, 94208
    buffer_load_dwordx4 v[132:135], v3, s[4:7], s25 offen sc1
    s_waitcnt vmcnt(0)
    s_branch KF_CK141
KF_CK142_R:
    s_add_u32 s36, s36, 1
    s_cmp_ge_u32 s36, s41
    s_cselect_b32 s41, 0, s41
    s_cbranch_scc1 KF_CK142_C
    s_sleep 4
    s_add_u32 s25, s48, 95232
    buffer_load_dwordx4 v[132:135], v3, s[4:7], s25 offen sc1
    s_waitcnt vmcnt(0)
    s_branch KF_CK142
KF_CK143_R:
    s_add_u32 s36, s36, 1
    s_cmp_ge_u32 s36, s41
    s_cselect_b32 s41, 0, s41
    s_cbranch_scc1 KF_CK143_C
    s_sleep 4
    s_add_u32 s25, s48, 96256
    buffer_load_dwordx4 v[132:135], v3, s[4:7], s25 offen sc1
    s_waitcnt vmcnt(0)
    s_branch KF_CK143
KF_CK144_R:
    s_add_u32 s36, s36, 1
    s_cmp_ge_u32 s36, s41
    s_cselect_b32 s41, 0, s41
    s_cbranch_scc1 KF_CK144_C
    s_sleep 4
    s_add_u32 s25, s48, 97280
    buffer_load_dwordx4 v[132:135], v3, s[4:7], s25 offen sc1
    s_waitcnt vmcnt(0)
    s_branch KF_CK144
KF_CK145_R:
    s_add_u32 s36, s36, 1
    s_cmp_ge_u32 s36, s41
    s_cselect_b32 s41, 0, s41
    s_cbranch_scc1 KF_CK145_C
    s_sleep 4
    s_add_u32 s25, s48, 98304
    buffer_load_dwordx4 v[132:135], v3, s[4:7], s25 offen sc1
    s_waitcnt vmcnt(0)
    s_branch KF_CK145
KF_CK146_R:
    s_add_u32 s36, s36, 1
    s_cmp_ge_u32 s36, s41
    s_cselect_b32 s41, 0, s41
    s_cbranch_scc1 KF_CK146_C
    s_sleep 4
    s_add_u32 s25, s48, 99328
    buffer_load_dwordx4 v[132:135], v3, s[4:7], s25 offen sc1
    s_waitcnt vmcnt(0)
    s_branch KF_CK146
KF_CK147_R:
    s_add_u32 s36, s36, 1
    s_cmp_ge_u32 s36, s41
    s_cselect_b32 s41, 0, s41
    s_cbranch_scc1 KF_CK147_C
    s_sleep 4
    s_add_u32 s25, s48, 100352
    buffer_load_dwordx4 v[132:135], v3, s[4:7], s25 offen sc1
    s_waitcnt vmcnt(0)
    s_branch KF_CK147
KF_CK148_R:
    s_add_u32 s36, s36, 1
    s_cmp_ge_u32 s36, s41
    s_cselect_b32 s41, 0, s41
    s_cbranch_scc1 KF_CK148_C
    s_sleep 4
    s_add_u32 s25, s48, 101376
    buffer_load_dwordx4 v[132:135], v3, s[4:7], s25 offen sc1
    s_waitcnt vmcnt(0)
    s_branch KF_CK148
KF_CK149_R:
    s_add_u32 s36, s36, 1
    s_cmp_ge_u32 s36, s41
    s_cselect_b32 s41, 0, s41
    s_cbranch_scc1 KF_CK149_C
    s_sleep 4
    s_add_u32 s25, s48, 102400
    buffer_load_dwordx4 v[132:135], v3, s[4:7], s25 offen sc1
    s_waitcnt vmcnt(0)
    s_branch KF_CK149
KF_CK150_R:
    s_add_u32 s36, s36, 1
    s_cmp_ge_u32 s36, s41
    s_cselect_b32 s41, 0, s41
    s_cbranch_scc1 KF_CK150_C
    s_sleep 4
    s_add_u32 s25, s48, 103424
    buffer_load_dwordx4 v[132:135], v3, s[4:7], s25 offen sc1
    s_waitcnt vmcnt(0)
    s_branch KF_CK150
KF_CK151_R:
    s_add_u32 s36, s36, 1
    s_cmp_ge_u32 s36, s41
    s_cselect_b32 s41, 0, s41
    s_cbranch_scc1 KF_CK151_C
    s_sleep 4
    s_add_u32 s25, s48, 104448
    buffer_load_dwordx4 v[132:135], v3, s[4:7], s25 offen sc1
    s_waitcnt vmcnt(0)
    s_branch KF_CK151
KF_CK152_R:
    s_add_u32 s36, s36, 1
    s_cmp_ge_u32 s36, s41
    s_cselect_b32 s41, 0, s41
    s_cbranch_scc1 KF_CK152_C
    s_sleep 4
    s_add_u32 s25, s48, 105472
    buffer_load_dwordx4 v[132:135], v3, s[4:7], s25 offen sc1
    s_waitcnt vmcnt(0)
    s_branch KF_CK152
KF_CK153_R:
    s_add_u32 s36, s36, 1
    s_cmp_ge_u32 s36, s41
    s_cselect_b32 s41, 0, s41
    s_cbranch_scc1 KF_CK153_C
    s_sleep 4
    s_add_u32 s25, s48, 106496
    buffer_load_dwordx4 v[132:135], v3, s[4:7], s25 offen sc1
    s_waitcnt vmcnt(0)
    s_branch KF_CK153
KF_CK154_R:
    s_add_u32 s36, s36, 1
    s_cmp_ge_u32 s36, s41
    s_cselect_b32 s41, 0, s41
    s_cbranch_scc1 KF_CK154_C
    s_sleep 4
    s_add_u32 s25, s48, 107520
    buffer_load_dwordx4 v[132:135], v3, s[4:7], s25 offen sc1
    s_waitcnt vmcnt(0)
    s_branch KF_CK154
KF_CK155_R:
    s_add_u32 s36, s36, 1
    s_cmp_ge_u32 s36, s41
    s_cselect_b32 s41, 0, s41
    s_cbranch_scc1 KF_CK155_C
    s_sleep 4
    s_add_u32 s25, s48, 108544
    buffer_load_dwordx4 v[132:135], v3, s[4:7], s25 offen sc1
    s_waitcnt vmcnt(0)
    s_branch KF_CK155
KF_CK156_R:
    s_add_u32 s36, s36, 1
    s_cmp_ge_u32 s36, s41
    s_cselect_b32 s41, 0, s41
    s_cbranch_scc1 KF_CK156_C
    s_sleep 4
    s_add_u32 s25, s48, 109568
    buffer_load_dwordx4 v[132:135], v3, s[4:7], s25 offen sc1
    s_waitcnt vmcnt(0)
    s_branch KF_CK156
KF_CK157_R:
    s_add_u32 s36, s36, 1
    s_cmp_ge_u32 s36, s41
    s_cselect_b32 s41, 0, s41
    s_cbranch_scc1 KF_CK157_C
    s_sleep 4
    s_add_u32 s25, s48, 110592
    buffer_load_dwordx4 v[132:135], v3, s[4:7], s25 offen sc1
    s_waitcnt vmcnt(0)
    s_branch KF_CK157
KF_CK158_R:
    s_add_u32 s36, s36, 1
    s_cmp_ge_u32 s36, s41
    s_cselect_b32 s41, 0, s41
    s_cbranch_scc1 KF_CK158_C
    s_sleep 4
    s_add_u32 s25, s48, 111616
    buffer_load_dwordx4 v[132:135], v3, s[4:7], s25 offen sc1
    s_waitcnt vmcnt(0)
    s_branch KF_CK158
KF_CK159_R:
    s_add_u32 s36, s36, 1
    s_cmp_ge_u32 s36, s41
    s_cselect_b32 s41, 0, s41
    s_cbranch_scc1 KF_CK159_C
    s_sleep 4
    s_add_u32 s25, s48, 112640
    buffer_load_dwordx4 v[132:135], v3, s[4:7], s25 offen sc1
    s_waitcnt vmcnt(0)
    s_branch KF_CK159
KF_CK160_R:
    s_add_u32 s36, s36, 1
    s_cmp_ge_u32 s36, s41
    s_cselect_b32 s41, 0, s41
    s_cbranch_scc1 KF_CK160_C
    s_sleep 4
    s_add_u32 s25, s48, 113664
    buffer_load_dwordx4 v[132:135], v3, s[4:7], s25 offen sc1
    s_waitcnt vmcnt(0)
    s_branch KF_CK160
KF_CK161_R:
    s_add_u32 s36, s36, 1
    s_cmp_ge_u32 s36, s41
    s_cselect_b32 s41, 0, s41
    s_cbranch_scc1 KF_CK161_C
    s_sleep 4
    s_add_u32 s25, s48, 114688
    buffer_load_dwordx4 v[132:135], v3, s[4:7], s25 offen sc1
    s_waitcnt vmcnt(0)
    s_branch KF_CK161
KF_CK162_R:
    s_add_u32 s36, s36, 1
    s_cmp_ge_u32 s36, s41
    s_cselect_b32 s41, 0, s41
    s_cbranch_scc1 KF_CK162_C
    s_sleep 4
    s_add_u32 s25, s48, 115712
    buffer_load_dwordx4 v[132:135], v3, s[4:7], s25 offen sc1
    s_waitcnt vmcnt(0)
    s_branch KF_CK162
KF_CK163_R:
    s_add_u32 s36, s36, 1
    s_cmp_ge_u32 s36, s41
    s_cselect_b32 s41, 0, s41
    s_cbranch_scc1 KF_CK163_C
    s_sleep 4
    s_add_u32 s25, s48, 116736
    buffer_load_dwordx4 v[132:135], v3, s[4:7], s25 offen sc1
    s_waitcnt vmcnt(0)
    s_branch KF_CK163
KF_CK164_R:
    s_add_u32 s36, s36, 1
    s_cmp_ge_u32 s36, s41
    s_cselect_b32 s41, 0, s41
    s_cbranch_scc1 KF_CK164_C
    s_sleep 4
    s_add_u32 s25, s48, 117760
    buffer_load_dwordx4 v[132:135], v3, s[4:7], s25 offen sc1
    s_waitcnt vmcnt(0)
    s_branch KF_CK164
KF_CK165_R:
    s_add_u32 s36, s36, 1
    s_cmp_ge_u32 s36, s41
    s_cselect_b32 s41, 0, s41
    s_cbranch_scc1 KF_CK165_C
    s_sleep 4
    s_add_u32 s25, s48, 118784
    buffer_load_dwordx4 v[132:135], v3, s[4:7], s25 offen sc1
    s_waitcnt vmcnt(0)
    s_branch KF_CK165
KF_CK166_R:
    s_add_u32 s36, s36, 1
    s_cmp_ge_u32 s36, s41
    s_cselect_b32 s41, 0, s41
    s_cbranch_scc1 KF_CK166_C
    s_sleep 4
    s_add_u32 s25, s48, 119808
    buffer_load_dwordx4 v[132:135], v3, s[4:7], s25 offen sc1
    s_waitcnt vmcnt(0)
    s_branch KF_CK166
KF_CK167_R:
    s_add_u32 s36, s36, 1
    s_cmp_ge_u32 s36, s41
    s_cselect_b32 s41, 0, s41
    s_cbranch_scc1 KF_CK167_C
    s_sleep 4
    s_add_u32 s25, s48, 120832
    buffer_load_dwordx4 v[132:135], v3, s[4:7], s25 offen sc1
    s_waitcnt vmcnt(0)
    s_branch KF_CK167
KF_CK168_R:
    s_add_u32 s36, s36, 1
    s_cmp_ge_u32 s36, s41
    s_cselect_b32 s41, 0, s41
    s_cbranch_scc1 KF_CK168_C
    s_sleep 4
    s_add_u32 s25, s48, 121856
    buffer_load_dwordx4 v[132:135], v3, s[4:7], s25 offen sc1
    s_waitcnt vmcnt(0)
    s_branch KF_CK168
KF_CK169_R:
    s_add_u32 s36, s36, 1
    s_cmp_ge_u32 s36, s41
    s_cselect_b32 s41, 0, s41
    s_cbranch_scc1 KF_CK169_C
    s_sleep 4
    s_add_u32 s25, s48, 122880
    buffer_load_dwordx4 v[132:135], v3, s[4:7], s25 offen sc1
    s_waitcnt vmcnt(0)
    s_branch KF_CK169
KF_CK170_R:
    s_add_u32 s36, s36, 1
    s_cmp_ge_u32 s36, s41
    s_cselect_b32 s41, 0, s41
    s_cbranch_scc1 KF_CK170_C
    s_sleep 4
    s_add_u32 s25, s48, 123904
    buffer_load_dwordx4 v[132:135], v3, s[4:7], s25 offen sc1
    s_waitcnt vmcnt(0)
    s_branch KF_CK170
KF_CK171_R:
    s_add_u32 s36, s36, 1
    s_cmp_ge_u32 s36, s41
    s_cselect_b32 s41, 0, s41
    s_cbranch_scc1 KF_CK171_C
    s_sleep 4
    s_add_u32 s25, s48, 124928
    buffer_load_dwordx4 v[132:135], v3, s[4:7], s25 offen sc1
    s_waitcnt vmcnt(0)
    s_branch KF_CK171
KF_CK172_R:
    s_add_u32 s36, s36, 1
    s_cmp_ge_u32 s36, s41
    s_cselect_b32 s41, 0, s41
    s_cbranch_scc1 KF_CK172_C
    s_sleep 4
    s_add_u32 s25, s48, 125952
    buffer_load_dwordx4 v[132:135], v3, s[4:7], s25 offen sc1
    s_waitcnt vmcnt(0)
    s_branch KF_CK172
KF_CK173_R:
    s_add_u32 s36, s36, 1
    s_cmp_ge_u32 s36, s41
    s_cselect_b32 s41, 0, s41
    s_cbranch_scc1 KF_CK173_C
    s_sleep 4
    s_add_u32 s25, s48, 126976
    buffer_load_dwordx4 v[132:135], v3, s[4:7], s25 offen sc1
    s_waitcnt vmcnt(0)
    s_branch KF_CK173
KF_CK174_R:
    s_add_u32 s36, s36, 1
    s_cmp_ge_u32 s36, s41
    s_cselect_b32 s41, 0, s41
    s_cbranch_scc1 KF_CK174_C
    s_sleep 4
    s_add_u32 s25, s48, 128000
    buffer_load_dwordx4 v[132:135], v3, s[4:7], s25 offen sc1
    s_waitcnt vmcnt(0)
    s_branch KF_CK174
KF_CK175_R:
    s_add_u32 s36, s36, 1
    s_cmp_ge_u32 s36, s41
    s_cselect_b32 s41, 0, s41
    s_cbranch_scc1 KF_CK175_C
    s_sleep 4
    s_add_u32 s25, s48, 129024
    buffer_load_dwordx4 v[132:135], v3, s[4:7], s25 offen sc1
    s_waitcnt vmcnt(0)
    s_branch KF_CK175
KF_CK176_R:
    s_add_u32 s36, s36, 1
    s_cmp_ge_u32 s36, s41
    s_cselect_b32 s41, 0, s41
    s_cbranch_scc1 KF_CK176_C
    s_sleep 4
    s_add_u32 s25, s48, 130048
    buffer_load_dwordx4 v[132:135], v3, s[4:7], s25 offen sc1
    s_waitcnt vmcnt(0)
    s_branch KF_CK176
KF_ST_R:
    s_add_u32 s36, s36, 1
    s_cmp_ge_u32 s36, 64
    s_cbranch_scc1 KF_ST_C
    s_sleep 8
    buffer_load_dwordx4 v[116:119], v3, s[4:7], s33 offen offset:0 sc1
    buffer_load_dwordx4 v[120:123], v3, s[4:7], s33 offen offset:1024 sc1
    s_waitcnt vmcnt(0)
    s_branch KF_ST_A
KF_CK195_R:
    s_add_u32 s36, s36, 1
    s_cmp_ge_u32 s36, s41
    s_cselect_b32 s41, 0, s41
    s_cbranch_scc1 KF_CK195_C
    s_sleep 6
    s_add_u32 s25, s38, 0
    buffer_load_dwordx4 v[200:203], v3, s[4:7], s25 offen offset:0 sc1
    s_waitcnt vmcnt(0)
    s_branch KF_CK195
KF_CK196_R:
    s_add_u32 s36, s36, 1
    s_cmp_ge_u32 s36, s41
    s_cselect_b32 s41, 0, s41
    s_cbranch_scc1 KF_CK196_C
    s_sleep 6
    s_add_u32 s25, s38, 0
    buffer_load_dwordx4 v[204:207], v3, s[4:7], s25 offen offset:1024 sc1
    s_waitcnt vmcnt(0)
    s_branch KF_CK196
KF_CK197_R:
    s_add_u32 s36, s36, 1
    s_cmp_ge_u32 s36, s41
    s_cselect_b32 s41, 0, s41
    s_cbranch_scc1 KF_CK197_C
    s_sleep 6
    s_add_u32 s25, s38, 0
    buffer_load_dwordx4 v[208:211], v3, s[4:7], s25 offen offset:2048 sc1
    s_waitcnt vmcnt(0)
    s_branch KF_CK197
KF_CK198_R:
    s_add_u32 s36, s36, 1
    s_cmp_ge_u32 s36, s41
    s_cselect_b32 s41, 0, s41
    s_cbranch_scc1 KF_CK198_C
    s_sleep 6
    s_add_u32 s25, s38, 0
    buffer_load_dwordx4 v[212:215], v3, s[4:7], s25 offen offset:3072 sc1
    s_waitcnt vmcnt(0)
    s_branch KF_CK198
KF_CK199_R:
    s_add_u32 s36, s36, 1
    s_cmp_ge_u32 s36, s41
    s_cselect_b32 s41, 0, s41
    s_cbranch_scc1 KF_CK199_C
    s_sleep 6
    s_add_u32 s25, s38, 4096
    buffer_load_dwordx4 v[216:219], v3, s[4:7], s25 offen offset:0 sc1
    s_waitcnt vmcnt(0)
    s_branch KF_CK199
KF_CK200_R:
    s_add_u32 s36, s36, 1
    s_cmp_ge_u32 s36, s41
    s_cselect_b32 s41, 0, s41
    s_cbranch_scc1 KF_CK200_C
    s_sleep 6
    s_add_u32 s25, s38, 4096
    buffer_load_dwordx4 v[220:223], v3, s[4:7], s25 offen offset:1024 sc1
    s_waitcnt vmcnt(0)
    s_branch KF_CK200
KF_CK201_R:
    s_add_u32 s36, s36, 1
    s_cmp_ge_u32 s36, s41
    s_cselect_b32 s41, 0, s41
    s_cbranch_scc1 KF_CK201_C
    s_sleep 6
    s_add_u32 s25, s38, 4096
    buffer_load_dwordx4 v[224:227], v3, s[4:7], s25 offen offset:2048 sc1
    s_waitcnt vmcnt(0)
    s_branch KF_CK201
KF_CK202_R:
    s_add_u32 s36, s36, 1
    s_cmp_ge_u32 s36, s41
    s_cselect_b32 s41, 0, s41
    s_cbranch_scc1 KF_CK202_C
    s_sleep 6
    s_add_u32 s25, s38, 4096
    buffer_load_dwordx4 v[228:231], v3, s[4:7], s25 offen offset:3072 sc1
    s_waitcnt vmcnt(0)
    s_branch KF_CK202
KF_CK203_R:
    s_add_u32 s36, s36, 1
    s_cmp_ge_u32 s36, s41
    s_cselect_b32 s41, 0, s41
    s_cbranch_scc1 KF_CK203_C
    s_sleep 6
    s_add_u32 s25, s38, 8192
    buffer_load_dwordx4 v[232:235], v3, s[4:7], s25 offen offset:0 sc1
    s_waitcnt vmcnt(0)
    s_branch KF_CK203
KF_CK204_R:
    s_add_u32 s36, s36, 1
    s_cmp_ge_u32 s36, s41
    s_cselect_b32 s41, 0, s41
    s_cbranch_scc1 KF_CK204_C
    s_sleep 6
    s_add_u32 s25, s38, 8192
    buffer_load_dwordx4 v[236:239], v3, s[4:7], s25 offen offset:1024 sc1
    s_waitcnt vmcnt(0)
    s_branch KF_CK204
KF_CK205_R:
    s_add_u32 s36, s36, 1
    s_cmp_ge_u32 s36, s41
    s_cselect_b32 s41, 0, s41
    s_cbranch_scc1 KF_CK205_C
    s_sleep 6
    s_add_u32 s25, s38, 8192
    buffer_load_dwordx4 v[240:243], v3, s[4:7], s25 offen offset:2048 sc1
    s_waitcnt vmcnt(0)
    s_branch KF_CK205
KF_CK206_R:
    s_add_u32 s36, s36, 1
    s_cmp_ge_u32 s36, s41
    s_cselect_b32 s41, 0, s41
    s_cbranch_scc1 KF_CK206_C
    s_sleep 6
    s_add_u32 s25, s38, 8192
    buffer_load_dwordx4 v[244:247], v3, s[4:7], s25 offen offset:3072 sc1
    s_waitcnt vmcnt(0)
    s_branch KF_CK206
KF_CK207_R:
    s_add_u32 s36, s36, 1
    s_cmp_ge_u32 s36, s41
    s_cselect_b32 s41, 0, s41
    s_cbranch_scc1 KF_CK207_C
    s_sleep 6
    s_add_u32 s25, s38, 12288
    buffer_load_dwordx4 v[248:251], v3, s[4:7], s25 offen offset:0 sc1
    s_waitcnt vmcnt(0)
    s_branch KF_CK207
KF_CK208_R:
    s_add_u32 s36, s36, 1
    s_cmp_ge_u32 s36, s41
    s_cselect_b32 s41, 0, s41
    s_cbranch_scc1 KF_CK208_C
    s_sleep 6
    s_add_u32 s25, s38, 12288
    buffer_load_dwordx4 v[252:255], v3, s[4:7], s25 offen offset:1024 sc1
    s_waitcnt vmcnt(0)
    s_branch KF_CK208
KF_CK209_R:
    s_add_u32 s36, s36, 1
    s_cmp_ge_u32 s36, s41
    s_cselect_b32 s41, 0, s41
    s_cbranch_scc1 KF_CK209_C
    s_sleep 6
    s_add_u32 s25, s39, 0
    buffer_load_dwordx4 v[132:135], v3, s[4:7], s25 offen offset:0 sc1
    s_waitcnt vmcnt(0)
    s_branch KF_CK209
KF_CK210_R:
    s_add_u32 s36, s36, 1
    s_cmp_ge_u32 s36, s41
    s_cselect_b32 s41, 0, s41
    s_cbranch_scc1 KF_CK210_C
    s_sleep 6
    s_add_u32 s25, s39, 0
    buffer_load_dwordx4 v[136:139], v3, s[4:7], s25 offen offset:1024 sc1
    s_waitcnt vmcnt(0)
    s_branch KF_CK210
KF_CK211_R:
    s_add_u32 s36, s36, 1
    s_cmp_ge_u32 s36, s41
    s_cselect_b32 s41, 0, s41
    s_cbranch_scc1 KF_CK211_C
    s_sleep 6
    s_add_u32 s25, s39, 0
    buffer_load_dwordx4 v[140:143], v3, s[4:7], s25 offen offset:2048 sc1
    s_waitcnt vmcnt(0)
    s_branch KF_CK211
KF_CK212_R:
    s_add_u32 s36, s36, 1
    s_cmp_ge_u32 s36, s41
    s_cselect_b32 s41, 0, s41
    s_cbranch_scc1 KF_CK212_C
    s_sleep 6
    s_add_u32 s25, s39, 0
    buffer_load_dwordx4 v[144:147], v3, s[4:7], s25 offen offset:3072 sc1
    s_waitcnt vmcnt(0)
    s_branch KF_CK212
KF_CK213_R:
    s_add_u32 s36, s36, 1
    s_cmp_ge_u32 s36, s41
    s_cselect_b32 s41, 0, s41
    s_cbranch_scc1 KF_CK213_C
    s_sleep 6
    s_add_u32 s25, s39, 4096
    buffer_load_dwordx4 v[148:151], v3, s[4:7], s25 offen offset:3072 sc1
    s_waitcnt vmcnt(0)
    s_branch KF_CK213
KF_CK214_R:
    s_add_u32 s36, s36, 1
    s_cmp_ge_u32 s36, s41
    s_cselect_b32 s41, 0, s41
    s_cbranch_scc1 KF_CK214_C
    s_sleep 6
    s_add_u32 s25, s39, 8192
    buffer_load_dwordx4 v[152:155], v3, s[4:7], s25 offen offset:0 sc1
    s_waitcnt vmcnt(0)
    s_branch KF_CK214
KF_CK215_R:
    s_add_u32 s36, s36, 1
    s_cmp_ge_u32 s36, s41
    s_cselect_b32 s41, 0, s41
    s_cbranch_scc1 KF_CK215_C
    s_sleep 6
    s_add_u32 s25, s39, 8192
    buffer_load_dwordx4 v[156:159], v3, s[4:7], s25 offen offset:1024 sc1
    s_waitcnt vmcnt(0)
    s_branch KF_CK215
KF_CK216_R:
    s_add_u32 s36, s36, 1
    s_cmp_ge_u32 s36, s41
    s_cselect_b32 s41, 0, s41
    s_cbranch_scc1 KF_CK216_C
    s_sleep 6
    s_add_u32 s25, s39, 8192
    buffer_load_dwordx4 v[160:163], v3, s[4:7], s25 offen offset:2048 sc1
    s_waitcnt vmcnt(0)
    s_branch KF_CK216
KF_CK217_R:
    s_add_u32 s36, s36, 1
    s_cmp_ge_u32 s36, s41
    s_cselect_b32 s41, 0, s41
    s_cbranch_scc1 KF_CK217_C
    s_sleep 6
    s_add_u32 s25, s39, 4096
    buffer_load_dwordx4 v[232:235], v3, s[4:7], s25 offen offset:0 sc1
    s_waitcnt vmcnt(0)
    s_branch KF_CK217
KF_CK218_R:
    s_add_u32 s36, s36, 1
    s_cmp_ge_u32 s36, s41
    s_cselect_b32 s41, 0, s41
    s_cbranch_scc1 KF_CK218_C
    s_sleep 6
    s_add_u32 s25, s39, 4096
    buffer_load_dwordx4 v[236:239], v3, s[4:7], s25 offen offset:1024 sc1
    s_waitcnt vmcnt(0)
    s_branch KF_CK218
KF_CK219_R:
    s_add_u32 s36, s36, 1
    s_cmp_ge_u32 s36, s41
    s_cselect_b32 s41, 0, s41
    s_cbranch_scc1 KF_CK219_C
    s_sleep 6
    s_add_u32 s25, s39, 4096
    buffer_load_dwordx4 v[240:243], v3, s[4:7], s25 offen offset:2048 sc1
    s_waitcnt vmcnt(0)
    s_branch KF_CK219
KF_CK220_R:
    s_add_u32 s36, s36, 1
    s_cmp_ge_u32 s36, s41
    s_cselect_b32 s41, 0, s41
    s_cbranch_scc1 KF_CK220_C
    s_sleep 6
    s_add_u32 s25, s39, 8192
    buffer_load_dwordx4 v[244:247], v3, s[4:7], s25 offen offset:3072 sc1
    s_waitcnt vmcnt(0)
    s_branch KF_CK220
KF_CK221_R:
    s_add_u32 s36, s36, 1
    s_cmp_ge_u32 s36, s41
    s_cselect_b32 s41, 0, s41
    s_cbranch_scc1 KF_CK221_C
    s_sleep 6
    s_add_u32 s25, s39, 12288
    buffer_load_dwordx4 v[248:251], v3, s[4:7], s25 offen offset:0 sc1
    s_waitcnt vmcnt(0)
    s_branch KF_CK221
KF_CK222_R:
    s_add_u32 s36, s36, 1
    s_cmp_ge_u32 s36, s41
    s_cselect_b32 s41, 0, s41
    s_cbranch_scc1 KF_CK222_C
    s_sleep 6
    s_add_u32 s25, s39, 12288
    buffer_load_dwordx4 v[252:255], v3, s[4:7], s25 offen offset:1024 sc1
    s_waitcnt vmcnt(0)
    s_branch KF_CK222
KF_END:
    s_endpgm

.section .rodata,"a"
.p2align 6
.amdhsa_kernel kf_main_kernel
  .amdhsa_next_free_vgpr 256
  .amdhsa_next_free_sgpr 100
  .amdhsa_accum_offset 256
  .amdhsa_group_segment_fixed_size 0
  .amdhsa_kernarg_size 112
  .amdhsa_user_sgpr_count 2
  .amdhsa_user_sgpr_kernarg_segment_ptr 1
  .amdhsa_system_sgpr_workgroup_id_x 1
.end_amdhsa_kernel
```
